```python
import torch

def _softmax(x, axis=-1):
    return torch.softmax(x, dim=axis)
def _gelu(x):
    return torch.nn.functional.gelu(x, approximate="tanh")
def _silu(x):
    return torch.nn.functional.silu(x)
def _sigmoid(x):
    return torch.sigmoid(x)
def _layernorm(x, axis=-1, eps=1e-5):
    m = x.mean(dim=axis, keepdim=True)
    v = x.var(dim=axis, keepdim=True, unbiased=False)
    return (x - m) / torch.sqrt(v + eps)
def _scatter_add(tgt, idx, src, axis=0):
    return tgt.clone().index_add_(axis, idx, src)
def _segment_sum(src, seg, n):
    out = torch.zeros((n,) + src.shape[1:], dtype=src.dtype)
    return out.index_add_(0, seg, src)
def _pad(x, pw):
    flat = tuple(v for pair in reversed(pw) for v in pair)
    return torch.nn.functional.pad(x, flat)

kernel_name = 'recurrent_scan__ssm_conv_s5__mixer_channel_mlp__prompt'

def setup_inputs():

    _w = (lambda a: (lambda t: t.to(torch.bfloat16) if t.is_floating_point() else t)(torch.as_tensor(a)))
    def _A_setup():
        B, S, D = 1, 2048, 576
        P = D
        Lambda_re = -0.5 * (lambda _x: torch.exp(torch.as_tensor(_x)))((lambda *s: torch.randn(*s, dtype=torch.bfloat16) * 0.2)(P))
        Lambda_im = (lambda *s: torch.randn(*s, dtype=torch.bfloat16) * 0.8)(P) * 1.0
        B_re = (lambda *s: torch.randn(*s, dtype=torch.bfloat16) * 0.2)(P, D) * (D ** -0.5)
        B_im = (lambda *s: torch.randn(*s, dtype=torch.bfloat16) * 0.2)(P, D) * (D ** -0.5)
        C_re = (lambda *s: torch.randn(*s, dtype=torch.bfloat16) * 0.2)(D, P) * (P ** -0.5)
        C_im = (lambda *s: torch.randn(*s, dtype=torch.bfloat16) * 0.2)(D, P) * (P ** -0.5)
        log_dt = (lambda *s: torch.randn(*s, dtype=torch.bfloat16) * 0.2)(P) * 0.3 - 2.0
        Dskip = (lambda *s: torch.randn(*s, dtype=torch.bfloat16) * 0.05)(D)
        return {
            "x": _w((lambda *s: torch.randn(*s, dtype=torch.bfloat16) * 0.05)(B, S, D)),
            "Lambda_re": _w(Lambda_re),
            "Lambda_im": _w(Lambda_im),
            "B_re": _w(B_re),
            "B_im": _w(B_im),
            "C_re": _w(C_re),
            "C_im": _w(C_im),
            "log_dt": _w(log_dt),
            "Dskip": _w(Dskip),
        }
    _A_in = _A_setup()

    def _B_setup():
        B, S, D, F = 1, 2048, 576, 4608
        return {
            "x": _w((lambda *s: torch.randn(*s, dtype=torch.bfloat16) * 0.05)(B, S, D)),
            "w1": _w((lambda *s: torch.randn(*s, dtype=torch.bfloat16) * 3.2)(D, F) * (D ** -0.5)),
            "b1": _w((lambda *s: torch.randn(*s, dtype=torch.bfloat16) * 1.6)(F)),
            "w2": _w((lambda *s: torch.randn(*s, dtype=torch.bfloat16) * 0.1)(F, D) * (F ** -0.5)),
            "b2": _w((lambda *s: torch.randn(*s, dtype=torch.bfloat16) * 0.1)(D)),
        }
    _B_in = _B_setup()

    return {
        "A_x": _A_in["x"],
        "A_Lambda_re": _A_in["Lambda_re"],
        "A_Lambda_im": _A_in["Lambda_im"],
        "A_B_re": _A_in["B_re"],
        "A_B_im": _A_in["B_im"],
        "A_C_re": _A_in["C_re"],
        "A_C_im": _A_in["C_im"],
        "A_log_dt": _A_in["log_dt"],
        "A_Dskip": _A_in["Dskip"],
        "B_x": _B_in["x"],
        "B_w1": _B_in["w1"],
        "B_b1": _B_in["b1"],
        "B_w2": _B_in["w2"],
        "B_b2": _B_in["b2"],
    }

def reference(A_x, A_Lambda_re, A_Lambda_im, A_B_re, A_B_im, A_C_re, A_C_im, A_log_dt, A_Dskip, B_x, B_w1, B_b1, B_w2, B_b2):
    def _A_ref(x, Lambda_re, Lambda_im, B_re, B_im, C_re, C_im, log_dt, Dskip):
        Bsz, L, H = x.shape
        Lam = Lambda_re + 1j * Lambda_im
        Bmat = B_re + 1j * B_im
        Cmat = C_re + 1j * C_im
        dt = torch.exp(log_dt)
        Lam_bar = torch.exp(dt * Lam)
        B_bar = ((Lam_bar - 1.0) / Lam)[:, None] * Bmat
        Bu = torch.einsum("bld,pd->blp", x + 0j, B_bar)
        h = torch.zeros_like(Bu[:, 0, :])
        hs = []
        for t in range(L):
            h = Lam_bar[None, :] * h + Bu[:, t, :]
            hs.append(h)
        hseq = torch.stack(hs, 1)
        y = 2.0 * torch.einsum("blp,dp->bld", hseq, Cmat).real + x * Dskip[None, None, :]
        return y

    def _B_ref(x, w1, b1, w2, b2):
        y = _layernorm(x, axis=-1)
        h = _gelu(torch.einsum("bsd,df->bsf", y, w1) + b1)
        return torch.einsum("bsf,fd->bsd", h, w2) + b2

    x = A_x
    xn = _layernorm(x, axis=-1)
    s = _A_ref(xn, A_Lambda_re, A_Lambda_im, A_B_re, A_B_im, A_C_re, A_C_im, A_log_dt, A_Dskip)
    g = _silu(_B_ref(xn, B_w1, B_b1, B_w2, B_b2))
    return x + s * g
```

```asm
; @launch grid=(256,1,1) block=(512,1,1) lds=163840
.amdgcn_target "amdgcn-amd-amdhsa--gfx950"
.text
.globl recurrent_scan__ssm_conv_s5__mixer_channel_mlp__prompt_kernel
.p2align 8
.type recurrent_scan__ssm_conv_s5__mixer_channel_mlp__prompt_kernel,@function
recurrent_scan__ssm_conv_s5__mixer_channel_mlp__prompt_kernel:
s_cmp_ge_u32 s2, 256
s_cbranch_scc1 L_exit
s_load_dwordx16 s[68:83], s[0:1], 0
s_load_dwordx16 s[84:99], s[0:1], 64
s_load_dwordx2 s[66:67], s[0:1], 128
v_lshrrev_b32 v2, 6, v0
v_and_b32 v1, 63, v0
v_readfirstlane_b32 s3, v2
s_getpc_b64 s[46:47]
L_pc0:
s_cmp_lt_u32 s3, 6
s_cbranch_scc1 L_pc1
s_bfe_u32 s48, s2, 131075
s_lshl_b32 s48, s48, 14
v_subrev_u32 v108, 384, v0
v_lshl_add_u32 v108, v108, 7, s48
v_min_u32 v108, L_exit-L_pc0, v108
v_mov_b32 v109, s47
v_add_co_u32 v108, vcc, s46, v108
s_nop 1
v_addc_co_u32 v109, vcc, 0, v109, vcc
global_load_dword v110, v[108:109], off
L_pc1:
s_and_b32 s28, s2, 7
s_lshr_b32 s29, s2, 3
s_lshr_b32 s30, s28, 1
s_and_b32 s31, s29, 3
s_mul_i32 s7, s30, 3
s_add_u32 s7, s7, s31
s_add_u32 s30, s30, 12
s_cmp_eq_u32 s31, 3
s_cselect_b32 s7, s30, s7
s_and_b32 s28, s28, 1
s_lshl_b32 s28, s28, 3
s_lshr_b32 s6, s29, 2
s_add_u32 s6, s6, s28
s_and_b32 s4, s3, 3
s_lshr_b32 s5, s3, 2
s_mov_b32 s63, 0x3f803f80
s_lshr_b32 s61, s2, 1
s_and_b32 s61, s61, 4
s_xor_b32 s61, s61, s3
s_waitcnt lgkmcnt(0)
s_mov_b32 s8, s68
s_mov_b32 s9, s69
s_mov_b32 s10, 2359296
s_mov_b32 s11, 0x20000
s_mov_b32 s20, s66
s_mov_b32 s21, s67
s_mov_b32 s22, 42848256
s_mov_b32 s23, 0x20000
v_lshrrev_b32 v8, 3, v1
s_lshl_b32 s28, s61, 4
v_add_u32 v8, s28, v8
v_mul_u32_u24 v8, 1152, v8
v_and_b32 v9, 7, v1
v_lshl_add_u32 v8, v9, 4, v8
s_mul_i32 s28, s6, 147456
s_add_u32 s29, s28, 9216
s_cmp_lg_u32 s5, 0
s_cbranch_scc1 L_x0
buffer_load_dwordx4 v[216:219], v8, s[8:11], s28 offen offset:0
buffer_load_dwordx4 v[220:223], v8, s[8:11], s29 offen offset:0
buffer_load_dwordx4 v[224:227], v8, s[8:11], s28 offen offset:128
buffer_load_dwordx4 v[228:231], v8, s[8:11], s29 offen offset:128
buffer_load_dwordx4 v[232:235], v8, s[8:11], s28 offen offset:256
buffer_load_dwordx4 v[236:239], v8, s[8:11], s29 offen offset:256
buffer_load_dwordx4 v[240:243], v8, s[8:11], s28 offen offset:384
buffer_load_dwordx4 v[244:247], v8, s[8:11], s29 offen offset:384
buffer_load_dwordx4 v[248:251], v8, s[8:11], s28 offen offset:512
buffer_load_dwordx4 v[252:255], v8, s[8:11], s29 offen offset:512
buffer_load_dwordx4 v[72:75], v8, s[8:11], s28 offen offset:640
buffer_load_dwordx4 v[76:79], v8, s[8:11], s29 offen offset:640
buffer_load_dwordx4 v[80:83], v8, s[8:11], s28 offen offset:768
buffer_load_dwordx4 v[84:87], v8, s[8:11], s29 offen offset:768
buffer_load_dwordx4 v[88:91], v8, s[8:11], s28 offen offset:896
buffer_load_dwordx4 v[92:95], v8, s[8:11], s29 offen offset:896
buffer_load_dwordx4 v[96:99], v8, s[8:11], s28 offen offset:1024
buffer_load_dwordx4 v[100:103], v8, s[8:11], s29 offen offset:1024
L_x0:
s_cmp_ge_u32 s7, 12
s_cbranch_scc1 L_ssm
s_mov_b32 s12, s88
s_mov_b32 s13, s89
s_mov_b32 s14, 5308416
s_mov_b32 s15, 0x20000
s_sub_u32 s16, s92, 4096
s_subb_u32 s17, s93, 0
s_mov_b32 s18, 5312512
s_mov_b32 s19, 0x20000
s_mov_b32 s24, s90
s_mov_b32 s25, s91
s_mov_b32 s26, 9216
s_mov_b32 s27, 0x20000
s_mul_i32 s30, s6, 43
s_lshr_b32 s30, s30, 8
s_mul_i32 s30, s30, 6
s_sub_u32 s56, s6, s30
s_mul_i32 s74, s7, 11
s_lshr_b32 s74, s74, 5
s_mul_i32 s30, s74, 3
s_sub_u32 s71, s7, s30
s_mul_i32 s30, s71, 3
s_add_u32 s57, s6, 9
s_sub_u32 s57, s57, s30
s_cmp_ge_u32 s57, 9
s_cselect_b32 s30, 9, 0
s_sub_u32 s57, s57, s30
s_cmp_ge_u32 s57, 9
s_cselect_b32 s30, 9, 0
s_sub_u32 s57, s57, s30
s_sub_u32 s72, s71, 1
s_cselect_b32 s72, 2, s72
s_getreg_b32 s73, hwreg(HW_REG_XCC_ID, 0, 4)
s_lshl_b32 s73, s73, 8
s_mov_b32 s40, 0
s_mov_b32 s41, 72704
s_mov_b32 s42, 145408
s_mov_b32 s43, 218112
s_mov_b32 s44, 294912
s_mov_b32 s45, 367616
s_mov_b32 s46, 440320
s_mov_b32 s47, 513024
s_mov_b32 s48, 589824
s_mul_i32 s64, s3, 9216
v_bfe_u32 v9, v1, 2, 3
v_lshrrev_b32 v10, 5, v1
v_and_b32 v11, 3, v1
v_lshlrev_b32 v11, 4, v11
v_lshl_add_u32 v10, v10, 6, v11
v_mul_u32_u24 v2, 9216, v9
v_add_u32 v2, v2, v10
s_mul_i32 s30, s3, 663552
s_mul_i32 s31, s7, 768
s_add_u32 s30, s30, s31
v_add_u32 v2, s30, v2
s_lshl_b32 s58, s56, 7
v_add_u32 v3, s58, v2
s_mul_i32 s30, s7, 768
v_lshl_add_u32 v49, v0, 1, s30
v_lshrrev_b32 v9, 5, v1
v_lshlrev_b32 v9, 10, v9
v_bfe_u32 v10, v1, 2, 2
v_lshl_add_u32 v9, v10, 6, v9
v_bfe_u32 v10, v1, 4, 1
v_lshl_add_u32 v9, v10, 5, v9
v_and_b32 v10, 3, v1
v_lshl_add_u32 v9, v10, 3, v9
s_lshl_b32 s30, s5, 9
v_add_u32 v4, s30, v9
v_add_u32 v5, 0x10000, v4
v_add_u32 v6, 0x20000, v4
v_lshrrev_b32 v9, 5, v1
s_lshl_b32 s30, s5, 7
s_add_u32 s30, s30, 155648
v_lshl_add_u32 v7, v9, 4, s30
s_mov_b32 s62, 0x409d30fc
s_mul_i32 s30, s3, 6
s_mul_i32 s34, s7, 442368
s_add_u32 s31, s30, 0
s_lshr_b32 s32, s31, 3
s_add_u32 s32, s32, s56
s_cmp_ge_u32 s32, 6
s_cselect_b32 s33, 6, 0
s_sub_u32 s32, s32, s33
s_lshl_b32 s32, s32, 3
s_and_b32 s31, s31, 7
s_add_u32 s32, s32, s31
s_mul_i32 s32, s32, 9216
s_add_u32 s32, s32, s34
s_add_u32 s50, s32, 4096
s_add_u32 s31, s30, 1
s_lshr_b32 s32, s31, 3
s_add_u32 s32, s32, s56
s_cmp_ge_u32 s32, 6
s_cselect_b32 s33, 6, 0
s_sub_u32 s32, s32, s33
s_lshl_b32 s32, s32, 3
s_and_b32 s31, s31, 7
s_add_u32 s32, s32, s31
s_mul_i32 s32, s32, 9216
s_add_u32 s32, s32, s34
s_add_u32 s51, s32, 3072
s_add_u32 s31, s30, 2
s_lshr_b32 s32, s31, 3
s_add_u32 s32, s32, s56
s_cmp_ge_u32 s32, 6
s_cselect_b32 s33, 6, 0
s_sub_u32 s32, s32, s33
s_lshl_b32 s32, s32, 3
s_and_b32 s31, s31, 7
s_add_u32 s32, s32, s31
s_mul_i32 s32, s32, 9216
s_add_u32 s32, s32, s34
s_add_u32 s52, s32, 2048
s_add_u32 s31, s30, 3
s_lshr_b32 s32, s31, 3
s_add_u32 s32, s32, s56
s_cmp_ge_u32 s32, 6
s_cselect_b32 s33, 6, 0
s_sub_u32 s32, s32, s33
s_lshl_b32 s32, s32, 3
s_and_b32 s31, s31, 7
s_add_u32 s32, s32, s31
s_mul_i32 s32, s32, 9216
s_add_u32 s32, s32, s34
s_add_u32 s53, s32, 1024
s_add_u32 s31, s30, 4
s_lshr_b32 s32, s31, 3
s_add_u32 s32, s32, s56
s_cmp_ge_u32 s32, 6
s_cselect_b32 s33, 6, 0
s_sub_u32 s32, s32, s33
s_lshl_b32 s32, s32, 3
s_and_b32 s31, s31, 7
s_add_u32 s32, s32, s31
s_mul_i32 s32, s32, 9216
s_add_u32 s32, s32, s34
s_add_u32 s54, s32, 4096
s_add_u32 s31, s30, 5
s_lshr_b32 s32, s31, 3
s_add_u32 s32, s32, s56
s_cmp_ge_u32 s32, 6
s_cselect_b32 s33, 6, 0
s_sub_u32 s32, s32, s33
s_lshl_b32 s32, s32, 3
s_and_b32 s31, s31, 7
s_add_u32 s32, s32, s31
s_mul_i32 s32, s32, 9216
s_add_u32 s32, s32, s34
s_add_u32 s55, s32, 3072
s_sub_u32 s30, s3, s56
s_cmp_lt_i32 s30, 0
s_cselect_b32 s31, 6, 0
s_add_u32 s30, s30, s31
s_lshl_b32 s30, s30, 8
s_add_u32 s30, s30, 155648
s_cmp_ge_u32 s3, 6
s_cselect_b32 s30, 157696, s30
v_lshl_add_u32 v50, v1, 2, s30
v_mov_b32 v16, 0
v_mov_b32 v17, 0
v_mov_b32 v18, 0
v_mov_b32 v19, 0
v_lshrrev_b32 v20, 3, v1
s_lshl_b32 s30, s61, 4
s_add_u32 s30, s30, 0
v_add_u32 v20, s30, v20
v_bfe_u32 v21, v20, 1, 3
v_and_b32 v22, 7, v1
v_xor_b32 v21, v21, v22
v_lshlrev_b32 v21, 4, v21
v_lshl_add_u32 v10, v20, 7, v21
v_add_u32 v10, 73728, v10
v_lshrrev_b32 v20, 3, v1
s_lshl_b32 s30, s61, 4
s_add_u32 s30, s30, 8
v_add_u32 v20, s30, v20
v_bfe_u32 v21, v20, 1, 3
v_and_b32 v22, 7, v1
v_xor_b32 v21, v21, v22
v_lshlrev_b32 v21, 4, v21
v_lshl_add_u32 v11, v20, 7, v21
v_add_u32 v11, 73728, v11
v_and_b32 v20, 31, v1
v_bfe_u32 v21, v20, 1, 3
v_lshrrev_b32 v22, 5, v1
v_xor_b32 v21, v21, v22
v_lshlrev_b32 v21, 4, v21
s_lshl_b32 s30, s4, 5
v_add_u32 v20, s30, v20
v_lshl_add_u32 v12, v20, 7, v21
v_add_u32 v12, 73728, v12
v_xor_b32 v13, 32, v12
v_xor_b32 v14, 64, v12
v_xor_b32 v15, 96, v12
s_cmp_eq_u32 s5, 0
s_cbranch_scc1 L_x11
buffer_load_dwordx4 v[216:219], v8, s[8:11], s28 offen offset:0
buffer_load_dwordx4 v[220:223], v8, s[8:11], s29 offen offset:0
buffer_load_dwordx4 v[224:227], v8, s[8:11], s28 offen offset:128
buffer_load_dwordx4 v[228:231], v8, s[8:11], s29 offen offset:128
buffer_load_dwordx4 v[232:235], v8, s[8:11], s28 offen offset:256
buffer_load_dwordx4 v[236:239], v8, s[8:11], s29 offen offset:256
buffer_load_dwordx4 v[240:243], v8, s[8:11], s28 offen offset:384
buffer_load_dwordx4 v[244:247], v8, s[8:11], s29 offen offset:384
buffer_load_dwordx4 v[248:251], v8, s[8:11], s28 offen offset:512
buffer_load_dwordx4 v[252:255], v8, s[8:11], s29 offen offset:512
buffer_load_dwordx4 v[72:75], v8, s[8:11], s28 offen offset:640
buffer_load_dwordx4 v[76:79], v8, s[8:11], s29 offen offset:640
buffer_load_dwordx4 v[80:83], v8, s[8:11], s28 offen offset:768
buffer_load_dwordx4 v[84:87], v8, s[8:11], s29 offen offset:768
buffer_load_dwordx4 v[88:91], v8, s[8:11], s28 offen offset:896
buffer_load_dwordx4 v[92:95], v8, s[8:11], s29 offen offset:896
buffer_load_dwordx4 v[96:99], v8, s[8:11], s28 offen offset:1024
buffer_load_dwordx4 v[100:103], v8, s[8:11], s29 offen offset:1024
L_x11:
s_waitcnt vmcnt(16)
v_dot2c_f32_bf16 v16, s63, v216
v_dot2c_f32_bf16 v18, v216, v216
v_dot2c_f32_bf16 v17, s63, v220
v_dot2c_f32_bf16 v19, v220, v220
v_dot2c_f32_bf16 v16, s63, v217
v_dot2c_f32_bf16 v18, v217, v217
v_dot2c_f32_bf16 v17, s63, v221
v_dot2c_f32_bf16 v19, v221, v221
v_dot2c_f32_bf16 v16, s63, v218
v_dot2c_f32_bf16 v18, v218, v218
v_dot2c_f32_bf16 v17, s63, v222
v_dot2c_f32_bf16 v19, v222, v222
v_dot2c_f32_bf16 v16, s63, v219
v_dot2c_f32_bf16 v18, v219, v219
v_dot2c_f32_bf16 v17, s63, v223
v_dot2c_f32_bf16 v19, v223, v223
s_waitcnt vmcnt(14)
v_dot2c_f32_bf16 v16, s63, v224
v_dot2c_f32_bf16 v18, v224, v224
v_dot2c_f32_bf16 v17, s63, v228
v_dot2c_f32_bf16 v19, v228, v228
v_dot2c_f32_bf16 v16, s63, v225
v_dot2c_f32_bf16 v18, v225, v225
v_dot2c_f32_bf16 v17, s63, v229
v_dot2c_f32_bf16 v19, v229, v229
v_dot2c_f32_bf16 v16, s63, v226
v_dot2c_f32_bf16 v18, v226, v226
v_dot2c_f32_bf16 v17, s63, v230
v_dot2c_f32_bf16 v19, v230, v230
v_dot2c_f32_bf16 v16, s63, v227
v_dot2c_f32_bf16 v18, v227, v227
v_dot2c_f32_bf16 v17, s63, v231
v_dot2c_f32_bf16 v19, v231, v231
s_waitcnt vmcnt(12)
v_dot2c_f32_bf16 v16, s63, v232
v_dot2c_f32_bf16 v18, v232, v232
v_dot2c_f32_bf16 v17, s63, v236
v_dot2c_f32_bf16 v19, v236, v236
v_dot2c_f32_bf16 v16, s63, v233
v_dot2c_f32_bf16 v18, v233, v233
v_dot2c_f32_bf16 v17, s63, v237
v_dot2c_f32_bf16 v19, v237, v237
v_dot2c_f32_bf16 v16, s63, v234
v_dot2c_f32_bf16 v18, v234, v234
v_dot2c_f32_bf16 v17, s63, v238
v_dot2c_f32_bf16 v19, v238, v238
v_dot2c_f32_bf16 v16, s63, v235
v_dot2c_f32_bf16 v18, v235, v235
v_dot2c_f32_bf16 v17, s63, v239
v_dot2c_f32_bf16 v19, v239, v239
s_waitcnt vmcnt(10)
v_dot2c_f32_bf16 v16, s63, v240
v_dot2c_f32_bf16 v18, v240, v240
v_dot2c_f32_bf16 v17, s63, v244
v_dot2c_f32_bf16 v19, v244, v244
v_dot2c_f32_bf16 v16, s63, v241
v_dot2c_f32_bf16 v18, v241, v241
v_dot2c_f32_bf16 v17, s63, v245
v_dot2c_f32_bf16 v19, v245, v245
v_dot2c_f32_bf16 v16, s63, v242
v_dot2c_f32_bf16 v18, v242, v242
v_dot2c_f32_bf16 v17, s63, v246
v_dot2c_f32_bf16 v19, v246, v246
v_dot2c_f32_bf16 v16, s63, v243
v_dot2c_f32_bf16 v18, v243, v243
v_dot2c_f32_bf16 v17, s63, v247
v_dot2c_f32_bf16 v19, v247, v247
s_waitcnt vmcnt(8)
v_dot2c_f32_bf16 v16, s63, v248
v_dot2c_f32_bf16 v18, v248, v248
v_dot2c_f32_bf16 v17, s63, v252
v_dot2c_f32_bf16 v19, v252, v252
v_dot2c_f32_bf16 v16, s63, v249
v_dot2c_f32_bf16 v18, v249, v249
v_dot2c_f32_bf16 v17, s63, v253
v_dot2c_f32_bf16 v19, v253, v253
v_dot2c_f32_bf16 v16, s63, v250
v_dot2c_f32_bf16 v18, v250, v250
v_dot2c_f32_bf16 v17, s63, v254
v_dot2c_f32_bf16 v19, v254, v254
v_dot2c_f32_bf16 v16, s63, v251
v_dot2c_f32_bf16 v18, v251, v251
v_dot2c_f32_bf16 v17, s63, v255
v_dot2c_f32_bf16 v19, v255, v255
s_waitcnt vmcnt(6)
v_dot2c_f32_bf16 v16, s63, v72
v_dot2c_f32_bf16 v18, v72, v72
v_dot2c_f32_bf16 v17, s63, v76
v_dot2c_f32_bf16 v19, v76, v76
v_dot2c_f32_bf16 v16, s63, v73
v_dot2c_f32_bf16 v18, v73, v73
v_dot2c_f32_bf16 v17, s63, v77
v_dot2c_f32_bf16 v19, v77, v77
v_dot2c_f32_bf16 v16, s63, v74
v_dot2c_f32_bf16 v18, v74, v74
v_dot2c_f32_bf16 v17, s63, v78
v_dot2c_f32_bf16 v19, v78, v78
v_dot2c_f32_bf16 v16, s63, v75
v_dot2c_f32_bf16 v18, v75, v75
v_dot2c_f32_bf16 v17, s63, v79
v_dot2c_f32_bf16 v19, v79, v79
s_waitcnt vmcnt(4)
v_dot2c_f32_bf16 v16, s63, v80
v_dot2c_f32_bf16 v18, v80, v80
v_dot2c_f32_bf16 v17, s63, v84
v_dot2c_f32_bf16 v19, v84, v84
v_dot2c_f32_bf16 v16, s63, v81
v_dot2c_f32_bf16 v18, v81, v81
v_dot2c_f32_bf16 v17, s63, v85
v_dot2c_f32_bf16 v19, v85, v85
v_dot2c_f32_bf16 v16, s63, v82
v_dot2c_f32_bf16 v18, v82, v82
v_dot2c_f32_bf16 v17, s63, v86
v_dot2c_f32_bf16 v19, v86, v86
v_dot2c_f32_bf16 v16, s63, v83
v_dot2c_f32_bf16 v18, v83, v83
v_dot2c_f32_bf16 v17, s63, v87
v_dot2c_f32_bf16 v19, v87, v87
s_waitcnt vmcnt(2)
v_dot2c_f32_bf16 v16, s63, v88
v_dot2c_f32_bf16 v18, v88, v88
v_dot2c_f32_bf16 v17, s63, v92
v_dot2c_f32_bf16 v19, v92, v92
v_dot2c_f32_bf16 v16, s63, v89
v_dot2c_f32_bf16 v18, v89, v89
v_dot2c_f32_bf16 v17, s63, v93
v_dot2c_f32_bf16 v19, v93, v93
v_dot2c_f32_bf16 v16, s63, v90
v_dot2c_f32_bf16 v18, v90, v90
v_dot2c_f32_bf16 v17, s63, v94
v_dot2c_f32_bf16 v19, v94, v94
v_dot2c_f32_bf16 v16, s63, v91
v_dot2c_f32_bf16 v18, v91, v91
v_dot2c_f32_bf16 v17, s63, v95
v_dot2c_f32_bf16 v19, v95, v95
s_waitcnt vmcnt(0)
v_dot2c_f32_bf16 v16, s63, v96
v_dot2c_f32_bf16 v18, v96, v96
v_dot2c_f32_bf16 v17, s63, v100
v_dot2c_f32_bf16 v19, v100, v100
v_dot2c_f32_bf16 v16, s63, v97
v_dot2c_f32_bf16 v18, v97, v97
v_dot2c_f32_bf16 v17, s63, v101
v_dot2c_f32_bf16 v19, v101, v101
v_dot2c_f32_bf16 v16, s63, v98
v_dot2c_f32_bf16 v18, v98, v98
v_dot2c_f32_bf16 v17, s63, v102
v_dot2c_f32_bf16 v19, v102, v102
v_dot2c_f32_bf16 v16, s63, v99
v_dot2c_f32_bf16 v18, v99, v99
v_dot2c_f32_bf16 v17, s63, v103
v_dot2c_f32_bf16 v19, v103, v103
s_nop 2
v_add_f32_dpp v16, v16, v16 quad_perm:[1,0,3,2] row_mask:0xf bank_mask:0xf
v_add_f32_dpp v17, v17, v17 quad_perm:[1,0,3,2] row_mask:0xf bank_mask:0xf
v_add_f32_dpp v18, v18, v18 quad_perm:[1,0,3,2] row_mask:0xf bank_mask:0xf
v_add_f32_dpp v19, v19, v19 quad_perm:[1,0,3,2] row_mask:0xf bank_mask:0xf
v_add_f32_dpp v16, v16, v16 quad_perm:[2,3,0,1] row_mask:0xf bank_mask:0xf
v_add_f32_dpp v17, v17, v17 quad_perm:[2,3,0,1] row_mask:0xf bank_mask:0xf
v_add_f32_dpp v18, v18, v18 quad_perm:[2,3,0,1] row_mask:0xf bank_mask:0xf
v_add_f32_dpp v19, v19, v19 quad_perm:[2,3,0,1] row_mask:0xf bank_mask:0xf
v_add_f32_dpp v16, v16, v16 row_half_mirror row_mask:0xf bank_mask:0xf
v_add_f32_dpp v17, v17, v17 row_half_mirror row_mask:0xf bank_mask:0xf
v_add_f32_dpp v18, v18, v18 row_half_mirror row_mask:0xf bank_mask:0xf
v_add_f32_dpp v19, v19, v19 row_half_mirror row_mask:0xf bank_mask:0xf
v_mul_f32 v20, 0x3ae38e39, v16
v_mul_f32 v21, 0x3ae38e39, v17
v_mul_f32 v22, 0x3ae38e39, v18
v_mul_f32 v23, 0x3ae38e39, v19
v_fma_f32 v22, -v20, v20, v22
v_fma_f32 v23, -v21, v21, v23
v_max_f32 v22, 0, v22
v_max_f32 v23, 0, v23
v_cvt_pk_bf16_f32 v24, v20, v20
v_cvt_pk_bf16_f32 v25, v21, v21
v_and_b32 v24, 0xffff0000, v24
v_and_b32 v25, 0xffff0000, v25
v_cvt_pk_bf16_f32 v26, v22, v22
v_cvt_pk_bf16_f32 v27, v23, v23
v_and_b32 v26, 0xffff0000, v26
v_and_b32 v27, 0xffff0000, v27
v_add_f32 v26, 0x3727c5ac, v26
v_add_f32 v27, 0x3727c5ac, v27
v_cvt_pk_bf16_f32 v26, v26, v26
v_cvt_pk_bf16_f32 v27, v27, v27
v_and_b32 v26, 0xffff0000, v26
v_and_b32 v27, 0xffff0000, v27
v_sqrt_f32 v26, v26
v_sqrt_f32 v27, v27
v_cvt_pk_bf16_f32 v26, v26, v26
v_cvt_pk_bf16_f32 v27, v27, v27
v_and_b32 v26, 0xffff0000, v26
v_and_b32 v27, 0xffff0000, v27
v_rcp_f32 v28, v26
v_rcp_f32 v29, v27
v_lshrrev_b32 v34, 3, v1
s_lshl_b32 s31, s61, 4
v_add_u32 v34, s31, v34
v_lshlrev_b32 v34, 3, v34
v_mov_b32 v36, v24
v_mov_b32 v38, v25
v_mov_b32 v37, v28
v_mov_b32 v39, v29
s_lshl_b32 s30, s2, 10
s_add_u32 s30, s30, 37748736
buffer_store_dwordx2 v[36:37], v34, s[20:23], s30 offen
buffer_store_dwordx2 v[38:39], v34, s[20:23], s30 offen offset:64
s_nop 1
v_sub_f32 v30, v20, v24
v_sub_f32 v31, v21, v25
v_mul_f32 v30, v30, v28
v_mul_f32 v31, v31, v29
v_cvt_pk_bf16_f32 v30, v30, v30
v_cvt_pk_bf16_f32 v31, v31, v31
v_and_b32 v30, 0xffff0000, v30
v_and_b32 v31, 0xffff0000, v31
v_mul_f32 v32, v28, v28
v_mul_f32 v33, v29, v29
v_mul_f32 v32, v32, v22
v_mul_f32 v33, v33, v23
v_cvt_pk_bf16_f32 v32, v32, v32
v_cvt_pk_bf16_f32 v33, v33, v33
v_and_b32 v32, 0xffff0000, v32
v_and_b32 v33, 0xffff0000, v33
v_add_f32 v32, 0x3727c5ac, v32
v_add_f32 v33, 0x3727c5ac, v33
v_cvt_pk_bf16_f32 v32, v32, v32
v_cvt_pk_bf16_f32 v33, v33, v33
v_and_b32 v32, 0xffff0000, v32
v_and_b32 v33, 0xffff0000, v33
v_sqrt_f32 v32, v32
v_sqrt_f32 v33, v33
v_cvt_pk_bf16_f32 v32, v32, v32
v_cvt_pk_bf16_f32 v33, v33, v33
v_and_b32 v32, 0xffff0000, v32
v_and_b32 v33, 0xffff0000, v33
v_rcp_f32 v32, v32
v_rcp_f32 v33, v33
v_fma_f32 v24, v30, v26, v24
v_fma_f32 v25, v31, v27, v25
v_mul_f32 v28, v28, v32
v_mul_f32 v29, v29, v33
v_mul_f32 v28, 0xbeeff558, v28
v_mul_f32 v29, 0xbeeff558, v29
v_cvt_pk_bf16_f32 v34, v28, v28
v_cvt_pk_bf16_f32 v35, v29, v29
v_and_b32 v34, 0xffff0000, v34
v_and_b32 v35, 0xffff0000, v35
v_lshrrev_b32 v36, 16, v34
v_lshrrev_b32 v37, 16, v35
v_mul_f32 v38, v34, v24
v_mul_f32 v39, v35, v25
v_sub_f32 v38, 0, v38
v_sub_f32 v39, 0, v39
v_dot2_f32_bf16 v40, v216, v36, v38
v_dot2_f32_bf16 v41, v216, v34, v38
v_dot2_f32_bf16 v42, v217, v36, v38
v_dot2_f32_bf16 v43, v217, v34, v38
v_dot2_f32_bf16 v44, v218, v36, v38
v_dot2_f32_bf16 v45, v218, v34, v38
v_dot2_f32_bf16 v46, v219, v36, v38
v_dot2_f32_bf16 v47, v219, v34, v38
s_nop 0
v_cvt_pk_bf16_f32 v216, v40, v41
v_cvt_pk_bf16_f32 v217, v42, v43
v_cvt_pk_bf16_f32 v218, v44, v45
s_nop 0
v_cvt_pk_bf16_f32 v219, v46, v47
ds_write_b128 v10, v[216:219] offset:0
s_add_u32 m0, s64, 0
s_nop 0
buffer_load_dwordx4 v3, s[12:15], s40 offen offset:0 lds
v_dot2_f32_bf16 v40, v220, v37, v39
v_dot2_f32_bf16 v41, v220, v35, v39
v_dot2_f32_bf16 v42, v221, v37, v39
v_dot2_f32_bf16 v43, v221, v35, v39
v_dot2_f32_bf16 v44, v222, v37, v39
v_dot2_f32_bf16 v45, v222, v35, v39
v_dot2_f32_bf16 v46, v223, v37, v39
v_dot2_f32_bf16 v47, v223, v35, v39
s_nop 0
v_cvt_pk_bf16_f32 v220, v40, v41
v_cvt_pk_bf16_f32 v221, v42, v43
v_cvt_pk_bf16_f32 v222, v44, v45
s_nop 0
v_cvt_pk_bf16_f32 v223, v46, v47
ds_write_b128 v11, v[220:223] offset:0
buffer_load_dwordx4 v3, s[12:15], s41 offen offset:1024 lds
v_dot2_f32_bf16 v40, v224, v36, v38
v_dot2_f32_bf16 v41, v224, v34, v38
v_dot2_f32_bf16 v42, v225, v36, v38
v_dot2_f32_bf16 v43, v225, v34, v38
v_dot2_f32_bf16 v44, v226, v36, v38
v_dot2_f32_bf16 v45, v226, v34, v38
v_dot2_f32_bf16 v46, v227, v36, v38
v_dot2_f32_bf16 v47, v227, v34, v38
s_nop 0
v_cvt_pk_bf16_f32 v224, v40, v41
v_cvt_pk_bf16_f32 v225, v42, v43
v_cvt_pk_bf16_f32 v226, v44, v45
s_nop 0
v_cvt_pk_bf16_f32 v227, v46, v47
ds_write_b128 v10, v[224:227] offset:16384
buffer_load_dwordx4 v3, s[12:15], s42 offen offset:2048 lds
v_dot2_f32_bf16 v40, v228, v37, v39
v_dot2_f32_bf16 v41, v228, v35, v39
v_dot2_f32_bf16 v42, v229, v37, v39
v_dot2_f32_bf16 v43, v229, v35, v39
v_dot2_f32_bf16 v44, v230, v37, v39
v_dot2_f32_bf16 v45, v230, v35, v39
v_dot2_f32_bf16 v46, v231, v37, v39
v_dot2_f32_bf16 v47, v231, v35, v39
s_nop 0
v_cvt_pk_bf16_f32 v228, v40, v41
v_cvt_pk_bf16_f32 v229, v42, v43
v_cvt_pk_bf16_f32 v230, v44, v45
s_nop 0
v_cvt_pk_bf16_f32 v231, v46, v47
ds_write_b128 v11, v[228:231] offset:16384
buffer_load_dwordx4 v3, s[12:15], s43 offen offset:3072 lds
v_dot2_f32_bf16 v40, v232, v36, v38
v_dot2_f32_bf16 v41, v232, v34, v38
v_dot2_f32_bf16 v42, v233, v36, v38
v_dot2_f32_bf16 v43, v233, v34, v38
v_dot2_f32_bf16 v44, v234, v36, v38
v_dot2_f32_bf16 v45, v234, v34, v38
v_dot2_f32_bf16 v46, v235, v36, v38
v_dot2_f32_bf16 v47, v235, v34, v38
s_nop 0
v_cvt_pk_bf16_f32 v232, v40, v41
v_cvt_pk_bf16_f32 v233, v42, v43
v_cvt_pk_bf16_f32 v234, v44, v45
s_nop 0
v_cvt_pk_bf16_f32 v235, v46, v47
ds_write_b128 v10, v[232:235] offset:32768
s_add_u32 m0, s64, 4096
s_nop 0
buffer_load_dwordx4 v3, s[12:15], s44 offen offset:0 lds
v_dot2_f32_bf16 v40, v236, v37, v39
v_dot2_f32_bf16 v41, v236, v35, v39
v_dot2_f32_bf16 v42, v237, v37, v39
v_dot2_f32_bf16 v43, v237, v35, v39
v_dot2_f32_bf16 v44, v238, v37, v39
v_dot2_f32_bf16 v45, v238, v35, v39
v_dot2_f32_bf16 v46, v239, v37, v39
v_dot2_f32_bf16 v47, v239, v35, v39
s_nop 0
v_cvt_pk_bf16_f32 v236, v40, v41
v_cvt_pk_bf16_f32 v237, v42, v43
v_cvt_pk_bf16_f32 v238, v44, v45
s_nop 0
v_cvt_pk_bf16_f32 v239, v46, v47
ds_write_b128 v11, v[236:239] offset:32768
buffer_load_dwordx4 v3, s[12:15], s45 offen offset:1024 lds
v_dot2_f32_bf16 v40, v240, v36, v38
v_dot2_f32_bf16 v41, v240, v34, v38
v_dot2_f32_bf16 v42, v241, v36, v38
v_dot2_f32_bf16 v43, v241, v34, v38
v_dot2_f32_bf16 v44, v242, v36, v38
v_dot2_f32_bf16 v45, v242, v34, v38
v_dot2_f32_bf16 v46, v243, v36, v38
v_dot2_f32_bf16 v47, v243, v34, v38
s_nop 0
v_cvt_pk_bf16_f32 v240, v40, v41
v_cvt_pk_bf16_f32 v241, v42, v43
v_cvt_pk_bf16_f32 v242, v44, v45
s_nop 0
v_cvt_pk_bf16_f32 v243, v46, v47
ds_write_b128 v10, v[240:243] offset:49152
buffer_load_dwordx4 v3, s[12:15], s46 offen offset:2048 lds
v_dot2_f32_bf16 v40, v244, v37, v39
v_dot2_f32_bf16 v41, v244, v35, v39
v_dot2_f32_bf16 v42, v245, v37, v39
v_dot2_f32_bf16 v43, v245, v35, v39
v_dot2_f32_bf16 v44, v246, v37, v39
v_dot2_f32_bf16 v45, v246, v35, v39
v_dot2_f32_bf16 v46, v247, v37, v39
v_dot2_f32_bf16 v47, v247, v35, v39
s_nop 0
v_cvt_pk_bf16_f32 v244, v40, v41
v_cvt_pk_bf16_f32 v245, v42, v43
v_cvt_pk_bf16_f32 v246, v44, v45
s_nop 0
v_cvt_pk_bf16_f32 v247, v46, v47
ds_write_b128 v11, v[244:247] offset:49152
buffer_load_dwordx4 v3, s[12:15], s47 offen offset:3072 lds
v_dot2_f32_bf16 v40, v248, v36, v38
v_dot2_f32_bf16 v41, v248, v34, v38
v_dot2_f32_bf16 v42, v249, v36, v38
v_dot2_f32_bf16 v43, v249, v34, v38
v_dot2_f32_bf16 v44, v250, v36, v38
v_dot2_f32_bf16 v45, v250, v34, v38
v_dot2_f32_bf16 v46, v251, v36, v38
v_dot2_f32_bf16 v47, v251, v34, v38
s_nop 0
v_cvt_pk_bf16_f32 v248, v40, v41
v_cvt_pk_bf16_f32 v249, v42, v43
v_cvt_pk_bf16_f32 v250, v44, v45
s_nop 0
v_cvt_pk_bf16_f32 v251, v46, v47
v_add_u32 v48, 0x10000, v10
ds_write_b128 v48, v[248:251]
s_add_u32 m0, s64, 8192
s_nop 0
buffer_load_dwordx4 v3, s[12:15], s48 offen offset:0 lds
v_dot2_f32_bf16 v40, v252, v37, v39
v_dot2_f32_bf16 v41, v252, v35, v39
v_dot2_f32_bf16 v42, v253, v37, v39
v_dot2_f32_bf16 v43, v253, v35, v39
v_dot2_f32_bf16 v44, v254, v37, v39
v_dot2_f32_bf16 v45, v254, v35, v39
v_dot2_f32_bf16 v46, v255, v37, v39
v_dot2_f32_bf16 v47, v255, v35, v39
s_nop 0
v_cvt_pk_bf16_f32 v252, v40, v41
v_cvt_pk_bf16_f32 v253, v42, v43
v_cvt_pk_bf16_f32 v254, v44, v45
s_nop 0
v_cvt_pk_bf16_f32 v255, v46, v47
v_add_u32 v48, 0x10000, v11
ds_write_b128 v48, v[252:255]
buffer_load_ushort v49, v49, s[24:27], 0 offen
s_waitcnt lgkmcnt(0)
s_barrier
ds_read_b128 v[112:115], v12 offset:0
ds_read_b128 v[116:119], v13 offset:0
ds_read_b128 v[120:123], v14 offset:0
ds_read_b128 v[124:127], v15 offset:0
ds_read_b128 v[128:131], v12 offset:16384
ds_read_b128 v[132:135], v13 offset:16384
ds_read_b128 v[136:139], v14 offset:16384
ds_read_b128 v[140:143], v15 offset:16384
ds_read_b128 v[144:147], v12 offset:32768
ds_read_b128 v[148:151], v13 offset:32768
ds_read_b128 v[152:155], v14 offset:32768
ds_read_b128 v[156:159], v15 offset:32768
ds_read_b128 v[160:163], v12 offset:49152
ds_read_b128 v[164:167], v13 offset:49152
ds_read_b128 v[168:171], v14 offset:49152
ds_read_b128 v[172:175], v15 offset:49152
v_add_u32 v48, 0x10000, v12
ds_read_b128 v[176:179], v48
v_add_u32 v48, 0x10000, v13
ds_read_b128 v[180:183], v48
v_add_u32 v48, 0x10000, v14
ds_read_b128 v[184:187], v48
v_add_u32 v48, 0x10000, v15
ds_read_b128 v[188:191], v48
v_dot2_f32_bf16 v40, v72, v36, v38
v_dot2_f32_bf16 v41, v72, v34, v38
v_dot2_f32_bf16 v42, v73, v36, v38
v_dot2_f32_bf16 v43, v73, v34, v38
v_dot2_f32_bf16 v44, v74, v36, v38
v_dot2_f32_bf16 v45, v74, v34, v38
v_dot2_f32_bf16 v46, v75, v36, v38
v_dot2_f32_bf16 v47, v75, v34, v38
s_nop 0
v_cvt_pk_bf16_f32 v72, v40, v41
v_cvt_pk_bf16_f32 v73, v42, v43
v_cvt_pk_bf16_f32 v74, v44, v45
s_nop 0
v_cvt_pk_bf16_f32 v75, v46, v47
v_dot2_f32_bf16 v40, v76, v37, v39
v_dot2_f32_bf16 v41, v76, v35, v39
v_dot2_f32_bf16 v42, v77, v37, v39
v_dot2_f32_bf16 v43, v77, v35, v39
v_dot2_f32_bf16 v44, v78, v37, v39
v_dot2_f32_bf16 v45, v78, v35, v39
v_dot2_f32_bf16 v46, v79, v37, v39
v_dot2_f32_bf16 v47, v79, v35, v39
s_nop 0
v_cvt_pk_bf16_f32 v76, v40, v41
v_cvt_pk_bf16_f32 v77, v42, v43
v_cvt_pk_bf16_f32 v78, v44, v45
s_nop 0
v_cvt_pk_bf16_f32 v79, v46, v47
v_dot2_f32_bf16 v40, v80, v36, v38
v_dot2_f32_bf16 v41, v80, v34, v38
v_dot2_f32_bf16 v42, v81, v36, v38
v_dot2_f32_bf16 v43, v81, v34, v38
v_dot2_f32_bf16 v44, v82, v36, v38
v_dot2_f32_bf16 v45, v82, v34, v38
v_dot2_f32_bf16 v46, v83, v36, v38
v_dot2_f32_bf16 v47, v83, v34, v38
s_nop 0
v_cvt_pk_bf16_f32 v80, v40, v41
v_cvt_pk_bf16_f32 v81, v42, v43
v_cvt_pk_bf16_f32 v82, v44, v45
s_nop 0
v_cvt_pk_bf16_f32 v83, v46, v47
v_dot2_f32_bf16 v40, v84, v37, v39
v_dot2_f32_bf16 v41, v84, v35, v39
v_dot2_f32_bf16 v42, v85, v37, v39
v_dot2_f32_bf16 v43, v85, v35, v39
v_dot2_f32_bf16 v44, v86, v37, v39
v_dot2_f32_bf16 v45, v86, v35, v39
v_dot2_f32_bf16 v46, v87, v37, v39
v_dot2_f32_bf16 v47, v87, v35, v39
s_nop 0
v_cvt_pk_bf16_f32 v84, v40, v41
v_cvt_pk_bf16_f32 v85, v42, v43
v_cvt_pk_bf16_f32 v86, v44, v45
s_nop 0
v_cvt_pk_bf16_f32 v87, v46, v47
v_dot2_f32_bf16 v40, v88, v36, v38
v_dot2_f32_bf16 v41, v88, v34, v38
v_dot2_f32_bf16 v42, v89, v36, v38
v_dot2_f32_bf16 v43, v89, v34, v38
v_dot2_f32_bf16 v44, v90, v36, v38
v_dot2_f32_bf16 v45, v90, v34, v38
v_dot2_f32_bf16 v46, v91, v36, v38
v_dot2_f32_bf16 v47, v91, v34, v38
s_nop 0
v_cvt_pk_bf16_f32 v88, v40, v41
v_cvt_pk_bf16_f32 v89, v42, v43
v_cvt_pk_bf16_f32 v90, v44, v45
s_nop 0
v_cvt_pk_bf16_f32 v91, v46, v47
v_dot2_f32_bf16 v40, v92, v37, v39
v_dot2_f32_bf16 v41, v92, v35, v39
v_dot2_f32_bf16 v42, v93, v37, v39
v_dot2_f32_bf16 v43, v93, v35, v39
v_dot2_f32_bf16 v44, v94, v37, v39
v_dot2_f32_bf16 v45, v94, v35, v39
v_dot2_f32_bf16 v46, v95, v37, v39
v_dot2_f32_bf16 v47, v95, v35, v39
s_nop 0
v_cvt_pk_bf16_f32 v92, v40, v41
v_cvt_pk_bf16_f32 v93, v42, v43
v_cvt_pk_bf16_f32 v94, v44, v45
s_nop 0
v_cvt_pk_bf16_f32 v95, v46, v47
v_dot2_f32_bf16 v40, v96, v36, v38
v_dot2_f32_bf16 v41, v96, v34, v38
v_dot2_f32_bf16 v42, v97, v36, v38
v_dot2_f32_bf16 v43, v97, v34, v38
v_dot2_f32_bf16 v44, v98, v36, v38
v_dot2_f32_bf16 v45, v98, v34, v38
v_dot2_f32_bf16 v46, v99, v36, v38
v_dot2_f32_bf16 v47, v99, v34, v38
s_nop 0
v_cvt_pk_bf16_f32 v96, v40, v41
v_cvt_pk_bf16_f32 v97, v42, v43
v_cvt_pk_bf16_f32 v98, v44, v45
s_nop 0
v_cvt_pk_bf16_f32 v99, v46, v47
v_dot2_f32_bf16 v40, v100, v37, v39
v_dot2_f32_bf16 v41, v100, v35, v39
v_dot2_f32_bf16 v42, v101, v37, v39
v_dot2_f32_bf16 v43, v101, v35, v39
v_dot2_f32_bf16 v44, v102, v37, v39
v_dot2_f32_bf16 v45, v102, v35, v39
v_dot2_f32_bf16 v46, v103, v37, v39
v_dot2_f32_bf16 v47, v103, v35, v39
s_nop 0
v_cvt_pk_bf16_f32 v100, v40, v41
v_cvt_pk_bf16_f32 v101, v42, v43
v_cvt_pk_bf16_f32 v102, v44, v45
s_nop 0
v_cvt_pk_bf16_f32 v103, v46, v47
s_waitcnt vmcnt(0)
v_lshlrev_b32 v49, 16, v49
v_mul_f32 v49, 0xbeeff558, v49
ds_write_b32 v50, v49
s_mov_b32 s24, s98
s_mov_b32 s25, s99
s_mov_b32 s26, 256
s_mov_b32 s27, 0x20000
s_lshl_b32 s28, s6, 3
s_add_u32 s28, s28, s3
s_mul_i32 s39, s28, 4352
s_add_u32 s39, s39, 38092800
s_lshl_b32 s28, s74, 7
s_add_u32 s28, s28, 128
s_add_u32 s70, s28, s39
s_lshl_b32 s71, s71, 2
s_add_u32 s71, s71, s70
s_lshl_b32 s72, s72, 2
s_add_u32 s72, s72, s70
v_mov_b32 v9, s73
s_mov_b64 exec, 1
buffer_store_dword v9, off, s[20:23], s71 sc0 sc1
s_mov_b64 exec, -1
s_add_u32 s58, s58, 128
s_cmp_ge_u32 s58, 768
s_cselect_b32 s58, 0, s58
v_add_u32 v3, s58, v2
s_waitcnt lgkmcnt(0)
s_barrier
ds_write_b128 v10, v[88:91] offset:32768
ds_write_b128 v11, v[92:95] offset:32768
ds_write_b128 v10, v[96:99] offset:49152
ds_write_b128 v11, v[100:103] offset:49152
ds_read_b128 v[16:19], v7 offset:0
ds_read_b128 v[20:23], v7 offset:32
ds_read_b128 v[24:27], v7 offset:64
ds_read_b128 v[28:31], v7 offset:96
ds_read_b64_tr_b16 v[48:49], v4 offset:0
ds_read_b64_tr_b16 v[50:51], v4 offset:256
ds_read_b64_tr_b16 v[52:53], v4 offset:2048
ds_read_b64_tr_b16 v[54:55], v4 offset:2304
ds_read_b64_tr_b16 v[56:57], v4 offset:4096
ds_read_b64_tr_b16 v[58:59], v4 offset:4352
s_waitcnt lgkmcnt(4)
v_mfma_f32_32x32x16_bf16 v[16:31], v[48:51], v[112:115], v[16:31]
ds_read_b64_tr_b16 v[60:61], v4 offset:6144
ds_read_b64_tr_b16 v[62:63], v4 offset:6400
ds_write_b128 v10, v[72:75] offset:0
ds_write_b128 v11, v[76:79] offset:0
s_waitcnt lgkmcnt(6)
v_mfma_f32_32x32x16_bf16 v[16:31], v[52:55], v[116:119], v[16:31]
ds_read_b64_tr_b16 v[48:49], v4 offset:8192
ds_read_b64_tr_b16 v[50:51], v4 offset:8448
ds_write_b128 v10, v[80:83] offset:16384
ds_write_b128 v11, v[84:87] offset:16384
s_waitcnt lgkmcnt(8)
v_mfma_f32_32x32x16_bf16 v[16:31], v[56:59], v[120:123], v[16:31]
ds_read_b64_tr_b16 v[52:53], v4 offset:10240
ds_read_b64_tr_b16 v[54:55], v4 offset:10496
s_waitcnt lgkmcnt(8)
v_mfma_f32_32x32x16_bf16 v[16:31], v[60:63], v[124:127], v[16:31]
s_waitcnt lgkmcnt(2)
s_barrier
ds_read_b64_tr_b16 v[56:57], v4 offset:12288
ds_read_b64_tr_b16 v[58:59], v4 offset:12544
ds_read_b128 v[192:195], v12 offset:0
ds_read_b128 v[196:199], v13 offset:0
ds_read_b128 v[200:203], v14 offset:0
ds_read_b128 v[204:207], v15 offset:0
ds_read_b128 v[208:211], v12 offset:16384
ds_read_b128 v[212:215], v13 offset:16384
v_mfma_f32_32x32x16_bf16 v[16:31], v[48:51], v[128:131], v[16:31]
ds_read_b64_tr_b16 v[60:61], v4 offset:14336
ds_read_b64_tr_b16 v[62:63], v4 offset:14592
ds_read_b128 v[216:219], v14 offset:16384
ds_read_b128 v[220:223], v15 offset:16384
ds_read_b128 v[224:227], v12 offset:32768
ds_read_b128 v[228:231], v13 offset:32768
ds_read_b128 v[232:235], v14 offset:32768
ds_read_b128 v[236:239], v15 offset:32768
s_waitcnt lgkmcnt(15)
v_mfma_f32_32x32x16_bf16 v[16:31], v[52:55], v[132:135], v[16:31]
ds_read_b64_tr_b16 v[48:49], v4 offset:16384
ds_read_b64_tr_b16 v[50:51], v4 offset:16640
ds_read_b128 v[240:243], v12 offset:49152
ds_read_b128 v[244:247], v13 offset:49152
ds_read_b128 v[248:251], v14 offset:49152
ds_read_b128 v[252:255], v15 offset:49152
s_waitcnt lgkmcnt(15)
v_mfma_f32_32x32x16_bf16 v[16:31], v[56:59], v[136:139], v[16:31]
ds_read_b64_tr_b16 v[52:53], v4 offset:18432
ds_read_b64_tr_b16 v[54:55], v4 offset:18688
s_waitcnt lgkmcnt(14)
v_mfma_f32_32x32x16_bf16 v[16:31], v[60:63], v[140:143], v[16:31]
s_waitcnt lgkmcnt(2)
s_barrier
ds_read_b64_tr_b16 v[56:57], v4 offset:20480
ds_read_b64_tr_b16 v[58:59], v4 offset:20736
s_add_u32 m0, s64, 73728
s_nop 0
buffer_load_dwordx4 v3, s[12:15], s40 offen offset:0 lds
v_mfma_f32_32x32x16_bf16 v[16:31], v[48:51], v[144:147], v[16:31]
ds_read_b64_tr_b16 v[60:61], v4 offset:22528
ds_read_b64_tr_b16 v[62:63], v4 offset:22784
buffer_load_dwordx4 v3, s[12:15], s41 offen offset:1024 lds
s_waitcnt lgkmcnt(4)
v_mfma_f32_32x32x16_bf16 v[16:31], v[52:55], v[148:151], v[16:31]
ds_read_b64_tr_b16 v[48:49], v4 offset:24576
ds_read_b64_tr_b16 v[50:51], v4 offset:24832
buffer_load_dwordx4 v3, s[12:15], s42 offen offset:2048 lds
s_waitcnt lgkmcnt(4)
v_mfma_f32_32x32x16_bf16 v[16:31], v[56:59], v[152:155], v[16:31]
ds_read_b64_tr_b16 v[52:53], v4 offset:26624
ds_read_b64_tr_b16 v[54:55], v4 offset:26880
buffer_load_dwordx4 v3, s[12:15], s43 offen offset:3072 lds
s_waitcnt lgkmcnt(4)
v_mfma_f32_32x32x16_bf16 v[16:31], v[60:63], v[156:159], v[16:31]
ds_read_b64_tr_b16 v[56:57], v4 offset:28672
ds_read_b64_tr_b16 v[58:59], v4 offset:28928
s_add_u32 m0, s64, 77824
s_nop 0
buffer_load_dwordx4 v3, s[12:15], s44 offen offset:0 lds
s_waitcnt lgkmcnt(4)
v_mfma_f32_32x32x16_bf16 v[16:31], v[48:51], v[160:163], v[16:31]
ds_read_b64_tr_b16 v[60:61], v4 offset:30720
ds_read_b64_tr_b16 v[62:63], v4 offset:30976
buffer_load_dwordx4 v3, s[12:15], s45 offen offset:1024 lds
s_waitcnt lgkmcnt(4)
v_mfma_f32_32x32x16_bf16 v[16:31], v[52:55], v[164:167], v[16:31]
ds_read_b64_tr_b16 v[48:49], v4 offset:32768
ds_read_b64_tr_b16 v[50:51], v4 offset:33024
buffer_load_dwordx4 v3, s[12:15], s46 offen offset:2048 lds
s_waitcnt lgkmcnt(4)
v_mfma_f32_32x32x16_bf16 v[16:31], v[56:59], v[168:171], v[16:31]
ds_read_b64_tr_b16 v[52:53], v4 offset:34816
ds_read_b64_tr_b16 v[54:55], v4 offset:35072
buffer_load_dwordx4 v3, s[12:15], s47 offen offset:3072 lds
s_waitcnt lgkmcnt(4)
v_mfma_f32_32x32x16_bf16 v[16:31], v[60:63], v[172:175], v[16:31]
ds_read_b64_tr_b16 v[56:57], v4 offset:36864
ds_read_b64_tr_b16 v[58:59], v4 offset:37120
s_add_u32 m0, s64, 81920
s_nop 0
buffer_load_dwordx4 v3, s[12:15], s48 offen offset:0 lds
s_waitcnt lgkmcnt(4)
v_mfma_f32_32x32x16_bf16 v[16:31], v[48:51], v[176:179], v[16:31]
ds_read_b64_tr_b16 v[60:61], v4 offset:38912
ds_read_b64_tr_b16 v[62:63], v4 offset:39168
s_waitcnt lgkmcnt(4)
v_mfma_f32_32x32x16_bf16 v[16:31], v[52:55], v[180:183], v[16:31]
ds_read_b64_tr_b16 v[48:49], v4 offset:40960
ds_read_b64_tr_b16 v[50:51], v4 offset:41216
v_and_b32 v104, 31, v1
v_lshrrev_b32 v105, 5, v1
s_waitcnt lgkmcnt(4)
v_mfma_f32_32x32x16_bf16 v[16:31], v[56:59], v[184:187], v[16:31]
ds_read_b64_tr_b16 v[52:53], v4 offset:43008
ds_read_b64_tr_b16 v[54:55], v4 offset:43264
v_lshlrev_b32 v104, 5, v104
v_lshl_add_u32 v108, v105, 4, v104
s_waitcnt lgkmcnt(4)
v_mfma_f32_32x32x16_bf16 v[16:31], v[60:63], v[188:191], v[16:31]
ds_read_b64_tr_b16 v[56:57], v4 offset:45056
ds_read_b64_tr_b16 v[58:59], v4 offset:45312
s_lshl_b32 s30, s6, 2
s_add_u32 s30, s30, s4
s_waitcnt lgkmcnt(4)
v_mfma_f32_32x32x16_bf16 v[16:31], v[48:51], v[192:195], v[16:31]
ds_read_b64_tr_b16 v[60:61], v4 offset:47104
ds_read_b64_tr_b16 v[62:63], v4 offset:47360
s_mul_i32 s30, s30, 294912
s_mul_i32 s31, s74, 2048
s_waitcnt lgkmcnt(4)
v_mfma_f32_32x32x16_bf16 v[16:31], v[52:55], v[196:199], v[16:31]
ds_read_b64_tr_b16 v[48:49], v4 offset:49152
ds_read_b64_tr_b16 v[50:51], v4 offset:49408
s_add_u32 s30, s30, s31
s_lshl_b32 s31, s5, 14
s_waitcnt lgkmcnt(4)
v_mfma_f32_32x32x16_bf16 v[16:31], v[56:59], v[200:203], v[16:31]
ds_read_b64_tr_b16 v[52:53], v4 offset:51200
ds_read_b64_tr_b16 v[54:55], v4 offset:51456
s_add_u32 s30, s30, s31
v_add_u32 v108, s30, v108
s_waitcnt lgkmcnt(4)
v_mfma_f32_32x32x16_bf16 v[16:31], v[60:63], v[204:207], v[16:31]
ds_read_b64_tr_b16 v[56:57], v4 offset:53248
ds_read_b64_tr_b16 v[58:59], v4 offset:53504
v_mov_b32 v104, -1
v_mov_b32 v105, -1
s_waitcnt lgkmcnt(4)
v_mfma_f32_32x32x16_bf16 v[16:31], v[48:51], v[208:211], v[16:31]
ds_read_b64_tr_b16 v[60:61], v4 offset:55296
ds_read_b64_tr_b16 v[62:63], v4 offset:55552
v_mov_b32 v106, -1
v_mov_b32 v107, -1
s_waitcnt lgkmcnt(4)
v_mfma_f32_32x32x16_bf16 v[16:31], v[52:55], v[212:215], v[16:31]
ds_read_b64_tr_b16 v[48:49], v4 offset:57344
ds_read_b64_tr_b16 v[50:51], v4 offset:57600
s_waitcnt lgkmcnt(4)
v_mfma_f32_32x32x16_bf16 v[16:31], v[56:59], v[216:219], v[16:31]
ds_read_b64_tr_b16 v[52:53], v4 offset:59392
ds_read_b64_tr_b16 v[54:55], v4 offset:59648
s_waitcnt lgkmcnt(4)
v_mfma_f32_32x32x16_bf16 v[16:31], v[60:63], v[220:223], v[16:31]
ds_read_b64_tr_b16 v[56:57], v4 offset:61440
ds_read_b64_tr_b16 v[58:59], v4 offset:61696
s_add_u32 s36, s57, 6
s_cmp_ge_u32 s36, 9
s_cselect_b32 s37, 9, 0
s_sub_u32 s36, s36, s37
s_lshl_b32 s36, s36, 15
buffer_store_dwordx4 v[104:107], v108, s[20:23], s36 offen offset:0 sc0 sc1
s_waitcnt lgkmcnt(4)
v_mfma_f32_32x32x16_bf16 v[16:31], v[48:51], v[224:227], v[16:31]
ds_read_b64_tr_b16 v[60:61], v4 offset:63488
ds_read_b64_tr_b16 v[62:63], v4 offset:63744
s_waitcnt lgkmcnt(4)
v_mfma_f32_32x32x16_bf16 v[16:31], v[52:55], v[228:231], v[16:31]
ds_read_b64_tr_b16 v[48:49], v5 offset:0
ds_read_b64_tr_b16 v[50:51], v5 offset:256
s_waitcnt lgkmcnt(4)
v_mfma_f32_32x32x16_bf16 v[16:31], v[56:59], v[232:235], v[16:31]
ds_read_b64_tr_b16 v[52:53], v5 offset:2048
ds_read_b64_tr_b16 v[54:55], v5 offset:2304
s_waitcnt lgkmcnt(4)
v_mfma_f32_32x32x16_bf16 v[16:31], v[60:63], v[236:239], v[16:31]
ds_read_b64_tr_b16 v[56:57], v5 offset:4096
ds_read_b64_tr_b16 v[58:59], v5 offset:4352
s_add_u32 s36, s57, 6
s_cmp_ge_u32 s36, 9
s_cselect_b32 s37, 9, 0
s_sub_u32 s36, s36, s37
s_lshl_b32 s36, s36, 15
buffer_store_dwordx4 v[104:107], v108, s[20:23], s36 offen offset:1024 sc0 sc1
ds_read_b128 v[32:35], v7 offset:256
ds_read_b128 v[36:39], v7 offset:288
ds_read_b128 v[40:43], v7 offset:320
ds_read_b128 v[44:47], v7 offset:352
s_waitcnt lgkmcnt(8)
v_mfma_f32_32x32x16_bf16 v[16:31], v[48:51], v[240:243], v[16:31]
ds_read_b64_tr_b16 v[60:61], v5 offset:6144
ds_read_b64_tr_b16 v[62:63], v5 offset:6400
s_waitcnt lgkmcnt(8)
v_mfma_f32_32x32x16_bf16 v[16:31], v[52:55], v[244:247], v[16:31]
s_waitcnt vmcnt(2)
s_barrier
ds_read_b64_tr_b16 v[48:49], v5 offset:8192
ds_read_b64_tr_b16 v[50:51], v5 offset:8448
s_waitcnt lgkmcnt(8)
v_mfma_f32_32x32x16_bf16 v[16:31], v[56:59], v[248:251], v[16:31]
ds_read_b64_tr_b16 v[52:53], v5 offset:10240
ds_read_b64_tr_b16 v[54:55], v5 offset:10496
s_add_u32 s58, s58, 128
s_cmp_ge_u32 s58, 768
s_cselect_b32 s58, 0, s58
v_add_u32 v3, s58, v2
s_waitcnt lgkmcnt(4)
v_mfma_f32_32x32x16_bf16 v[16:31], v[60:63], v[252:255], v[16:31]
ds_read_b64_tr_b16 v[56:57], v5 offset:12288
ds_read_b64_tr_b16 v[58:59], v5 offset:12544
s_add_u32 m0, s64, 0
s_nop 0
buffer_load_dwordx4 v3, s[12:15], s40 offen offset:0 lds
s_waitcnt lgkmcnt(4)
v_mfma_f32_32x32x16_bf16 v[32:47], v[48:51], v[112:115], v[32:47]
ds_read_b64_tr_b16 v[60:61], v5 offset:14336
ds_read_b64_tr_b16 v[62:63], v5 offset:14592
s_waitcnt lgkmcnt(4)
v_mfma_f32_32x32x16_bf16 v[32:47], v[52:55], v[116:119], v[32:47]
ds_read_b64_tr_b16 v[48:49], v5 offset:16384
ds_read_b64_tr_b16 v[50:51], v5 offset:16640
buffer_load_dwordx4 v3, s[12:15], s41 offen offset:1024 lds
s_waitcnt lgkmcnt(4)
v_mfma_f32_32x32x16_bf16 v[32:47], v[56:59], v[120:123], v[32:47]
ds_read_b64_tr_b16 v[52:53], v5 offset:18432
ds_read_b64_tr_b16 v[54:55], v5 offset:18688
v_fma_f32 v64, v16, v16, s62
v_fma_f32 v65, v17, v17, s62
v_fma_f32 v66, v18, v18, s62
v_fma_f32 v67, v19, v19, s62
v_mul_f32 v64, v64, v16
v_mul_f32 v65, v65, v17
s_waitcnt lgkmcnt(4)
v_mfma_f32_32x32x16_bf16 v[32:47], v[60:63], v[124:127], v[32:47]
ds_read_b64_tr_b16 v[56:57], v5 offset:20480
ds_read_b64_tr_b16 v[58:59], v5 offset:20736
buffer_load_dwordx4 v3, s[12:15], s42 offen offset:2048 lds
v_mul_f32 v66, v66, v18
v_mul_f32 v67, v67, v19
v_exp_f32 v64, v64
v_exp_f32 v65, v65
s_waitcnt lgkmcnt(4)
v_mfma_f32_32x32x16_bf16 v[32:47], v[48:51], v[128:131], v[32:47]
ds_read_b64_tr_b16 v[60:61], v5 offset:22528
ds_read_b64_tr_b16 v[62:63], v5 offset:22784
v_exp_f32 v66, v66
v_exp_f32 v67, v67
s_waitcnt lgkmcnt(4)
v_mfma_f32_32x32x16_bf16 v[32:47], v[52:55], v[132:135], v[32:47]
ds_read_b64_tr_b16 v[48:49], v5 offset:24576
ds_read_b64_tr_b16 v[50:51], v5 offset:24832
buffer_load_dwordx4 v3, s[12:15], s43 offen offset:3072 lds
v_add_f32 v64, 1.0, v64
v_add_f32 v65, 1.0, v65
v_add_f32 v66, 1.0, v66
v_add_f32 v67, 1.0, v67
s_waitcnt lgkmcnt(4)
v_mfma_f32_32x32x16_bf16 v[32:47], v[56:59], v[136:139], v[32:47]
ds_read_b64_tr_b16 v[52:53], v5 offset:26624
ds_read_b64_tr_b16 v[54:55], v5 offset:26880
v_rcp_f32 v64, v64
v_rcp_f32 v65, v65
s_waitcnt lgkmcnt(4)
v_mfma_f32_32x32x16_bf16 v[32:47], v[60:63], v[140:143], v[32:47]
ds_read_b64_tr_b16 v[56:57], v5 offset:28672
ds_read_b64_tr_b16 v[58:59], v5 offset:28928
s_add_u32 m0, s64, 4096
s_nop 0
buffer_load_dwordx4 v3, s[12:15], s44 offen offset:0 lds
v_rcp_f32 v66, v66
v_rcp_f32 v67, v67
s_waitcnt lgkmcnt(4)
v_mfma_f32_32x32x16_bf16 v[32:47], v[48:51], v[144:147], v[32:47]
ds_read_b64_tr_b16 v[60:61], v5 offset:30720
ds_read_b64_tr_b16 v[62:63], v5 offset:30976
v_mul_f32 v64, v64, v16
v_mul_f32 v65, v65, v17
v_mul_f32 v66, v66, v18
v_mul_f32 v67, v67, v19
v_cvt_pk_bf16_f32 v72, v64, v65
s_waitcnt lgkmcnt(4)
v_mfma_f32_32x32x16_bf16 v[32:47], v[52:55], v[148:151], v[32:47]
ds_read_b64_tr_b16 v[48:49], v5 offset:32768
ds_read_b64_tr_b16 v[50:51], v5 offset:33024
buffer_load_dwordx4 v3, s[12:15], s45 offen offset:1024 lds
v_cvt_pk_bf16_f32 v73, v66, v67
v_fma_f32 v68, v20, v20, s62
v_fma_f32 v69, v21, v21, s62
v_fma_f32 v70, v22, v22, s62
v_fma_f32 v71, v23, v23, s62
v_mul_f32 v68, v68, v20
s_waitcnt lgkmcnt(4)
v_mfma_f32_32x32x16_bf16 v[32:47], v[56:59], v[152:155], v[32:47]
ds_read_b64_tr_b16 v[52:53], v5 offset:34816
ds_read_b64_tr_b16 v[54:55], v5 offset:35072
v_mul_f32 v69, v69, v21
v_mul_f32 v70, v70, v22
v_mul_f32 v71, v71, v23
v_exp_f32 v68, v68
s_waitcnt lgkmcnt(4)
v_mfma_f32_32x32x16_bf16 v[32:47], v[60:63], v[156:159], v[32:47]
ds_read_b64_tr_b16 v[56:57], v5 offset:36864
ds_read_b64_tr_b16 v[58:59], v5 offset:37120
buffer_load_dwordx4 v3, s[12:15], s46 offen offset:2048 lds
v_exp_f32 v69, v69
v_exp_f32 v70, v70
s_waitcnt lgkmcnt(4)
v_mfma_f32_32x32x16_bf16 v[32:47], v[48:51], v[160:163], v[32:47]
ds_read_b64_tr_b16 v[60:61], v5 offset:38912
ds_read_b64_tr_b16 v[62:63], v5 offset:39168
v_exp_f32 v71, v71
v_add_f32 v68, 1.0, v68
v_add_f32 v69, 1.0, v69
v_add_f32 v70, 1.0, v70
s_waitcnt lgkmcnt(4)
v_mfma_f32_32x32x16_bf16 v[32:47], v[52:55], v[164:167], v[32:47]
ds_read_b64_tr_b16 v[48:49], v5 offset:40960
ds_read_b64_tr_b16 v[50:51], v5 offset:41216
buffer_load_dwordx4 v3, s[12:15], s47 offen offset:3072 lds
v_add_f32 v71, 1.0, v71
v_rcp_f32 v68, v68
v_rcp_f32 v69, v69
s_waitcnt lgkmcnt(4)
v_mfma_f32_32x32x16_bf16 v[32:47], v[56:59], v[168:171], v[32:47]
ds_read_b64_tr_b16 v[52:53], v5 offset:43008
ds_read_b64_tr_b16 v[54:55], v5 offset:43264
v_rcp_f32 v70, v70
v_rcp_f32 v71, v71
s_waitcnt lgkmcnt(4)
v_mfma_f32_32x32x16_bf16 v[32:47], v[60:63], v[172:175], v[32:47]
ds_read_b64_tr_b16 v[56:57], v5 offset:45056
ds_read_b64_tr_b16 v[58:59], v5 offset:45312
s_add_u32 m0, s64, 8192
s_nop 0
buffer_load_dwordx4 v3, s[12:15], s48 offen offset:0 lds
v_mul_f32 v68, v68, v20
v_mul_f32 v69, v69, v21
v_mul_f32 v70, v70, v22
v_mul_f32 v71, v71, v23
s_waitcnt lgkmcnt(4)
v_mfma_f32_32x32x16_bf16 v[32:47], v[48:51], v[176:179], v[32:47]
ds_read_b64_tr_b16 v[60:61], v5 offset:47104
ds_read_b64_tr_b16 v[62:63], v5 offset:47360
s_cmp_lg_u32 s3, 0
s_cbranch_scc1 L_ann_m
s_lshl_b32 s28, s6, 4
s_add_u32 s28, s28, s7
v_mov_b32 v0, 1
s_mov_b64 exec, 1
buffer_store_byte v0, off, s[24:27], s28 sc0 sc1
s_mov_b64 exec, -1
L_ann_m:
v_cvt_pk_bf16_f32 v74, v68, v69
v_cvt_pk_bf16_f32 v75, v70, v71
v_fma_f32 v64, v24, v24, s62
v_fma_f32 v65, v25, v25, s62
v_fma_f32 v66, v26, v26, s62
s_waitcnt lgkmcnt(4)
v_mfma_f32_32x32x16_bf16 v[32:47], v[52:55], v[180:183], v[32:47]
ds_read_b64_tr_b16 v[48:49], v5 offset:49152
ds_read_b64_tr_b16 v[50:51], v5 offset:49408
v_fma_f32 v67, v27, v27, s62
v_mul_f32 v64, v64, v24
v_mul_f32 v65, v65, v25
v_mul_f32 v66, v66, v26
v_mul_f32 v67, v67, v27
v_exp_f32 v64, v64
s_waitcnt lgkmcnt(4)
v_mfma_f32_32x32x16_bf16 v[32:47], v[56:59], v[184:187], v[32:47]
ds_read_b64_tr_b16 v[52:53], v5 offset:51200
ds_read_b64_tr_b16 v[54:55], v5 offset:51456
v_exp_f32 v65, v65
v_exp_f32 v66, v66
s_waitcnt lgkmcnt(4)
v_mfma_f32_32x32x16_bf16 v[32:47], v[60:63], v[188:191], v[32:47]
ds_read_b64_tr_b16 v[56:57], v5 offset:53248
ds_read_b64_tr_b16 v[58:59], v5 offset:53504
v_exp_f32 v67, v67
v_add_f32 v64, 1.0, v64
s_waitcnt lgkmcnt(4)
v_mfma_f32_32x32x16_bf16 v[32:47], v[48:51], v[192:195], v[32:47]
ds_read_b64_tr_b16 v[60:61], v5 offset:55296
ds_read_b64_tr_b16 v[62:63], v5 offset:55552
v_add_f32 v65, 1.0, v65
v_add_f32 v66, 1.0, v66
v_add_f32 v67, 1.0, v67
v_rcp_f32 v64, v64
s_waitcnt lgkmcnt(4)
v_mfma_f32_32x32x16_bf16 v[32:47], v[52:55], v[196:199], v[32:47]
ds_read_b64_tr_b16 v[48:49], v5 offset:57344
ds_read_b64_tr_b16 v[50:51], v5 offset:57600
v_rcp_f32 v65, v65
v_rcp_f32 v66, v66
s_waitcnt lgkmcnt(4)
v_mfma_f32_32x32x16_bf16 v[32:47], v[56:59], v[200:203], v[32:47]
ds_read_b64_tr_b16 v[52:53], v5 offset:59392
ds_read_b64_tr_b16 v[54:55], v5 offset:59648
s_add_u32 s36, s57, 7
s_cmp_ge_u32 s36, 9
s_cselect_b32 s37, 9, 0
s_sub_u32 s36, s36, s37
s_lshl_b32 s36, s36, 15
buffer_store_dwordx4 v[104:107], v108, s[20:23], s36 offen offset:0 sc0 sc1
v_rcp_f32 v67, v67
v_mul_f32 v64, v64, v24
v_mul_f32 v65, v65, v25
v_mul_f32 v66, v66, v26
s_waitcnt lgkmcnt(4)
v_mfma_f32_32x32x16_bf16 v[32:47], v[60:63], v[204:207], v[32:47]
ds_read_b64_tr_b16 v[56:57], v5 offset:61440
ds_read_b64_tr_b16 v[58:59], v5 offset:61696
v_mul_f32 v67, v67, v27
v_cvt_pk_bf16_f32 v76, v64, v65
v_cvt_pk_bf16_f32 v77, v66, v67
v_fma_f32 v68, v28, v28, s62
v_fma_f32 v69, v29, v29, s62
s_waitcnt lgkmcnt(4)
v_mfma_f32_32x32x16_bf16 v[32:47], v[48:51], v[208:211], v[32:47]
ds_read_b64_tr_b16 v[60:61], v5 offset:63488
ds_read_b64_tr_b16 v[62:63], v5 offset:63744
v_fma_f32 v70, v30, v30, s62
v_fma_f32 v71, v31, v31, s62
v_mul_f32 v68, v68, v28
v_mul_f32 v69, v69, v29
v_mul_f32 v70, v70, v30
s_waitcnt lgkmcnt(4)
v_mfma_f32_32x32x16_bf16 v[32:47], v[52:55], v[212:215], v[32:47]
ds_read_b64_tr_b16 v[48:49], v6 offset:0
ds_read_b64_tr_b16 v[50:51], v6 offset:256
v_mul_f32 v71, v71, v31
v_exp_f32 v68, v68
v_exp_f32 v69, v69
s_waitcnt lgkmcnt(4)
v_mfma_f32_32x32x16_bf16 v[32:47], v[56:59], v[216:219], v[32:47]
ds_read_b64_tr_b16 v[52:53], v6 offset:2048
ds_read_b64_tr_b16 v[54:55], v6 offset:2304
v_exp_f32 v70, v70
v_exp_f32 v71, v71
s_waitcnt lgkmcnt(4)
v_mfma_f32_32x32x16_bf16 v[32:47], v[60:63], v[220:223], v[32:47]
ds_read_b64_tr_b16 v[56:57], v6 offset:4096
ds_read_b64_tr_b16 v[58:59], v6 offset:4352
v_add_f32 v68, 1.0, v68
v_add_f32 v69, 1.0, v69
v_add_f32 v70, 1.0, v70
v_add_f32 v71, 1.0, v71
v_rcp_f32 v68, v68
s_waitcnt lgkmcnt(4)
v_mfma_f32_32x32x16_bf16 v[32:47], v[48:51], v[224:227], v[32:47]
ds_read_b64_tr_b16 v[60:61], v6 offset:6144
ds_read_b64_tr_b16 v[62:63], v6 offset:6400
v_rcp_f32 v69, v69
v_rcp_f32 v70, v70
s_waitcnt lgkmcnt(4)
v_mfma_f32_32x32x16_bf16 v[32:47], v[52:55], v[228:231], v[32:47]
ds_read_b64_tr_b16 v[48:49], v6 offset:8192
ds_read_b64_tr_b16 v[50:51], v6 offset:8448
v_rcp_f32 v71, v71
v_mul_f32 v68, v68, v28
v_mul_f32 v69, v69, v29
s_waitcnt lgkmcnt(4)
v_mfma_f32_32x32x16_bf16 v[32:47], v[56:59], v[232:235], v[32:47]
ds_read_b64_tr_b16 v[52:53], v6 offset:10240
ds_read_b64_tr_b16 v[54:55], v6 offset:10496
v_mul_f32 v70, v70, v30
v_mul_f32 v71, v71, v31
v_cvt_pk_bf16_f32 v78, v68, v69
v_cvt_pk_bf16_f32 v79, v70, v71
s_waitcnt lgkmcnt(4)
v_mfma_f32_32x32x16_bf16 v[32:47], v[60:63], v[236:239], v[32:47]
ds_read_b64_tr_b16 v[56:57], v6 offset:12288
ds_read_b64_tr_b16 v[58:59], v6 offset:12544
ds_read_b128 v[16:19], v7 offset:512
ds_read_b128 v[20:23], v7 offset:544
ds_read_b128 v[24:27], v7 offset:576
ds_read_b128 v[28:31], v7 offset:608
s_waitcnt lgkmcnt(8)
v_mfma_f32_32x32x16_bf16 v[32:47], v[48:51], v[240:243], v[32:47]
ds_read_b64_tr_b16 v[60:61], v6 offset:14336
ds_read_b64_tr_b16 v[62:63], v6 offset:14592
s_waitcnt lgkmcnt(8)
v_mfma_f32_32x32x16_bf16 v[32:47], v[52:55], v[244:247], v[32:47]
s_waitcnt vmcnt(1)
s_barrier
ds_read_b64_tr_b16 v[48:49], v4 offset:0
ds_read_b64_tr_b16 v[50:51], v4 offset:256
s_waitcnt lgkmcnt(8)
v_mfma_f32_32x32x16_bf16 v[32:47], v[56:59], v[248:251], v[32:47]
ds_read_b64_tr_b16 v[52:53], v4 offset:2048
ds_read_b64_tr_b16 v[54:55], v4 offset:2304
s_add_u32 s58, s58, 128
s_cmp_ge_u32 s58, 768
s_cselect_b32 s58, 0, s58
v_add_u32 v3, s58, v2
s_waitcnt lgkmcnt(4)
v_mfma_f32_32x32x16_bf16 v[32:47], v[60:63], v[252:255], v[32:47]
ds_read_b64_tr_b16 v[56:57], v4 offset:4096
ds_read_b64_tr_b16 v[58:59], v4 offset:4352
s_add_u32 m0, s64, 73728
s_nop 0
buffer_load_dwordx4 v3, s[12:15], s40 offen offset:0 lds
s_waitcnt lgkmcnt(4)
v_mfma_f32_32x32x16_bf16 v[16:31], v[48:51], v[112:115], v[16:31]
ds_read_b64_tr_b16 v[60:61], v4 offset:6144
ds_read_b64_tr_b16 v[62:63], v4 offset:6400
s_waitcnt lgkmcnt(4)
v_mfma_f32_32x32x16_bf16 v[16:31], v[52:55], v[116:119], v[16:31]
ds_read_b64_tr_b16 v[48:49], v4 offset:8192
ds_read_b64_tr_b16 v[50:51], v4 offset:8448
buffer_load_dwordx4 v3, s[12:15], s41 offen offset:1024 lds
s_waitcnt lgkmcnt(4)
v_mfma_f32_32x32x16_bf16 v[16:31], v[56:59], v[120:123], v[16:31]
ds_read_b64_tr_b16 v[52:53], v4 offset:10240
ds_read_b64_tr_b16 v[54:55], v4 offset:10496
v_fma_f32 v64, v32, v32, s62
v_fma_f32 v65, v33, v33, s62
v_fma_f32 v66, v34, v34, s62
v_fma_f32 v67, v35, v35, s62
v_mul_f32 v64, v64, v32
v_mul_f32 v65, v65, v33
s_waitcnt lgkmcnt(4)
v_mfma_f32_32x32x16_bf16 v[16:31], v[60:63], v[124:127], v[16:31]
ds_read_b64_tr_b16 v[56:57], v4 offset:12288
ds_read_b64_tr_b16 v[58:59], v4 offset:12544
buffer_load_dwordx4 v3, s[12:15], s42 offen offset:2048 lds
v_mul_f32 v66, v66, v34
v_mul_f32 v67, v67, v35
v_exp_f32 v64, v64
v_exp_f32 v65, v65
s_waitcnt lgkmcnt(4)
v_mfma_f32_32x32x16_bf16 v[16:31], v[48:51], v[128:131], v[16:31]
ds_read_b64_tr_b16 v[60:61], v4 offset:14336
ds_read_b64_tr_b16 v[62:63], v4 offset:14592
v_exp_f32 v66, v66
v_exp_f32 v67, v67
s_waitcnt lgkmcnt(4)
v_mfma_f32_32x32x16_bf16 v[16:31], v[52:55], v[132:135], v[16:31]
ds_read_b64_tr_b16 v[48:49], v4 offset:16384
ds_read_b64_tr_b16 v[50:51], v4 offset:16640
buffer_load_dwordx4 v3, s[12:15], s43 offen offset:3072 lds
v_add_f32 v64, 1.0, v64
v_add_f32 v65, 1.0, v65
v_add_f32 v66, 1.0, v66
v_add_f32 v67, 1.0, v67
s_waitcnt lgkmcnt(4)
v_mfma_f32_32x32x16_bf16 v[16:31], v[56:59], v[136:139], v[16:31]
ds_read_b64_tr_b16 v[52:53], v4 offset:18432
ds_read_b64_tr_b16 v[54:55], v4 offset:18688
v_rcp_f32 v64, v64
v_rcp_f32 v65, v65
s_waitcnt lgkmcnt(4)
v_mfma_f32_32x32x16_bf16 v[16:31], v[60:63], v[140:143], v[16:31]
ds_read_b64_tr_b16 v[56:57], v4 offset:20480
ds_read_b64_tr_b16 v[58:59], v4 offset:20736
s_add_u32 m0, s64, 77824
s_nop 0
buffer_load_dwordx4 v3, s[12:15], s44 offen offset:0 lds
v_rcp_f32 v66, v66
v_rcp_f32 v67, v67
s_waitcnt lgkmcnt(4)
v_mfma_f32_32x32x16_bf16 v[16:31], v[48:51], v[144:147], v[16:31]
ds_read_b64_tr_b16 v[60:61], v4 offset:22528
ds_read_b64_tr_b16 v[62:63], v4 offset:22784
v_mul_f32 v64, v64, v32
v_mul_f32 v65, v65, v33
v_mul_f32 v66, v66, v34
v_mul_f32 v67, v67, v35
v_cvt_pk_bf16_f32 v80, v64, v65
s_waitcnt lgkmcnt(4)
v_mfma_f32_32x32x16_bf16 v[16:31], v[52:55], v[148:151], v[16:31]
ds_read_b64_tr_b16 v[48:49], v4 offset:24576
ds_read_b64_tr_b16 v[50:51], v4 offset:24832
buffer_load_dwordx4 v3, s[12:15], s45 offen offset:1024 lds
v_cvt_pk_bf16_f32 v81, v66, v67
v_fma_f32 v68, v36, v36, s62
v_fma_f32 v69, v37, v37, s62
v_fma_f32 v70, v38, v38, s62
v_fma_f32 v71, v39, v39, s62
v_mul_f32 v68, v68, v36
s_waitcnt lgkmcnt(4)
v_mfma_f32_32x32x16_bf16 v[16:31], v[56:59], v[152:155], v[16:31]
ds_read_b64_tr_b16 v[52:53], v4 offset:26624
ds_read_b64_tr_b16 v[54:55], v4 offset:26880
v_mul_f32 v69, v69, v37
v_mul_f32 v70, v70, v38
v_mul_f32 v71, v71, v39
v_exp_f32 v68, v68
s_waitcnt lgkmcnt(4)
v_mfma_f32_32x32x16_bf16 v[16:31], v[60:63], v[156:159], v[16:31]
ds_read_b64_tr_b16 v[56:57], v4 offset:28672
ds_read_b64_tr_b16 v[58:59], v4 offset:28928
buffer_load_dwordx4 v3, s[12:15], s46 offen offset:2048 lds
v_exp_f32 v69, v69
v_exp_f32 v70, v70
s_waitcnt lgkmcnt(4)
v_mfma_f32_32x32x16_bf16 v[16:31], v[48:51], v[160:163], v[16:31]
ds_read_b64_tr_b16 v[60:61], v4 offset:30720
ds_read_b64_tr_b16 v[62:63], v4 offset:30976
v_exp_f32 v71, v71
v_add_f32 v68, 1.0, v68
v_add_f32 v69, 1.0, v69
v_add_f32 v70, 1.0, v70
s_waitcnt lgkmcnt(4)
v_mfma_f32_32x32x16_bf16 v[16:31], v[52:55], v[164:167], v[16:31]
ds_read_b64_tr_b16 v[48:49], v4 offset:32768
ds_read_b64_tr_b16 v[50:51], v4 offset:33024
buffer_load_dwordx4 v3, s[12:15], s47 offen offset:3072 lds
v_add_f32 v71, 1.0, v71
v_rcp_f32 v68, v68
v_rcp_f32 v69, v69
s_waitcnt lgkmcnt(4)
v_mfma_f32_32x32x16_bf16 v[16:31], v[56:59], v[168:171], v[16:31]
ds_read_b64_tr_b16 v[52:53], v4 offset:34816
ds_read_b64_tr_b16 v[54:55], v4 offset:35072
v_rcp_f32 v70, v70
v_rcp_f32 v71, v71
s_waitcnt lgkmcnt(4)
v_mfma_f32_32x32x16_bf16 v[16:31], v[60:63], v[172:175], v[16:31]
ds_read_b64_tr_b16 v[56:57], v4 offset:36864
ds_read_b64_tr_b16 v[58:59], v4 offset:37120
s_add_u32 m0, s64, 81920
s_nop 0
buffer_load_dwordx4 v3, s[12:15], s48 offen offset:0 lds
v_mul_f32 v68, v68, v36
v_mul_f32 v69, v69, v37
v_mul_f32 v70, v70, v38
v_mul_f32 v71, v71, v39
s_waitcnt lgkmcnt(4)
v_mfma_f32_32x32x16_bf16 v[16:31], v[48:51], v[176:179], v[16:31]
ds_read_b64_tr_b16 v[60:61], v4 offset:38912
ds_read_b64_tr_b16 v[62:63], v4 offset:39168
v_cvt_pk_bf16_f32 v82, v68, v69
v_cvt_pk_bf16_f32 v83, v70, v71
v_fma_f32 v64, v40, v40, s62
v_fma_f32 v65, v41, v41, s62
v_fma_f32 v66, v42, v42, s62
s_waitcnt lgkmcnt(4)
v_mfma_f32_32x32x16_bf16 v[16:31], v[52:55], v[180:183], v[16:31]
ds_read_b64_tr_b16 v[48:49], v4 offset:40960
ds_read_b64_tr_b16 v[50:51], v4 offset:41216
v_fma_f32 v67, v43, v43, s62
v_mul_f32 v64, v64, v40
v_mul_f32 v65, v65, v41
v_mul_f32 v66, v66, v42
v_mul_f32 v67, v67, v43
v_exp_f32 v64, v64
s_waitcnt lgkmcnt(4)
v_mfma_f32_32x32x16_bf16 v[16:31], v[56:59], v[184:187], v[16:31]
ds_read_b64_tr_b16 v[52:53], v4 offset:43008
ds_read_b64_tr_b16 v[54:55], v4 offset:43264
s_and_b32 s28, s6, 7
s_lshl_b32 s28, s28, 3
s_add_u32 s28, s28, s3
s_mul_i32 s28, s28, 6912
s_mul_i32 s29, s7, 442368
s_add_u32 s28, s28, s29
s_add_u32 s28, s28, 4096
v_lshlrev_b32 v14, 6, v1
buffer_load_dword v15, v14, s[16:19], s28 offen
v_exp_f32 v65, v65
v_exp_f32 v66, v66
s_waitcnt lgkmcnt(4)
v_mfma_f32_32x32x16_bf16 v[16:31], v[60:63], v[188:191], v[16:31]
ds_read_b64_tr_b16 v[56:57], v4 offset:45056
ds_read_b64_tr_b16 v[58:59], v4 offset:45312
v_exp_f32 v67, v67
v_add_f32 v64, 1.0, v64
s_waitcnt lgkmcnt(4)
v_mfma_f32_32x32x16_bf16 v[16:31], v[48:51], v[192:195], v[16:31]
ds_read_b64_tr_b16 v[60:61], v4 offset:47104
ds_read_b64_tr_b16 v[62:63], v4 offset:47360
v_add_f32 v65, 1.0, v65
v_add_f32 v66, 1.0, v66
v_add_f32 v67, 1.0, v67
v_rcp_f32 v64, v64
s_waitcnt lgkmcnt(4)
v_mfma_f32_32x32x16_bf16 v[16:31], v[52:55], v[196:199], v[16:31]
ds_read_b64_tr_b16 v[48:49], v4 offset:49152
ds_read_b64_tr_b16 v[50:51], v4 offset:49408
v_rcp_f32 v65, v65
v_rcp_f32 v66, v66
s_waitcnt lgkmcnt(4)
v_mfma_f32_32x32x16_bf16 v[16:31], v[56:59], v[200:203], v[16:31]
ds_read_b64_tr_b16 v[52:53], v4 offset:51200
ds_read_b64_tr_b16 v[54:55], v4 offset:51456
s_add_u32 s36, s57, 7
s_cmp_ge_u32 s36, 9
s_cselect_b32 s37, 9, 0
s_sub_u32 s36, s36, s37
s_lshl_b32 s36, s36, 15
buffer_store_dwordx4 v[104:107], v108, s[20:23], s36 offen offset:1024 sc0 sc1
v_rcp_f32 v67, v67
v_mul_f32 v64, v64, v40
v_mul_f32 v65, v65, v41
v_mul_f32 v66, v66, v42
s_waitcnt lgkmcnt(4)
v_mfma_f32_32x32x16_bf16 v[16:31], v[60:63], v[204:207], v[16:31]
ds_read_b64_tr_b16 v[56:57], v4 offset:53248
ds_read_b64_tr_b16 v[58:59], v4 offset:53504
v_mul_f32 v67, v67, v43
v_cvt_pk_bf16_f32 v84, v64, v65
v_cvt_pk_bf16_f32 v85, v66, v67
v_fma_f32 v68, v44, v44, s62
v_fma_f32 v69, v45, v45, s62
s_waitcnt lgkmcnt(4)
v_mfma_f32_32x32x16_bf16 v[16:31], v[48:51], v[208:211], v[16:31]
ds_read_b64_tr_b16 v[60:61], v4 offset:55296
ds_read_b64_tr_b16 v[62:63], v4 offset:55552
v_fma_f32 v70, v46, v46, s62
v_fma_f32 v71, v47, v47, s62
v_mul_f32 v68, v68, v44
v_mul_f32 v69, v69, v45
v_mul_f32 v70, v70, v46
s_waitcnt lgkmcnt(4)
v_mfma_f32_32x32x16_bf16 v[16:31], v[52:55], v[212:215], v[16:31]
ds_read_b64_tr_b16 v[48:49], v4 offset:57344
ds_read_b64_tr_b16 v[50:51], v4 offset:57600
v_mul_f32 v71, v71, v47
v_exp_f32 v68, v68
v_exp_f32 v69, v69
s_waitcnt lgkmcnt(4)
v_mfma_f32_32x32x16_bf16 v[16:31], v[56:59], v[216:219], v[16:31]
ds_read_b64_tr_b16 v[52:53], v4 offset:59392
ds_read_b64_tr_b16 v[54:55], v4 offset:59648
v_exp_f32 v70, v70
v_exp_f32 v71, v71
s_waitcnt lgkmcnt(4)
v_mfma_f32_32x32x16_bf16 v[16:31], v[60:63], v[220:223], v[16:31]
ds_read_b64_tr_b16 v[56:57], v4 offset:61440
ds_read_b64_tr_b16 v[58:59], v4 offset:61696
v_add_f32 v68, 1.0, v68
v_add_f32 v69, 1.0, v69
v_add_f32 v70, 1.0, v70
v_add_f32 v71, 1.0, v71
v_rcp_f32 v68, v68
s_waitcnt lgkmcnt(4)
v_mfma_f32_32x32x16_bf16 v[16:31], v[48:51], v[224:227], v[16:31]
ds_read_b64_tr_b16 v[60:61], v4 offset:63488
ds_read_b64_tr_b16 v[62:63], v4 offset:63744
v_rcp_f32 v69, v69
v_rcp_f32 v70, v70
s_waitcnt lgkmcnt(4)
v_mfma_f32_32x32x16_bf16 v[16:31], v[52:55], v[228:231], v[16:31]
ds_read_b64_tr_b16 v[48:49], v5 offset:0
ds_read_b64_tr_b16 v[50:51], v5 offset:256
v_rcp_f32 v71, v71
v_mul_f32 v68, v68, v44
v_mul_f32 v69, v69, v45
s_waitcnt lgkmcnt(4)
v_mfma_f32_32x32x16_bf16 v[16:31], v[56:59], v[232:235], v[16:31]
ds_read_b64_tr_b16 v[52:53], v5 offset:2048
ds_read_b64_tr_b16 v[54:55], v5 offset:2304
v_mul_f32 v70, v70, v46
v_mul_f32 v71, v71, v47
v_cvt_pk_bf16_f32 v86, v68, v69
v_cvt_pk_bf16_f32 v87, v70, v71
s_waitcnt lgkmcnt(4)
v_mfma_f32_32x32x16_bf16 v[16:31], v[60:63], v[236:239], v[16:31]
ds_read_b64_tr_b16 v[56:57], v5 offset:4096
ds_read_b64_tr_b16 v[58:59], v5 offset:4352
ds_read_b128 v[32:35], v7 offset:768
ds_read_b128 v[36:39], v7 offset:800
ds_read_b128 v[40:43], v7 offset:832
ds_read_b128 v[44:47], v7 offset:864
s_waitcnt lgkmcnt(8)
v_mfma_f32_32x32x16_bf16 v[16:31], v[48:51], v[240:243], v[16:31]
ds_read_b64_tr_b16 v[60:61], v5 offset:6144
ds_read_b64_tr_b16 v[62:63], v5 offset:6400
s_waitcnt lgkmcnt(8)
v_mfma_f32_32x32x16_bf16 v[16:31], v[52:55], v[244:247], v[16:31]
s_waitcnt vmcnt(2)
s_barrier
ds_read_b64_tr_b16 v[48:49], v5 offset:8192
ds_read_b64_tr_b16 v[50:51], v5 offset:8448
s_waitcnt lgkmcnt(8)
v_mfma_f32_32x32x16_bf16 v[16:31], v[56:59], v[248:251], v[16:31]
ds_read_b64_tr_b16 v[52:53], v5 offset:10240
ds_read_b64_tr_b16 v[54:55], v5 offset:10496
s_cmp_lg_u32 s3, 0
s_cbranch_scc1 L_hs0
v_lshlrev_b32 v12, 2, v1
buffer_load_dword v13, v12, s[24:27], 0 offen sc0 sc1
L_hs0:
s_add_u32 s58, s58, 128
s_cmp_ge_u32 s58, 768
s_cselect_b32 s58, 0, s58
v_add_u32 v3, s58, v2
s_waitcnt lgkmcnt(4)
v_mfma_f32_32x32x16_bf16 v[16:31], v[60:63], v[252:255], v[16:31]
ds_read_b64_tr_b16 v[56:57], v5 offset:12288
ds_read_b64_tr_b16 v[58:59], v5 offset:12544
s_add_u32 m0, s64, 0
s_nop 0
buffer_load_dwordx4 v3, s[12:15], s40 offen offset:0 lds
s_waitcnt lgkmcnt(4)
v_mfma_f32_32x32x16_bf16 v[32:47], v[48:51], v[112:115], v[32:47]
ds_read_b64_tr_b16 v[60:61], v5 offset:14336
ds_read_b64_tr_b16 v[62:63], v5 offset:14592
s_waitcnt lgkmcnt(4)
v_mfma_f32_32x32x16_bf16 v[32:47], v[52:55], v[116:119], v[32:47]
ds_read_b64_tr_b16 v[48:49], v5 offset:16384
ds_read_b64_tr_b16 v[50:51], v5 offset:16640
buffer_load_dwordx4 v3, s[12:15], s41 offen offset:1024 lds
s_waitcnt lgkmcnt(4)
v_mfma_f32_32x32x16_bf16 v[32:47], v[56:59], v[120:123], v[32:47]
ds_read_b64_tr_b16 v[52:53], v5 offset:18432
ds_read_b64_tr_b16 v[54:55], v5 offset:18688
v_fma_f32 v64, v16, v16, s62
v_fma_f32 v65, v17, v17, s62
v_fma_f32 v66, v18, v18, s62
v_fma_f32 v67, v19, v19, s62
v_mul_f32 v64, v64, v16
v_mul_f32 v65, v65, v17
s_waitcnt lgkmcnt(4)
v_mfma_f32_32x32x16_bf16 v[32:47], v[60:63], v[124:127], v[32:47]
ds_read_b64_tr_b16 v[56:57], v5 offset:20480
ds_read_b64_tr_b16 v[58:59], v5 offset:20736
buffer_load_dwordx4 v3, s[12:15], s42 offen offset:2048 lds
v_mul_f32 v66, v66, v18
v_mul_f32 v67, v67, v19
v_exp_f32 v64, v64
v_exp_f32 v65, v65
s_waitcnt lgkmcnt(4)
v_mfma_f32_32x32x16_bf16 v[32:47], v[48:51], v[128:131], v[32:47]
ds_read_b64_tr_b16 v[60:61], v5 offset:22528
ds_read_b64_tr_b16 v[62:63], v5 offset:22784
v_exp_f32 v66, v66
v_exp_f32 v67, v67
s_waitcnt lgkmcnt(4)
v_mfma_f32_32x32x16_bf16 v[32:47], v[52:55], v[132:135], v[32:47]
ds_read_b64_tr_b16 v[48:49], v5 offset:24576
ds_read_b64_tr_b16 v[50:51], v5 offset:24832
buffer_load_dwordx4 v3, s[12:15], s43 offen offset:3072 lds
v_add_f32 v64, 1.0, v64
v_add_f32 v65, 1.0, v65
v_add_f32 v66, 1.0, v66
v_add_f32 v67, 1.0, v67
s_waitcnt lgkmcnt(4)
v_mfma_f32_32x32x16_bf16 v[32:47], v[56:59], v[136:139], v[32:47]
ds_read_b64_tr_b16 v[52:53], v5 offset:26624
ds_read_b64_tr_b16 v[54:55], v5 offset:26880
v_rcp_f32 v64, v64
v_rcp_f32 v65, v65
s_waitcnt lgkmcnt(4)
v_mfma_f32_32x32x16_bf16 v[32:47], v[60:63], v[140:143], v[32:47]
ds_read_b64_tr_b16 v[56:57], v5 offset:28672
ds_read_b64_tr_b16 v[58:59], v5 offset:28928
s_add_u32 m0, s64, 4096
s_nop 0
buffer_load_dwordx4 v3, s[12:15], s44 offen offset:0 lds
v_rcp_f32 v66, v66
v_rcp_f32 v67, v67
s_waitcnt lgkmcnt(4)
v_mfma_f32_32x32x16_bf16 v[32:47], v[48:51], v[144:147], v[32:47]
ds_read_b64_tr_b16 v[60:61], v5 offset:30720
ds_read_b64_tr_b16 v[62:63], v5 offset:30976
v_mul_f32 v64, v64, v16
v_mul_f32 v65, v65, v17
v_mul_f32 v66, v66, v18
v_mul_f32 v67, v67, v19
v_cvt_pk_bf16_f32 v88, v64, v65
s_waitcnt lgkmcnt(4)
v_mfma_f32_32x32x16_bf16 v[32:47], v[52:55], v[148:151], v[32:47]
ds_read_b64_tr_b16 v[48:49], v5 offset:32768
ds_read_b64_tr_b16 v[50:51], v5 offset:33024
buffer_load_dwordx4 v3, s[12:15], s45 offen offset:1024 lds
v_cvt_pk_bf16_f32 v89, v66, v67
v_fma_f32 v68, v20, v20, s62
v_fma_f32 v69, v21, v21, s62
v_fma_f32 v70, v22, v22, s62
v_fma_f32 v71, v23, v23, s62
v_mul_f32 v68, v68, v20
s_waitcnt lgkmcnt(4)
v_mfma_f32_32x32x16_bf16 v[32:47], v[56:59], v[152:155], v[32:47]
ds_read_b64_tr_b16 v[52:53], v5 offset:34816
ds_read_b64_tr_b16 v[54:55], v5 offset:35072
v_mul_f32 v69, v69, v21
v_mul_f32 v70, v70, v22
v_mul_f32 v71, v71, v23
v_exp_f32 v68, v68
s_waitcnt lgkmcnt(4)
v_mfma_f32_32x32x16_bf16 v[32:47], v[60:63], v[156:159], v[32:47]
ds_read_b64_tr_b16 v[56:57], v5 offset:36864
ds_read_b64_tr_b16 v[58:59], v5 offset:37120
buffer_load_dwordx4 v3, s[12:15], s46 offen offset:2048 lds
v_exp_f32 v69, v69
v_exp_f32 v70, v70
s_waitcnt lgkmcnt(4)
v_mfma_f32_32x32x16_bf16 v[32:47], v[48:51], v[160:163], v[32:47]
ds_read_b64_tr_b16 v[60:61], v5 offset:38912
ds_read_b64_tr_b16 v[62:63], v5 offset:39168
v_exp_f32 v71, v71
v_add_f32 v68, 1.0, v68
v_add_f32 v69, 1.0, v69
v_add_f32 v70, 1.0, v70
s_waitcnt lgkmcnt(4)
v_mfma_f32_32x32x16_bf16 v[32:47], v[52:55], v[164:167], v[32:47]
ds_read_b64_tr_b16 v[48:49], v5 offset:40960
ds_read_b64_tr_b16 v[50:51], v5 offset:41216
buffer_load_dwordx4 v3, s[12:15], s47 offen offset:3072 lds
v_add_f32 v71, 1.0, v71
v_rcp_f32 v68, v68
v_rcp_f32 v69, v69
s_waitcnt lgkmcnt(4)
v_mfma_f32_32x32x16_bf16 v[32:47], v[56:59], v[168:171], v[32:47]
ds_read_b64_tr_b16 v[52:53], v5 offset:43008
ds_read_b64_tr_b16 v[54:55], v5 offset:43264
v_rcp_f32 v70, v70
v_rcp_f32 v71, v71
s_waitcnt lgkmcnt(4)
v_mfma_f32_32x32x16_bf16 v[32:47], v[60:63], v[172:175], v[32:47]
ds_read_b64_tr_b16 v[56:57], v5 offset:45056
ds_read_b64_tr_b16 v[58:59], v5 offset:45312
s_add_u32 m0, s64, 8192
s_nop 0
buffer_load_dwordx4 v3, s[12:15], s48 offen offset:0 lds
v_mul_f32 v68, v68, v20
v_mul_f32 v69, v69, v21
v_mul_f32 v70, v70, v22
v_mul_f32 v71, v71, v23
s_waitcnt lgkmcnt(4)
v_mfma_f32_32x32x16_bf16 v[32:47], v[48:51], v[176:179], v[32:47]
ds_read_b64_tr_b16 v[60:61], v5 offset:47104
ds_read_b64_tr_b16 v[62:63], v5 offset:47360
v_cvt_pk_bf16_f32 v90, v68, v69
v_cvt_pk_bf16_f32 v91, v70, v71
v_fma_f32 v64, v24, v24, s62
v_fma_f32 v65, v25, v25, s62
v_fma_f32 v66, v26, v26, s62
s_waitcnt lgkmcnt(4)
v_mfma_f32_32x32x16_bf16 v[32:47], v[52:55], v[180:183], v[32:47]
ds_read_b64_tr_b16 v[48:49], v5 offset:49152
ds_read_b64_tr_b16 v[50:51], v5 offset:49408
v_fma_f32 v67, v27, v27, s62
v_mul_f32 v64, v64, v24
v_mul_f32 v65, v65, v25
v_mul_f32 v66, v66, v26
v_mul_f32 v67, v67, v27
v_exp_f32 v64, v64
s_waitcnt lgkmcnt(4)
v_mfma_f32_32x32x16_bf16 v[32:47], v[56:59], v[184:187], v[32:47]
ds_read_b64_tr_b16 v[52:53], v5 offset:51200
ds_read_b64_tr_b16 v[54:55], v5 offset:51456
s_and_b32 s28, s6, 7
s_lshl_b32 s28, s28, 3
s_add_u32 s28, s28, s3
s_mul_i32 s28, s28, 6912
s_mul_i32 s29, s7, 442368
s_add_u32 s28, s28, s29
s_add_u32 s28, s28, 8192
v_lshlrev_b32 v14, 6, v1
buffer_load_dword v15, v14, s[16:19], s28 offen
v_exp_f32 v65, v65
v_exp_f32 v66, v66
s_waitcnt lgkmcnt(4)
v_mfma_f32_32x32x16_bf16 v[32:47], v[60:63], v[188:191], v[32:47]
ds_read_b64_tr_b16 v[56:57], v5 offset:53248
ds_read_b64_tr_b16 v[58:59], v5 offset:53504
v_exp_f32 v67, v67
v_add_f32 v64, 1.0, v64
s_waitcnt lgkmcnt(4)
v_mfma_f32_32x32x16_bf16 v[32:47], v[48:51], v[192:195], v[32:47]
ds_read_b64_tr_b16 v[60:61], v5 offset:55296
ds_read_b64_tr_b16 v[62:63], v5 offset:55552
v_add_f32 v65, 1.0, v65
v_add_f32 v66, 1.0, v66
v_add_f32 v67, 1.0, v67
v_rcp_f32 v64, v64
s_waitcnt lgkmcnt(4)
v_mfma_f32_32x32x16_bf16 v[32:47], v[52:55], v[196:199], v[32:47]
ds_read_b64_tr_b16 v[48:49], v5 offset:57344
ds_read_b64_tr_b16 v[50:51], v5 offset:57600
v_rcp_f32 v65, v65
v_rcp_f32 v66, v66
s_waitcnt lgkmcnt(4)
v_mfma_f32_32x32x16_bf16 v[32:47], v[56:59], v[200:203], v[32:47]
ds_read_b64_tr_b16 v[52:53], v5 offset:59392
ds_read_b64_tr_b16 v[54:55], v5 offset:59648
s_add_u32 s36, s57, 8
s_cmp_ge_u32 s36, 9
s_cselect_b32 s37, 9, 0
s_sub_u32 s36, s36, s37
s_lshl_b32 s36, s36, 15
buffer_store_dwordx4 v[104:107], v108, s[20:23], s36 offen offset:0 sc0 sc1
v_rcp_f32 v67, v67
v_mul_f32 v64, v64, v24
v_mul_f32 v65, v65, v25
v_mul_f32 v66, v66, v26
s_waitcnt lgkmcnt(4)
v_mfma_f32_32x32x16_bf16 v[32:47], v[60:63], v[204:207], v[32:47]
ds_read_b64_tr_b16 v[56:57], v5 offset:61440
ds_read_b64_tr_b16 v[58:59], v5 offset:61696
v_mul_f32 v67, v67, v27
v_cvt_pk_bf16_f32 v92, v64, v65
v_cvt_pk_bf16_f32 v93, v66, v67
v_fma_f32 v68, v28, v28, s62
v_fma_f32 v69, v29, v29, s62
s_waitcnt lgkmcnt(4)
v_mfma_f32_32x32x16_bf16 v[32:47], v[48:51], v[208:211], v[32:47]
ds_read_b64_tr_b16 v[60:61], v5 offset:63488
ds_read_b64_tr_b16 v[62:63], v5 offset:63744
v_fma_f32 v70, v30, v30, s62
v_fma_f32 v71, v31, v31, s62
v_mul_f32 v68, v68, v28
v_mul_f32 v69, v69, v29
v_mul_f32 v70, v70, v30
s_waitcnt lgkmcnt(4)
v_mfma_f32_32x32x16_bf16 v[32:47], v[52:55], v[212:215], v[32:47]
ds_read_b64_tr_b16 v[48:49], v6 offset:0
ds_read_b64_tr_b16 v[50:51], v6 offset:256
v_mul_f32 v71, v71, v31
v_exp_f32 v68, v68
v_exp_f32 v69, v69
s_waitcnt lgkmcnt(4)
v_mfma_f32_32x32x16_bf16 v[32:47], v[56:59], v[216:219], v[32:47]
ds_read_b64_tr_b16 v[52:53], v6 offset:2048
ds_read_b64_tr_b16 v[54:55], v6 offset:2304
v_exp_f32 v70, v70
v_exp_f32 v71, v71
s_waitcnt lgkmcnt(4)
v_mfma_f32_32x32x16_bf16 v[32:47], v[60:63], v[220:223], v[32:47]
ds_read_b64_tr_b16 v[56:57], v6 offset:4096
ds_read_b64_tr_b16 v[58:59], v6 offset:4352
v_add_f32 v68, 1.0, v68
v_add_f32 v69, 1.0, v69
v_add_f32 v70, 1.0, v70
v_add_f32 v71, 1.0, v71
v_rcp_f32 v68, v68
s_waitcnt lgkmcnt(4)
v_mfma_f32_32x32x16_bf16 v[32:47], v[48:51], v[224:227], v[32:47]
ds_read_b64_tr_b16 v[60:61], v6 offset:6144
ds_read_b64_tr_b16 v[62:63], v6 offset:6400
v_rcp_f32 v69, v69
v_rcp_f32 v70, v70
s_waitcnt lgkmcnt(4)
v_mfma_f32_32x32x16_bf16 v[32:47], v[52:55], v[228:231], v[32:47]
ds_read_b64_tr_b16 v[48:49], v6 offset:8192
ds_read_b64_tr_b16 v[50:51], v6 offset:8448
v_rcp_f32 v71, v71
v_mul_f32 v68, v68, v28
v_mul_f32 v69, v69, v29
s_waitcnt lgkmcnt(4)
v_mfma_f32_32x32x16_bf16 v[32:47], v[56:59], v[232:235], v[32:47]
ds_read_b64_tr_b16 v[52:53], v6 offset:10240
ds_read_b64_tr_b16 v[54:55], v6 offset:10496
v_mul_f32 v70, v70, v30
v_mul_f32 v71, v71, v31
v_cvt_pk_bf16_f32 v94, v68, v69
v_cvt_pk_bf16_f32 v95, v70, v71
s_waitcnt lgkmcnt(4)
v_mfma_f32_32x32x16_bf16 v[32:47], v[60:63], v[236:239], v[32:47]
ds_read_b64_tr_b16 v[56:57], v6 offset:12288
ds_read_b64_tr_b16 v[58:59], v6 offset:12544
ds_read_b128 v[16:19], v7 offset:1024
ds_read_b128 v[20:23], v7 offset:1056
ds_read_b128 v[24:27], v7 offset:1088
ds_read_b128 v[28:31], v7 offset:1120
s_waitcnt lgkmcnt(8)
v_mfma_f32_32x32x16_bf16 v[32:47], v[48:51], v[240:243], v[32:47]
ds_read_b64_tr_b16 v[60:61], v6 offset:14336
ds_read_b64_tr_b16 v[62:63], v6 offset:14592
s_waitcnt lgkmcnt(8)
v_mfma_f32_32x32x16_bf16 v[32:47], v[52:55], v[244:247], v[32:47]
s_waitcnt vmcnt(2)
s_cmp_lg_u32 s3, 0
s_cbranch_scc1 L_hs1
v_and_b32 v13, 0x01010101, v13
v_cmp_ne_u32 vcc, 0x01010101, v13
s_cbranch_vccz L_hs1
v_lshlrev_b32 v12, 2, v1
s_movk_i32 s28, 0x4000
L_hs2:
buffer_load_dword v13, v12, s[24:27], 0 offen sc0 sc1
s_sub_u32 s28, s28, 1
s_cbranch_scc1 L_hs2_d
s_waitcnt vmcnt(0)
v_and_b32 v13, 0x01010101, v13
v_cmp_ne_u32 vcc, 0x01010101, v13
s_cbranch_vccnz L_hs2
L_hs2_d:
s_waitcnt vmcnt(0)
L_hs1:
s_barrier
ds_read_b64_tr_b16 v[48:49], v4 offset:0
ds_read_b64_tr_b16 v[50:51], v4 offset:256
s_waitcnt lgkmcnt(8)
v_mfma_f32_32x32x16_bf16 v[32:47], v[56:59], v[248:251], v[32:47]
ds_read_b64_tr_b16 v[52:53], v4 offset:2048
ds_read_b64_tr_b16 v[54:55], v4 offset:2304
s_add_u32 s58, s58, 128
s_cmp_ge_u32 s58, 768
s_cselect_b32 s58, 0, s58
v_add_u32 v3, s58, v2
s_waitcnt lgkmcnt(4)
v_mfma_f32_32x32x16_bf16 v[32:47], v[60:63], v[252:255], v[32:47]
ds_read_b64_tr_b16 v[56:57], v4 offset:4096
ds_read_b64_tr_b16 v[58:59], v4 offset:4352
s_add_u32 m0, s64, 73728
s_nop 0
buffer_load_dwordx4 v3, s[12:15], s40 offen offset:0 lds
s_waitcnt lgkmcnt(4)
v_mfma_f32_32x32x16_bf16 v[16:31], v[48:51], v[112:115], v[16:31]
ds_read_b64_tr_b16 v[60:61], v4 offset:6144
ds_read_b64_tr_b16 v[62:63], v4 offset:6400
s_waitcnt lgkmcnt(4)
v_mfma_f32_32x32x16_bf16 v[16:31], v[52:55], v[116:119], v[16:31]
ds_read_b64_tr_b16 v[48:49], v4 offset:8192
ds_read_b64_tr_b16 v[50:51], v4 offset:8448
buffer_load_dwordx4 v3, s[12:15], s41 offen offset:1024 lds
s_waitcnt lgkmcnt(4)
v_mfma_f32_32x32x16_bf16 v[16:31], v[56:59], v[120:123], v[16:31]
ds_read_b64_tr_b16 v[52:53], v4 offset:10240
ds_read_b64_tr_b16 v[54:55], v4 offset:10496
v_fma_f32 v64, v32, v32, s62
v_fma_f32 v65, v33, v33, s62
v_fma_f32 v66, v34, v34, s62
v_fma_f32 v67, v35, v35, s62
v_mul_f32 v64, v64, v32
v_mul_f32 v65, v65, v33
s_waitcnt lgkmcnt(4)
v_mfma_f32_32x32x16_bf16 v[16:31], v[60:63], v[124:127], v[16:31]
ds_read_b64_tr_b16 v[56:57], v4 offset:12288
ds_read_b64_tr_b16 v[58:59], v4 offset:12544
buffer_load_dwordx4 v3, s[12:15], s42 offen offset:2048 lds
v_mul_f32 v66, v66, v34
v_mul_f32 v67, v67, v35
v_exp_f32 v64, v64
v_exp_f32 v65, v65
s_waitcnt lgkmcnt(4)
v_mfma_f32_32x32x16_bf16 v[16:31], v[48:51], v[128:131], v[16:31]
ds_read_b64_tr_b16 v[60:61], v4 offset:14336
ds_read_b64_tr_b16 v[62:63], v4 offset:14592
v_exp_f32 v66, v66
v_exp_f32 v67, v67
s_waitcnt lgkmcnt(4)
v_mfma_f32_32x32x16_bf16 v[16:31], v[52:55], v[132:135], v[16:31]
ds_read_b64_tr_b16 v[48:49], v4 offset:16384
ds_read_b64_tr_b16 v[50:51], v4 offset:16640
buffer_load_dwordx4 v3, s[12:15], s43 offen offset:3072 lds
v_add_f32 v64, 1.0, v64
v_add_f32 v65, 1.0, v65
v_add_f32 v66, 1.0, v66
v_add_f32 v67, 1.0, v67
s_waitcnt lgkmcnt(4)
v_mfma_f32_32x32x16_bf16 v[16:31], v[56:59], v[136:139], v[16:31]
ds_read_b64_tr_b16 v[52:53], v4 offset:18432
ds_read_b64_tr_b16 v[54:55], v4 offset:18688
v_rcp_f32 v64, v64
v_rcp_f32 v65, v65
s_waitcnt lgkmcnt(4)
v_mfma_f32_32x32x16_bf16 v[16:31], v[60:63], v[140:143], v[16:31]
ds_read_b64_tr_b16 v[56:57], v4 offset:20480
ds_read_b64_tr_b16 v[58:59], v4 offset:20736
s_add_u32 m0, s64, 77824
s_nop 0
buffer_load_dwordx4 v3, s[12:15], s44 offen offset:0 lds
v_rcp_f32 v66, v66
v_rcp_f32 v67, v67
s_waitcnt lgkmcnt(4)
v_mfma_f32_32x32x16_bf16 v[16:31], v[48:51], v[144:147], v[16:31]
ds_read_b64_tr_b16 v[60:61], v4 offset:22528
ds_read_b64_tr_b16 v[62:63], v4 offset:22784
v_mul_f32 v64, v64, v32
v_mul_f32 v65, v65, v33
v_mul_f32 v66, v66, v34
v_mul_f32 v67, v67, v35
v_cvt_pk_bf16_f32 v96, v64, v65
s_waitcnt lgkmcnt(4)
v_mfma_f32_32x32x16_bf16 v[16:31], v[52:55], v[148:151], v[16:31]
ds_read_b64_tr_b16 v[48:49], v4 offset:24576
ds_read_b64_tr_b16 v[50:51], v4 offset:24832
buffer_load_dwordx4 v3, s[12:15], s45 offen offset:1024 lds
v_cvt_pk_bf16_f32 v97, v66, v67
v_fma_f32 v68, v36, v36, s62
v_fma_f32 v69, v37, v37, s62
v_fma_f32 v70, v38, v38, s62
v_fma_f32 v71, v39, v39, s62
v_mul_f32 v68, v68, v36
s_waitcnt lgkmcnt(4)
v_mfma_f32_32x32x16_bf16 v[16:31], v[56:59], v[152:155], v[16:31]
ds_read_b64_tr_b16 v[52:53], v4 offset:26624
ds_read_b64_tr_b16 v[54:55], v4 offset:26880
v_mul_f32 v69, v69, v37
v_mul_f32 v70, v70, v38
v_mul_f32 v71, v71, v39
v_exp_f32 v68, v68
s_waitcnt lgkmcnt(4)
v_mfma_f32_32x32x16_bf16 v[16:31], v[60:63], v[156:159], v[16:31]
ds_read_b64_tr_b16 v[56:57], v4 offset:28672
ds_read_b64_tr_b16 v[58:59], v4 offset:28928
buffer_load_dwordx4 v3, s[12:15], s46 offen offset:2048 lds
v_exp_f32 v69, v69
v_exp_f32 v70, v70
s_waitcnt lgkmcnt(4)
v_mfma_f32_32x32x16_bf16 v[16:31], v[48:51], v[160:163], v[16:31]
ds_read_b64_tr_b16 v[60:61], v4 offset:30720
ds_read_b64_tr_b16 v[62:63], v4 offset:30976
v_exp_f32 v71, v71
v_add_f32 v68, 1.0, v68
v_add_f32 v69, 1.0, v69
v_add_f32 v70, 1.0, v70
s_waitcnt lgkmcnt(4)
v_mfma_f32_32x32x16_bf16 v[16:31], v[52:55], v[164:167], v[16:31]
ds_read_b64_tr_b16 v[48:49], v4 offset:32768
ds_read_b64_tr_b16 v[50:51], v4 offset:33024
buffer_load_dwordx4 v3, s[12:15], s47 offen offset:3072 lds
v_add_f32 v71, 1.0, v71
v_rcp_f32 v68, v68
v_rcp_f32 v69, v69
s_waitcnt lgkmcnt(4)
v_mfma_f32_32x32x16_bf16 v[16:31], v[56:59], v[168:171], v[16:31]
ds_read_b64_tr_b16 v[52:53], v4 offset:34816
ds_read_b64_tr_b16 v[54:55], v4 offset:35072
v_rcp_f32 v70, v70
v_rcp_f32 v71, v71
s_waitcnt lgkmcnt(4)
v_mfma_f32_32x32x16_bf16 v[16:31], v[60:63], v[172:175], v[16:31]
ds_read_b64_tr_b16 v[56:57], v4 offset:36864
ds_read_b64_tr_b16 v[58:59], v4 offset:37120
s_add_u32 m0, s64, 81920
s_nop 0
buffer_load_dwordx4 v3, s[12:15], s48 offen offset:0 lds
v_mul_f32 v68, v68, v36
v_mul_f32 v69, v69, v37
v_mul_f32 v70, v70, v38
v_mul_f32 v71, v71, v39
s_waitcnt lgkmcnt(4)
v_mfma_f32_32x32x16_bf16 v[16:31], v[48:51], v[176:179], v[16:31]
ds_read_b64_tr_b16 v[60:61], v4 offset:38912
ds_read_b64_tr_b16 v[62:63], v4 offset:39168
v_cvt_pk_bf16_f32 v98, v68, v69
v_cvt_pk_bf16_f32 v99, v70, v71
v_fma_f32 v64, v40, v40, s62
v_fma_f32 v65, v41, v41, s62
v_fma_f32 v66, v42, v42, s62
s_waitcnt lgkmcnt(4)
v_mfma_f32_32x32x16_bf16 v[16:31], v[52:55], v[180:183], v[16:31]
ds_read_b64_tr_b16 v[48:49], v4 offset:40960
ds_read_b64_tr_b16 v[50:51], v4 offset:41216
v_fma_f32 v67, v43, v43, s62
v_mul_f32 v64, v64, v40
v_mul_f32 v65, v65, v41
v_mul_f32 v66, v66, v42
v_mul_f32 v67, v67, v43
v_exp_f32 v64, v64
s_waitcnt lgkmcnt(4)
v_mfma_f32_32x32x16_bf16 v[16:31], v[56:59], v[184:187], v[16:31]
ds_read_b64_tr_b16 v[52:53], v4 offset:43008
ds_read_b64_tr_b16 v[54:55], v4 offset:43264
v_exp_f32 v65, v65
v_exp_f32 v66, v66
s_waitcnt lgkmcnt(4)
v_mfma_f32_32x32x16_bf16 v[16:31], v[60:63], v[188:191], v[16:31]
ds_read_b64_tr_b16 v[56:57], v4 offset:45056
ds_read_b64_tr_b16 v[58:59], v4 offset:45312
v_exp_f32 v67, v67
v_add_f32 v64, 1.0, v64
s_waitcnt lgkmcnt(4)
v_mfma_f32_32x32x16_bf16 v[16:31], v[48:51], v[192:195], v[16:31]
ds_read_b64_tr_b16 v[60:61], v4 offset:47104
ds_read_b64_tr_b16 v[62:63], v4 offset:47360
s_mov_b64 exec, 1
buffer_load_dwordx3 v[12:14], off, s[20:23], s70 sc0 sc1
s_mov_b64 exec, -1
v_add_f32 v65, 1.0, v65
v_add_f32 v66, 1.0, v66
v_add_f32 v67, 1.0, v67
v_rcp_f32 v64, v64
s_waitcnt lgkmcnt(4)
v_mfma_f32_32x32x16_bf16 v[16:31], v[52:55], v[196:199], v[16:31]
ds_read_b64_tr_b16 v[48:49], v4 offset:49152
ds_read_b64_tr_b16 v[50:51], v4 offset:49408
v_rcp_f32 v65, v65
v_rcp_f32 v66, v66
s_waitcnt lgkmcnt(4)
v_mfma_f32_32x32x16_bf16 v[16:31], v[56:59], v[200:203], v[16:31]
ds_read_b64_tr_b16 v[52:53], v4 offset:51200
ds_read_b64_tr_b16 v[54:55], v4 offset:51456
s_add_u32 s36, s57, 8
s_cmp_ge_u32 s36, 9
s_cselect_b32 s37, 9, 0
s_sub_u32 s36, s36, s37
s_lshl_b32 s36, s36, 15
buffer_store_dwordx4 v[104:107], v108, s[20:23], s36 offen offset:1024 sc0 sc1
v_rcp_f32 v67, v67
v_mul_f32 v64, v64, v40
v_mul_f32 v65, v65, v41
v_mul_f32 v66, v66, v42
s_waitcnt lgkmcnt(4)
v_mfma_f32_32x32x16_bf16 v[16:31], v[60:63], v[204:207], v[16:31]
ds_read_b64_tr_b16 v[56:57], v4 offset:53248
ds_read_b64_tr_b16 v[58:59], v4 offset:53504
v_mul_f32 v67, v67, v43
v_cvt_pk_bf16_f32 v100, v64, v65
v_cvt_pk_bf16_f32 v101, v66, v67
v_fma_f32 v68, v44, v44, s62
v_fma_f32 v69, v45, v45, s62
s_waitcnt lgkmcnt(4)
v_mfma_f32_32x32x16_bf16 v[16:31], v[48:51], v[208:211], v[16:31]
ds_read_b64_tr_b16 v[60:61], v4 offset:55296
ds_read_b64_tr_b16 v[62:63], v4 offset:55552
v_fma_f32 v70, v46, v46, s62
v_fma_f32 v71, v47, v47, s62
v_mul_f32 v68, v68, v44
v_mul_f32 v69, v69, v45
v_mul_f32 v70, v70, v46
s_waitcnt lgkmcnt(4)
v_mfma_f32_32x32x16_bf16 v[16:31], v[52:55], v[212:215], v[16:31]
ds_read_b64_tr_b16 v[48:49], v4 offset:57344
ds_read_b64_tr_b16 v[50:51], v4 offset:57600
v_mul_f32 v71, v71, v47
v_exp_f32 v68, v68
v_exp_f32 v69, v69
s_waitcnt lgkmcnt(4)
v_mfma_f32_32x32x16_bf16 v[16:31], v[56:59], v[216:219], v[16:31]
ds_read_b64_tr_b16 v[52:53], v4 offset:59392
ds_read_b64_tr_b16 v[54:55], v4 offset:59648
v_exp_f32 v70, v70
v_exp_f32 v71, v71
s_waitcnt lgkmcnt(4)
v_mfma_f32_32x32x16_bf16 v[16:31], v[60:63], v[220:223], v[16:31]
ds_read_b64_tr_b16 v[56:57], v4 offset:61440
ds_read_b64_tr_b16 v[58:59], v4 offset:61696
v_add_f32 v68, 1.0, v68
v_add_f32 v69, 1.0, v69
v_add_f32 v70, 1.0, v70
v_add_f32 v71, 1.0, v71
v_rcp_f32 v68, v68
s_waitcnt lgkmcnt(4)
v_mfma_f32_32x32x16_bf16 v[16:31], v[48:51], v[224:227], v[16:31]
ds_read_b64_tr_b16 v[60:61], v4 offset:63488
ds_read_b64_tr_b16 v[62:63], v4 offset:63744
v_rcp_f32 v69, v69
v_rcp_f32 v70, v70
s_waitcnt lgkmcnt(4)
v_mfma_f32_32x32x16_bf16 v[16:31], v[52:55], v[228:231], v[16:31]
ds_read_b64_tr_b16 v[48:49], v5 offset:0
ds_read_b64_tr_b16 v[50:51], v5 offset:256
v_rcp_f32 v71, v71
v_mul_f32 v68, v68, v44
v_mul_f32 v69, v69, v45
s_waitcnt lgkmcnt(4)
v_mfma_f32_32x32x16_bf16 v[16:31], v[56:59], v[232:235], v[16:31]
ds_read_b64_tr_b16 v[52:53], v5 offset:2048
ds_read_b64_tr_b16 v[54:55], v5 offset:2304
v_mul_f32 v70, v70, v46
v_mul_f32 v71, v71, v47
v_cvt_pk_bf16_f32 v102, v68, v69
v_cvt_pk_bf16_f32 v103, v70, v71
s_waitcnt lgkmcnt(4)
v_mfma_f32_32x32x16_bf16 v[16:31], v[60:63], v[236:239], v[16:31]
ds_read_b64_tr_b16 v[56:57], v5 offset:4096
ds_read_b64_tr_b16 v[58:59], v5 offset:4352
ds_read_b128 v[32:35], v7 offset:1280
ds_read_b128 v[36:39], v7 offset:1312
ds_read_b128 v[40:43], v7 offset:1344
ds_read_b128 v[44:47], v7 offset:1376
s_waitcnt lgkmcnt(8)
v_mfma_f32_32x32x16_bf16 v[16:31], v[48:51], v[240:243], v[16:31]
ds_read_b64_tr_b16 v[60:61], v5 offset:6144
ds_read_b64_tr_b16 v[62:63], v5 offset:6400
s_waitcnt lgkmcnt(8)
v_mfma_f32_32x32x16_bf16 v[16:31], v[52:55], v[244:247], v[16:31]
s_waitcnt vmcnt(2)
s_barrier
ds_read_b64_tr_b16 v[48:49], v5 offset:8192
ds_read_b64_tr_b16 v[50:51], v5 offset:8448
s_waitcnt lgkmcnt(8)
v_mfma_f32_32x32x16_bf16 v[16:31], v[56:59], v[248:251], v[16:31]
ds_read_b64_tr_b16 v[52:53], v5 offset:10240
ds_read_b64_tr_b16 v[54:55], v5 offset:10496
s_mul_i32 s59, s3, 6144
v_bfe_u32 v9, v1, 2, 3
v_lshrrev_b32 v10, 5, v1
v_and_b32 v11, 3, v1
v_lshlrev_b32 v11, 4, v11
v_lshl_add_u32 v10, v10, 6, v11
v_mul_u32_u24 v2, 1152, v9
v_add_u32 v2, v2, v10
s_lshl_b32 s58, s57, 7
v_add_u32 v3, s58, v2
s_waitcnt lgkmcnt(4)
v_mfma_f32_32x32x16_bf16 v[16:31], v[60:63], v[252:255], v[16:31]
ds_read_b64_tr_b16 v[56:57], v5 offset:12288
ds_read_b64_tr_b16 v[58:59], v5 offset:12544
s_add_u32 m0, s59, 0
s_nop 0
buffer_load_dwordx4 v3, s[16:19], s50 offen offset:0 lds
s_waitcnt lgkmcnt(4)
v_mfma_f32_32x32x16_bf16 v[32:47], v[48:51], v[112:115], v[32:47]
ds_read_b64_tr_b16 v[60:61], v5 offset:14336
ds_read_b64_tr_b16 v[62:63], v5 offset:14592
s_waitcnt lgkmcnt(4)
v_mfma_f32_32x32x16_bf16 v[32:47], v[52:55], v[116:119], v[32:47]
ds_read_b64_tr_b16 v[48:49], v5 offset:16384
ds_read_b64_tr_b16 v[50:51], v5 offset:16640
buffer_load_dwordx4 v3, s[16:19], s51 offen offset:1024 lds
s_waitcnt lgkmcnt(4)
v_mfma_f32_32x32x16_bf16 v[32:47], v[56:59], v[120:123], v[32:47]
ds_read_b64_tr_b16 v[52:53], v5 offset:18432
ds_read_b64_tr_b16 v[54:55], v5 offset:18688
v_fma_f32 v64, v16, v16, s62
v_fma_f32 v65, v17, v17, s62
v_fma_f32 v66, v18, v18, s62
v_fma_f32 v67, v19, v19, s62
v_mul_f32 v64, v64, v16
v_mul_f32 v65, v65, v17
s_waitcnt lgkmcnt(4)
v_mfma_f32_32x32x16_bf16 v[32:47], v[60:63], v[124:127], v[32:47]
ds_read_b64_tr_b16 v[56:57], v5 offset:20480
ds_read_b64_tr_b16 v[58:59], v5 offset:20736
buffer_load_dwordx4 v3, s[16:19], s52 offen offset:2048 lds
v_mul_f32 v66, v66, v18
v_mul_f32 v67, v67, v19
v_exp_f32 v64, v64
v_exp_f32 v65, v65
s_waitcnt lgkmcnt(4)
v_mfma_f32_32x32x16_bf16 v[32:47], v[48:51], v[128:131], v[32:47]
ds_read_b64_tr_b16 v[60:61], v5 offset:22528
ds_read_b64_tr_b16 v[62:63], v5 offset:22784
v_exp_f32 v66, v66
v_exp_f32 v67, v67
s_waitcnt lgkmcnt(4)
v_mfma_f32_32x32x16_bf16 v[32:47], v[52:55], v[132:135], v[32:47]
ds_read_b64_tr_b16 v[48:49], v5 offset:24576
ds_read_b64_tr_b16 v[50:51], v5 offset:24832
buffer_load_dwordx4 v3, s[16:19], s53 offen offset:3072 lds
v_add_f32 v64, 1.0, v64
v_add_f32 v65, 1.0, v65
v_add_f32 v66, 1.0, v66
v_add_f32 v67, 1.0, v67
s_waitcnt lgkmcnt(4)
v_mfma_f32_32x32x16_bf16 v[32:47], v[56:59], v[136:139], v[32:47]
ds_read_b64_tr_b16 v[52:53], v5 offset:26624
ds_read_b64_tr_b16 v[54:55], v5 offset:26880
v_rcp_f32 v64, v64
v_rcp_f32 v65, v65
s_waitcnt lgkmcnt(4)
v_mfma_f32_32x32x16_bf16 v[32:47], v[60:63], v[140:143], v[32:47]
ds_read_b64_tr_b16 v[56:57], v5 offset:28672
ds_read_b64_tr_b16 v[58:59], v5 offset:28928
s_add_u32 m0, s59, 4096
s_nop 0
buffer_load_dwordx4 v3, s[16:19], s54 offen offset:0 lds
v_rcp_f32 v66, v66
v_rcp_f32 v67, v67
s_waitcnt lgkmcnt(4)
v_mfma_f32_32x32x16_bf16 v[32:47], v[48:51], v[144:147], v[32:47]
ds_read_b64_tr_b16 v[60:61], v5 offset:30720
ds_read_b64_tr_b16 v[62:63], v5 offset:30976
v_mul_f32 v64, v64, v16
v_mul_f32 v65, v65, v17
v_mul_f32 v66, v66, v18
v_mul_f32 v67, v67, v19
v_cvt_pk_bf16_f32 v104, v64, v65
s_waitcnt lgkmcnt(4)
v_mfma_f32_32x32x16_bf16 v[32:47], v[52:55], v[148:151], v[32:47]
ds_read_b64_tr_b16 v[48:49], v5 offset:32768
ds_read_b64_tr_b16 v[50:51], v5 offset:33024
buffer_load_dwordx4 v3, s[16:19], s55 offen offset:1024 lds
v_cvt_pk_bf16_f32 v105, v66, v67
v_fma_f32 v68, v20, v20, s62
v_fma_f32 v69, v21, v21, s62
v_fma_f32 v70, v22, v22, s62
v_fma_f32 v71, v23, v23, s62
v_mul_f32 v68, v68, v20
s_waitcnt lgkmcnt(4)
v_mfma_f32_32x32x16_bf16 v[32:47], v[56:59], v[152:155], v[32:47]
ds_read_b64_tr_b16 v[52:53], v5 offset:34816
ds_read_b64_tr_b16 v[54:55], v5 offset:35072
v_mul_f32 v69, v69, v21
v_mul_f32 v70, v70, v22
v_mul_f32 v71, v71, v23
v_exp_f32 v68, v68
s_waitcnt lgkmcnt(4)
v_mfma_f32_32x32x16_bf16 v[32:47], v[60:63], v[156:159], v[32:47]
ds_read_b64_tr_b16 v[56:57], v5 offset:36864
ds_read_b64_tr_b16 v[58:59], v5 offset:37120
v_exp_f32 v69, v69
v_exp_f32 v70, v70
s_waitcnt lgkmcnt(4)
v_mfma_f32_32x32x16_bf16 v[32:47], v[48:51], v[160:163], v[32:47]
ds_read_b64_tr_b16 v[60:61], v5 offset:38912
ds_read_b64_tr_b16 v[62:63], v5 offset:39168
s_waitcnt vmcnt(7)
v_xor_b32 v13, v12, v13
v_xor_b32 v14, v12, v14
v_or_b32 v13, v13, v14
s_nop 0
v_readfirstlane_b32 s70, v13
s_and_b32 s70, s70, 0xf00
v_exp_f32 v71, v71
v_add_f32 v68, 1.0, v68
v_add_f32 v69, 1.0, v69
v_add_f32 v70, 1.0, v70
s_waitcnt lgkmcnt(4)
v_mfma_f32_32x32x16_bf16 v[32:47], v[52:55], v[164:167], v[32:47]
ds_read_b64_tr_b16 v[48:49], v5 offset:40960
ds_read_b64_tr_b16 v[50:51], v5 offset:41216
v_add_f32 v71, 1.0, v71
v_rcp_f32 v68, v68
v_rcp_f32 v69, v69
s_waitcnt lgkmcnt(4)
v_mfma_f32_32x32x16_bf16 v[32:47], v[56:59], v[168:171], v[32:47]
ds_read_b64_tr_b16 v[52:53], v5 offset:43008
ds_read_b64_tr_b16 v[54:55], v5 offset:43264
v_rcp_f32 v70, v70
v_rcp_f32 v71, v71
s_waitcnt lgkmcnt(4)
v_mfma_f32_32x32x16_bf16 v[32:47], v[60:63], v[172:175], v[32:47]
ds_read_b64_tr_b16 v[56:57], v5 offset:45056
ds_read_b64_tr_b16 v[58:59], v5 offset:45312
v_mul_f32 v68, v68, v20
v_mul_f32 v69, v69, v21
v_mul_f32 v70, v70, v22
v_mul_f32 v71, v71, v23
s_waitcnt lgkmcnt(4)
v_mfma_f32_32x32x16_bf16 v[32:47], v[48:51], v[176:179], v[32:47]
ds_read_b64_tr_b16 v[60:61], v5 offset:47104
ds_read_b64_tr_b16 v[62:63], v5 offset:47360
v_cvt_pk_bf16_f32 v106, v68, v69
v_cvt_pk_bf16_f32 v107, v70, v71
v_fma_f32 v64, v24, v24, s62
v_fma_f32 v65, v25, v25, s62
v_fma_f32 v66, v26, v26, s62
s_waitcnt lgkmcnt(4)
v_mfma_f32_32x32x16_bf16 v[32:47], v[52:55], v[180:183], v[32:47]
ds_read_b64_tr_b16 v[48:49], v5 offset:49152
ds_read_b64_tr_b16 v[50:51], v5 offset:49408
v_fma_f32 v67, v27, v27, s62
v_mul_f32 v64, v64, v24
v_mul_f32 v65, v65, v25
v_mul_f32 v66, v66, v26
v_mul_f32 v67, v67, v27
v_exp_f32 v64, v64
s_waitcnt lgkmcnt(4)
v_mfma_f32_32x32x16_bf16 v[32:47], v[56:59], v[184:187], v[32:47]
ds_read_b64_tr_b16 v[52:53], v5 offset:51200
ds_read_b64_tr_b16 v[54:55], v5 offset:51456
v_exp_f32 v65, v65
v_exp_f32 v66, v66
s_waitcnt lgkmcnt(4)
v_mfma_f32_32x32x16_bf16 v[32:47], v[60:63], v[188:191], v[32:47]
ds_read_b64_tr_b16 v[56:57], v5 offset:53248
ds_read_b64_tr_b16 v[58:59], v5 offset:53504
v_lshlrev_b32 v9, 4, v1
s_lshl_b32 s30, s3, 11
v_exp_f32 v67, v67
v_add_f32 v64, 1.0, v64
s_waitcnt lgkmcnt(4)
v_mfma_f32_32x32x16_bf16 v[32:47], v[48:51], v[192:195], v[32:47]
ds_read_b64_tr_b16 v[60:61], v5 offset:55296
ds_read_b64_tr_b16 v[62:63], v5 offset:55552
s_add_u32 s30, s30, 49152
v_add_u32 v182, s30, v9
v_add_f32 v65, 1.0, v65
v_add_f32 v66, 1.0, v66
v_add_f32 v67, 1.0, v67
v_rcp_f32 v64, v64
s_waitcnt lgkmcnt(4)
v_mfma_f32_32x32x16_bf16 v[32:47], v[52:55], v[196:199], v[32:47]
ds_read_b64_tr_b16 v[48:49], v5 offset:57344
ds_read_b64_tr_b16 v[50:51], v5 offset:57600
v_add_u32 v183, 98304, v182
v_xor_b32 v184, 0x2000, v182
v_rcp_f32 v65, v65
v_rcp_f32 v66, v66
s_waitcnt lgkmcnt(4)
v_mfma_f32_32x32x16_bf16 v[32:47], v[56:59], v[200:203], v[32:47]
s_barrier
ds_read_b64_tr_b16 v[52:53], v5 offset:59392
ds_read_b64_tr_b16 v[54:55], v5 offset:59648
v_add_u32 v185, 98304, v184
v_rcp_f32 v67, v67
v_mul_f32 v64, v64, v24
v_mul_f32 v65, v65, v25
v_mul_f32 v66, v66, v26
s_waitcnt lgkmcnt(4)
v_mfma_f32_32x32x16_bf16 v[32:47], v[60:63], v[204:207], v[32:47]
ds_read_b64_tr_b16 v[56:57], v5 offset:61440
ds_read_b64_tr_b16 v[58:59], v5 offset:61696
ds_write_b128 v182, v[72:75] offset:0
ds_write_b128 v182, v[76:79] offset:1024
v_mul_f32 v67, v67, v27
v_cvt_pk_bf16_f32 v108, v64, v65
v_cvt_pk_bf16_f32 v109, v66, v67
v_fma_f32 v68, v28, v28, s62
v_fma_f32 v69, v29, v29, s62
s_waitcnt lgkmcnt(6)
v_mfma_f32_32x32x16_bf16 v[32:47], v[48:51], v[208:211], v[32:47]
ds_read_b64_tr_b16 v[60:61], v5 offset:63488
ds_read_b64_tr_b16 v[62:63], v5 offset:63744
ds_write_b128 v182, v[80:83] offset:16384
ds_write_b128 v182, v[84:87] offset:17408
v_fma_f32 v70, v30, v30, s62
v_fma_f32 v71, v31, v31, s62
v_mul_f32 v68, v68, v28
v_mul_f32 v69, v69, v29
v_mul_f32 v70, v70, v30
s_waitcnt lgkmcnt(8)
v_mfma_f32_32x32x16_bf16 v[32:47], v[52:55], v[212:215], v[32:47]
ds_read_b64_tr_b16 v[48:49], v6 offset:0
ds_read_b64_tr_b16 v[50:51], v6 offset:256
v_lshrrev_b32 v9, 5, v1
v_lshlrev_b32 v9, 8, v9
v_bfe_u32 v10, v1, 2, 2
v_lshl_add_u32 v9, v10, 6, v9
v_and_b32 v10, 1, v1
ds_write_b128 v182, v[88:91] offset:32768
ds_write_b128 v182, v[92:95] offset:33792
v_mul_f32 v71, v71, v31
v_exp_f32 v68, v68
v_exp_f32 v69, v69
s_waitcnt lgkmcnt(10)
v_mfma_f32_32x32x16_bf16 v[32:47], v[56:59], v[216:219], v[32:47]
ds_read_b64_tr_b16 v[52:53], v6 offset:2048
ds_read_b64_tr_b16 v[54:55], v6 offset:2304
v_lshl_add_u32 v9, v10, 5, v9
v_bfe_u32 v10, v1, 1, 1
v_lshl_add_u32 v9, v10, 3, v9
v_bfe_u32 v10, v1, 4, 1
ds_write_b128 v183, v[96:99] offset:0
ds_write_b128 v183, v[100:103] offset:1024
v_exp_f32 v70, v70
v_exp_f32 v71, v71
s_waitcnt lgkmcnt(10)
v_mfma_f32_32x32x16_bf16 v[32:47], v[60:63], v[220:223], v[32:47]
ds_read_b64_tr_b16 v[56:57], v6 offset:4096
ds_read_b64_tr_b16 v[58:59], v6 offset:4352
v_lshl_add_u32 v9, v10, 4, v9
s_mul_i32 s30, s5, 4608
v_add_u32 v176, s30, v9
v_xor_b32 v177, 0x1000, v176
v_add_u32 v178, 49152, v176
v_add_f32 v68, 1.0, v68
v_add_f32 v69, 1.0, v69
v_add_f32 v70, 1.0, v70
v_add_f32 v71, 1.0, v71
v_rcp_f32 v68, v68
s_waitcnt lgkmcnt(8)
v_mfma_f32_32x32x16_bf16 v[32:47], v[48:51], v[224:227], v[32:47]
ds_read_b64_tr_b16 v[60:61], v6 offset:6144
ds_read_b64_tr_b16 v[62:63], v6 offset:6400
v_add_u32 v179, 49152, v177
v_add_u32 v180, 98304, v176
v_add_u32 v181, 98304, v177
v_and_b32 v9, 31, v1
v_rcp_f32 v69, v69
v_rcp_f32 v70, v70
s_waitcnt lgkmcnt(6)
v_mfma_f32_32x32x16_bf16 v[32:47], v[52:55], v[228:231], v[32:47]
s_waitcnt lgkmcnt(4)
s_barrier
ds_read_b64_tr_b16 v[48:49], v6 offset:8192
ds_read_b64_tr_b16 v[50:51], v6 offset:8448
v_lshrrev_b32 v10, 5, v1
v_lshlrev_b32 v9, 5, v9
v_lshl_add_u32 v8, v10, 4, v9
s_lshl_b32 s30, s6, 2
s_add_u32 s30, s30, s4
ds_read_b128 v[112:115], v184 offset:0
ds_read_b128 v[116:119], v184 offset:1024
v_rcp_f32 v71, v71
v_mul_f32 v68, v68, v28
v_mul_f32 v69, v69, v29
s_waitcnt lgkmcnt(6)
v_mfma_f32_32x32x16_bf16 v[32:47], v[56:59], v[232:235], v[32:47]
ds_read_b64_tr_b16 v[52:53], v6 offset:10240
ds_read_b64_tr_b16 v[54:55], v6 offset:10496
s_mul_i32 s30, s30, 294912
s_mul_i32 s31, s74, 2048
s_add_u32 s30, s30, s31
s_lshl_b32 s31, s5, 14
ds_read_b128 v[120:123], v184 offset:16384
ds_read_b128 v[124:127], v184 offset:17408
v_mul_f32 v70, v70, v30
v_mul_f32 v71, v71, v31
v_cvt_pk_bf16_f32 v110, v68, v69
v_cvt_pk_bf16_f32 v111, v70, v71
s_waitcnt lgkmcnt(8)
v_mfma_f32_32x32x16_bf16 v[32:47], v[60:63], v[236:239], v[32:47]
ds_read_b64_tr_b16 v[56:57], v6 offset:12288
ds_read_b64_tr_b16 v[58:59], v6 offset:12544
s_add_u32 s30, s30, s31
v_add_u32 v8, s30, v8
s_lshl_b32 s60, s57, 15
s_add_u32 s75, s60, 18874368
ds_read_b128 v[128:131], v184 offset:32768
ds_read_b128 v[132:135], v184 offset:33792
s_waitcnt lgkmcnt(10)
v_mfma_f32_32x32x16_bf16 v[32:47], v[48:51], v[240:243], v[32:47]
ds_read_b64_tr_b16 v[60:61], v6 offset:14336
ds_read_b64_tr_b16 v[62:63], v6 offset:14592
ds_read_b128 v[136:139], v185 offset:0
ds_read_b128 v[140:143], v185 offset:1024
s_waitcnt lgkmcnt(10)
v_mfma_f32_32x32x16_bf16 v[32:47], v[52:55], v[244:247], v[32:47]
s_waitcnt lgkmcnt(0)
s_waitcnt vmcnt(0)
s_barrier
ds_read_b64_tr_b16 v[48:49], v176 offset:0
ds_read_b64_tr_b16 v[50:51], v176 offset:1024
v_mfma_f32_32x32x16_bf16 v[32:47], v[56:59], v[248:251], v[32:47]
ds_read_b64_tr_b16 v[52:53], v176 offset:2048
ds_read_b64_tr_b16 v[54:55], v176 offset:3072
s_add_u32 s58, s58, 128
s_cmp_ge_u32 s58, 1152
s_cselect_b32 s58, 0, s58
v_add_u32 v3, s58, v2
v_mfma_f32_32x32x16_bf16 v[32:47], v[60:63], v[252:255], v[32:47]
ds_read_b64_tr_b16 v[56:57], v176 offset:8192
ds_read_b64_tr_b16 v[58:59], v176 offset:9216
s_add_u32 m0, s59, 49152
s_nop 0
buffer_load_dwordx4 v3, s[16:19], s50 offen offset:0 lds
s_waitcnt lgkmcnt(4)
v_mfma_f32_32x32x16_bf16 v[16:31], v[48:51], v[72:75], 0
ds_read_b64_tr_b16 v[60:61], v176 offset:10240
ds_read_b64_tr_b16 v[62:63], v176 offset:11264
s_waitcnt lgkmcnt(4)
v_mfma_f32_32x32x16_bf16 v[16:31], v[52:55], v[76:79], v[16:31]
ds_read_b64_tr_b16 v[48:49], v176 offset:16384
ds_read_b64_tr_b16 v[50:51], v176 offset:17408
buffer_load_dwordx4 v3, s[16:19], s51 offen offset:1024 lds
ds_write_b128 v182, v[104:107] offset:49152
ds_write_b128 v182, v[108:111] offset:50176
s_waitcnt lgkmcnt(6)
v_mfma_f32_32x32x16_bf16 v[16:31], v[56:59], v[80:83], v[16:31]
ds_read_b64_tr_b16 v[52:53], v176 offset:18432
ds_read_b64_tr_b16 v[54:55], v176 offset:19456
v_add_u32 v183, 0x10000, v182
v_add_u32 v185, 0x10000, v184
v_fma_f32 v64, v32, v32, s62
v_fma_f32 v65, v33, v33, s62
v_fma_f32 v66, v34, v34, s62
v_fma_f32 v67, v35, v35, s62
v_mul_f32 v64, v64, v32
v_mul_f32 v65, v65, v33
v_mul_f32 v66, v66, v34
v_mul_f32 v67, v67, v35
v_exp_f32 v64, v64
v_exp_f32 v65, v65
s_waitcnt lgkmcnt(6)
v_mfma_f32_32x32x16_bf16 v[16:31], v[60:63], v[84:87], v[16:31]
ds_read_b64_tr_b16 v[56:57], v176 offset:24576
ds_read_b64_tr_b16 v[58:59], v176 offset:25600
buffer_load_dwordx4 v3, s[16:19], s52 offen offset:2048 lds
v_exp_f32 v66, v66
v_exp_f32 v67, v67
v_add_f32 v64, 1.0, v64
v_add_f32 v65, 1.0, v65
v_add_f32 v66, 1.0, v66
v_add_f32 v67, 1.0, v67
v_rcp_f32 v64, v64
s_waitcnt lgkmcnt(6)
v_mfma_f32_32x32x16_bf16 v[16:31], v[48:51], v[88:91], v[16:31]
ds_read_b64_tr_b16 v[60:61], v176 offset:26624
ds_read_b64_tr_b16 v[62:63], v176 offset:27648
v_rcp_f32 v65, v65
v_rcp_f32 v66, v66
v_rcp_f32 v67, v67
v_mul_f32 v64, v64, v32
v_mul_f32 v65, v65, v33
v_mul_f32 v66, v66, v34
v_mul_f32 v67, v67, v35
s_waitcnt lgkmcnt(4)
v_mfma_f32_32x32x16_bf16 v[16:31], v[52:55], v[92:95], v[16:31]
ds_read_b64_tr_b16 v[48:49], v176 offset:32768
ds_read_b64_tr_b16 v[50:51], v176 offset:33792
buffer_load_dwordx4 v3, s[16:19], s53 offen offset:3072 lds
v_cvt_pk_bf16_f32 v160, v64, v65
v_cvt_pk_bf16_f32 v161, v66, v67
v_fma_f32 v68, v36, v36, s62
v_fma_f32 v69, v37, v37, s62
v_fma_f32 v70, v38, v38, s62
v_fma_f32 v71, v39, v39, s62
v_mul_f32 v68, v68, v36
v_mul_f32 v69, v69, v37
v_mul_f32 v70, v70, v38
v_mul_f32 v71, v71, v39
v_exp_f32 v68, v68
s_waitcnt lgkmcnt(4)
v_mfma_f32_32x32x16_bf16 v[16:31], v[56:59], v[96:99], v[16:31]
ds_read_b64_tr_b16 v[52:53], v176 offset:34816
ds_read_b64_tr_b16 v[54:55], v176 offset:35840
v_exp_f32 v69, v69
v_exp_f32 v70, v70
v_exp_f32 v71, v71
v_add_f32 v68, 1.0, v68
v_add_f32 v69, 1.0, v69
v_add_f32 v70, 1.0, v70
s_waitcnt lgkmcnt(4)
v_mfma_f32_32x32x16_bf16 v[16:31], v[60:63], v[100:103], v[16:31]
ds_read_b64_tr_b16 v[56:57], v177 offset:0
ds_read_b64_tr_b16 v[58:59], v177 offset:1024
s_add_u32 m0, s59, 53248
s_nop 0
buffer_load_dwordx4 v3, s[16:19], s54 offen offset:0 lds
v_add_f32 v71, 1.0, v71
v_rcp_f32 v68, v68
v_rcp_f32 v69, v69
v_rcp_f32 v70, v70
v_rcp_f32 v71, v71
v_mul_f32 v68, v68, v36
s_waitcnt lgkmcnt(4)
v_mfma_f32_32x32x16_bf16 v[16:31], v[48:51], v[104:107], v[16:31]
ds_read_b64_tr_b16 v[60:61], v177 offset:2048
ds_read_b64_tr_b16 v[62:63], v177 offset:3072
v_mul_f32 v69, v69, v37
v_mul_f32 v70, v70, v38
v_mul_f32 v71, v71, v39
v_cvt_pk_bf16_f32 v162, v68, v69
v_cvt_pk_bf16_f32 v163, v70, v71
v_fma_f32 v64, v40, v40, s62
v_fma_f32 v65, v41, v41, s62
v_fma_f32 v66, v42, v42, s62
v_fma_f32 v67, v43, v43, s62
v_mul_f32 v64, v64, v40
v_mul_f32 v65, v65, v41
v_mul_f32 v66, v66, v42
s_waitcnt lgkmcnt(4)
v_mfma_f32_32x32x16_bf16 v[16:31], v[52:55], v[108:111], v[16:31]
ds_read_b64_tr_b16 v[48:49], v177 offset:8192
ds_read_b64_tr_b16 v[50:51], v177 offset:9216
buffer_load_dwordx4 v3, s[16:19], s55 offen offset:1024 lds
v_mul_f32 v67, v67, v43
v_exp_f32 v64, v64
v_exp_f32 v65, v65
v_exp_f32 v66, v66
v_exp_f32 v67, v67
s_waitcnt lgkmcnt(4)
v_mfma_f32_32x32x16_bf16 v[16:31], v[56:59], v[112:115], v[16:31]
ds_read_b64_tr_b16 v[52:53], v177 offset:10240
ds_read_b64_tr_b16 v[54:55], v177 offset:11264
s_cmp_lg_u32 s3, 0
s_cbranch_scc1 L_ann_m2
s_lshl_b32 s28, s6, 4
s_add_u32 s28, s28, s7
v_mov_b32 v0, 3
s_mov_b64 exec, 1
buffer_store_byte v0, off, s[24:27], s28 sc0 sc1
s_mov_b64 exec, -1
L_ann_m2:
v_add_f32 v64, 1.0, v64
v_add_f32 v65, 1.0, v65
v_add_f32 v66, 1.0, v66
v_add_f32 v67, 1.0, v67
v_rcp_f32 v64, v64
v_rcp_f32 v65, v65
v_rcp_f32 v66, v66
v_rcp_f32 v67, v67
s_waitcnt lgkmcnt(4)
v_mfma_f32_32x32x16_bf16 v[16:31], v[60:63], v[116:119], v[16:31]
ds_read_b64_tr_b16 v[56:57], v177 offset:16384
ds_read_b64_tr_b16 v[58:59], v177 offset:17408
v_mul_f32 v64, v64, v40
v_mul_f32 v65, v65, v41
v_mul_f32 v66, v66, v42
v_mul_f32 v67, v67, v43
v_cvt_pk_bf16_f32 v164, v64, v65
v_cvt_pk_bf16_f32 v165, v66, v67
v_fma_f32 v68, v44, v44, s62
v_fma_f32 v69, v45, v45, s62
v_fma_f32 v70, v46, v46, s62
v_fma_f32 v71, v47, v47, s62
s_waitcnt lgkmcnt(4)
v_mfma_f32_32x32x16_bf16 v[16:31], v[48:51], v[120:123], v[16:31]
ds_read_b64_tr_b16 v[60:61], v177 offset:18432
ds_read_b64_tr_b16 v[62:63], v177 offset:19456
v_mul_f32 v68, v68, v44
v_mul_f32 v69, v69, v45
v_mul_f32 v70, v70, v46
v_mul_f32 v71, v71, v47
v_exp_f32 v68, v68
v_exp_f32 v69, v69
v_exp_f32 v70, v70
s_waitcnt lgkmcnt(4)
v_mfma_f32_32x32x16_bf16 v[16:31], v[52:55], v[124:127], v[16:31]
ds_read_b64_tr_b16 v[48:49], v177 offset:24576
ds_read_b64_tr_b16 v[50:51], v177 offset:25600
v_exp_f32 v71, v71
v_add_f32 v68, 1.0, v68
v_add_f32 v69, 1.0, v69
v_add_f32 v70, 1.0, v70
v_add_f32 v71, 1.0, v71
v_rcp_f32 v68, v68
v_rcp_f32 v69, v69
s_waitcnt lgkmcnt(4)
v_mfma_f32_32x32x16_bf16 v[16:31], v[56:59], v[128:131], v[16:31]
ds_read_b64_tr_b16 v[52:53], v177 offset:26624
ds_read_b64_tr_b16 v[54:55], v177 offset:27648
v_rcp_f32 v70, v70
v_rcp_f32 v71, v71
v_mul_f32 v68, v68, v44
v_mul_f32 v69, v69, v45
v_mul_f32 v70, v70, v46
v_mul_f32 v71, v71, v47
v_cvt_pk_bf16_f32 v166, v68, v69
v_cvt_pk_bf16_f32 v167, v70, v71
s_waitcnt lgkmcnt(4)
v_mfma_f32_32x32x16_bf16 v[16:31], v[60:63], v[132:135], v[16:31]
ds_read_b64_tr_b16 v[56:57], v176 offset:40960
ds_read_b64_tr_b16 v[58:59], v176 offset:41984
ds_write_b128 v183, v[160:163] offset:0
ds_write_b128 v183, v[164:167] offset:1024
s_waitcnt lgkmcnt(6)
v_mfma_f32_32x32x16_bf16 v[16:31], v[48:51], v[136:139], v[16:31]
ds_read_b64_tr_b16 v[60:61], v176 offset:43008
ds_read_b64_tr_b16 v[62:63], v176 offset:44032
s_waitcnt lgkmcnt(6)
v_mfma_f32_32x32x16_bf16 v[16:31], v[52:55], v[140:143], v[16:31]
s_waitcnt lgkmcnt(2)
s_barrier
ds_read_b64_tr_b16 v[48:49], v177 offset:32768
ds_read_b64_tr_b16 v[50:51], v177 offset:33792
ds_read_b128 v[144:147], v184 offset:49152
ds_read_b128 v[148:151], v184 offset:50176
ds_read_b128 v[152:155], v185 offset:0
ds_read_b128 v[156:159], v185 offset:1024
v_mfma_f32_32x32x16_bf16 v[16:31], v[56:59], v[160:163], v[16:31]
ds_read_b64_tr_b16 v[52:53], v177 offset:34816
ds_read_b64_tr_b16 v[54:55], v177 offset:35840
s_waitcnt lgkmcnt(8)
v_mfma_f32_32x32x16_bf16 v[16:31], v[60:63], v[164:167], v[16:31]
ds_read_b64_tr_b16 v[56:57], v177 offset:40960
ds_read_b64_tr_b16 v[58:59], v177 offset:41984
s_waitcnt lgkmcnt(6)
v_mfma_f32_32x32x16_bf16 v[16:31], v[48:51], v[144:147], v[16:31]
ds_read_b64_tr_b16 v[60:61], v177 offset:43008
ds_read_b64_tr_b16 v[62:63], v177 offset:44032
s_waitcnt lgkmcnt(4)
v_mfma_f32_32x32x16_bf16 v[16:31], v[52:55], v[148:151], v[16:31]
s_waitcnt vmcnt(0)
s_barrier
ds_read_b64_tr_b16 v[48:49], v178 offset:0
ds_read_b64_tr_b16 v[50:51], v178 offset:1024
s_waitcnt lgkmcnt(4)
v_mfma_f32_32x32x16_bf16 v[16:31], v[56:59], v[152:155], v[16:31]
ds_read_b64_tr_b16 v[52:53], v178 offset:2048
ds_read_b64_tr_b16 v[54:55], v178 offset:3072
s_add_u32 s58, s58, 128
s_cmp_ge_u32 s58, 1152
s_cselect_b32 s58, 0, s58
v_add_u32 v3, s58, v2
s_waitcnt lgkmcnt(4)
v_mfma_f32_32x32x16_bf16 v[16:31], v[60:63], v[156:159], v[16:31]
ds_read_b64_tr_b16 v[56:57], v178 offset:8192
ds_read_b64_tr_b16 v[58:59], v178 offset:9216
s_add_u32 m0, s59, 98304
s_nop 0
buffer_load_dwordx4 v3, s[16:19], s50 offen offset:0 lds
s_waitcnt lgkmcnt(4)
v_mfma_f32_32x32x16_bf16 v[32:47], v[48:51], v[72:75], 0
ds_read_b64_tr_b16 v[60:61], v178 offset:10240
ds_read_b64_tr_b16 v[62:63], v178 offset:11264
s_waitcnt lgkmcnt(4)
v_mfma_f32_32x32x16_bf16 v[32:47], v[52:55], v[76:79], v[32:47]
ds_read_b64_tr_b16 v[48:49], v178 offset:16384
ds_read_b64_tr_b16 v[50:51], v178 offset:17408
buffer_load_dwordx4 v3, s[16:19], s51 offen offset:1024 lds
s_waitcnt lgkmcnt(4)
v_mfma_f32_32x32x16_bf16 v[32:47], v[56:59], v[80:83], v[32:47]
ds_read_b64_tr_b16 v[52:53], v178 offset:18432
ds_read_b64_tr_b16 v[54:55], v178 offset:19456
v_cvt_pk_bf16_f32 v168, v16, v17
v_cvt_pk_bf16_f32 v169, v18, v19
v_cvt_pk_bf16_f32 v170, v20, v21
v_cvt_pk_bf16_f32 v171, v22, v23
s_waitcnt lgkmcnt(4)
v_mfma_f32_32x32x16_bf16 v[32:47], v[60:63], v[84:87], v[32:47]
ds_read_b64_tr_b16 v[56:57], v178 offset:24576
ds_read_b64_tr_b16 v[58:59], v178 offset:25600
buffer_load_dwordx4 v3, s[16:19], s52 offen offset:2048 lds
s_cmp_lg_u32 s70, 0
s_cbranch_scc1 L_rm1
buffer_store_dwordx4 v[168:171], v8, s[20:23], s75 offen offset:0
s_branch L_rm1e
L_rm1:
buffer_store_dwordx4 v[168:171], v8, s[20:23], s75 offen offset:0 sc0 sc1
L_rm1e:
v_cvt_pk_bf16_f32 v172, v24, v25
v_cvt_pk_bf16_f32 v173, v26, v27
s_waitcnt lgkmcnt(4)
v_mfma_f32_32x32x16_bf16 v[32:47], v[48:51], v[88:91], v[32:47]
ds_read_b64_tr_b16 v[60:61], v178 offset:26624
ds_read_b64_tr_b16 v[62:63], v178 offset:27648
v_cvt_pk_bf16_f32 v174, v28, v29
v_cvt_pk_bf16_f32 v175, v30, v31
s_cmp_lg_u32 s70, 0
s_cbranch_scc1 L_rm2
buffer_store_dwordx4 v[172:175], v8, s[20:23], s75 offen offset:1024
s_branch L_rm2e
L_rm2:
buffer_store_dwordx4 v[172:175], v8, s[20:23], s75 offen offset:1024 sc0 sc1
L_rm2e:
s_waitcnt lgkmcnt(4)
v_mfma_f32_32x32x16_bf16 v[32:47], v[52:55], v[92:95], v[32:47]
ds_read_b64_tr_b16 v[48:49], v178 offset:32768
ds_read_b64_tr_b16 v[50:51], v178 offset:33792
buffer_load_dwordx4 v3, s[16:19], s53 offen offset:3072 lds
s_add_u32 s60, s60, 32768
s_cmp_ge_u32 s60, 294912
s_cselect_b32 s60, 0, s60
s_add_u32 s75, s60, 18874368
s_waitcnt lgkmcnt(4)
v_mfma_f32_32x32x16_bf16 v[32:47], v[56:59], v[96:99], v[32:47]
ds_read_b64_tr_b16 v[52:53], v178 offset:34816
ds_read_b64_tr_b16 v[54:55], v178 offset:35840
s_waitcnt lgkmcnt(4)
v_mfma_f32_32x32x16_bf16 v[32:47], v[60:63], v[100:103], v[32:47]
ds_read_b64_tr_b16 v[56:57], v179 offset:0
ds_read_b64_tr_b16 v[58:59], v179 offset:1024
s_add_u32 m0, s59, 102400
s_nop 0
buffer_load_dwordx4 v3, s[16:19], s54 offen offset:0 lds
v_bfe_u32 v224, v1, 3, 2
v_bfe_u32 v225, v1, 1, 1
v_lshl_add_u32 v224, v224, 1, v225
s_waitcnt lgkmcnt(4)
v_mfma_f32_32x32x16_bf16 v[32:47], v[48:51], v[104:107], v[32:47]
ds_read_b64_tr_b16 v[60:61], v179 offset:2048
ds_read_b64_tr_b16 v[62:63], v179 offset:3072
v_lshrrev_b32 v225, 3, v1
v_xor_b32 v225, v225, v1
s_waitcnt lgkmcnt(4)
v_mfma_f32_32x32x16_bf16 v[32:47], v[52:55], v[108:111], v[32:47]
ds_read_b64_tr_b16 v[48:49], v179 offset:8192
ds_read_b64_tr_b16 v[50:51], v179 offset:9216
buffer_load_dwordx4 v3, s[16:19], s55 offen offset:1024 lds
v_and_b32 v225, 4, v225
v_lshl_add_u32 v224, v225, 2, v224
s_waitcnt lgkmcnt(4)
v_mfma_f32_32x32x16_bf16 v[32:47], v[56:59], v[112:115], v[32:47]
ds_read_b64_tr_b16 v[52:53], v179 offset:10240
ds_read_b64_tr_b16 v[54:55], v179 offset:11264
s_add_u32 s58, s58, 128
s_cmp_ge_u32 s58, 1152
s_cselect_b32 s58, 0, s58
v_add_u32 v3, s58, v2
v_and_b32 v225, 1, v1
v_lshlrev_b32 v225, 4, v225
s_waitcnt lgkmcnt(4)
v_mfma_f32_32x32x16_bf16 v[32:47], v[60:63], v[116:119], v[32:47]
ds_read_b64_tr_b16 v[56:57], v179 offset:16384
ds_read_b64_tr_b16 v[58:59], v179 offset:17408
s_add_u32 m0, s59, 0
s_nop 0
buffer_load_dwordx4 v3, s[16:19], s50 offen offset:0 lds
v_mov_b32 v226, 0x3f80
v_lshlrev_b32 v225, v225, v226
s_waitcnt lgkmcnt(4)
v_mfma_f32_32x32x16_bf16 v[32:47], v[48:51], v[120:123], v[32:47]
ds_read_b64_tr_b16 v[60:61], v179 offset:18432
ds_read_b64_tr_b16 v[62:63], v179 offset:19456
v_cmp_eq_u32 vcc, 0, v224
s_nop 1
v_cndmask_b32 v216, 0, v225, vcc
s_waitcnt lgkmcnt(4)
v_mfma_f32_32x32x16_bf16 v[32:47], v[52:55], v[124:127], v[32:47]
ds_read_b64_tr_b16 v[48:49], v179 offset:24576
ds_read_b64_tr_b16 v[50:51], v179 offset:25600
buffer_load_dwordx4 v3, s[16:19], s51 offen offset:1024 lds
v_cmp_eq_u32 vcc, 1, v224
s_nop 1
v_cndmask_b32 v217, 0, v225, vcc
s_waitcnt lgkmcnt(4)
v_mfma_f32_32x32x16_bf16 v[32:47], v[56:59], v[128:131], v[32:47]
ds_read_b64_tr_b16 v[52:53], v179 offset:26624
ds_read_b64_tr_b16 v[54:55], v179 offset:27648
v_cmp_eq_u32 vcc, 2, v224
s_nop 1
v_cndmask_b32 v218, 0, v225, vcc
s_waitcnt lgkmcnt(4)
v_mfma_f32_32x32x16_bf16 v[32:47], v[60:63], v[132:135], v[32:47]
ds_read_b64_tr_b16 v[56:57], v178 offset:40960
ds_read_b64_tr_b16 v[58:59], v178 offset:41984
buffer_load_dwordx4 v3, s[16:19], s52 offen offset:2048 lds
s_add_u32 s28, s73, 1
v_mov_b32 v204, s28
s_waitcnt vmcnt(6)
s_mov_b64 exec, 1
s_cmp_lg_u32 s70, 0
s_cbranch_scc1 L_rm13
buffer_store_dword v204, off, s[20:23], s71
s_branch L_rm13e
L_rm13:
buffer_store_dword v204, off, s[20:23], s71 sc0 sc1
L_rm13e:
s_mov_b64 exec, -1
v_cmp_eq_u32 vcc, 3, v224
s_nop 1
v_cndmask_b32 v219, 0, v225, vcc
s_waitcnt lgkmcnt(4)
v_mfma_f32_32x32x16_bf16 v[32:47], v[48:51], v[136:139], v[32:47]
ds_read_b64_tr_b16 v[60:61], v178 offset:43008
ds_read_b64_tr_b16 v[62:63], v178 offset:44032
v_cmp_eq_u32 vcc, 4, v224
s_nop 1
v_cndmask_b32 v220, 0, v225, vcc
s_waitcnt lgkmcnt(4)
v_mfma_f32_32x32x16_bf16 v[32:47], v[52:55], v[140:143], v[32:47]
ds_read_b64_tr_b16 v[48:49], v179 offset:32768
ds_read_b64_tr_b16 v[50:51], v179 offset:33792
buffer_load_dwordx4 v3, s[16:19], s53 offen offset:3072 lds
v_cmp_eq_u32 vcc, 5, v224
s_nop 1
v_cndmask_b32 v221, 0, v225, vcc
s_waitcnt lgkmcnt(4)
v_mfma_f32_32x32x16_bf16 v[32:47], v[56:59], v[160:163], v[32:47]
ds_read_b64_tr_b16 v[52:53], v179 offset:34816
ds_read_b64_tr_b16 v[54:55], v179 offset:35840
v_cmp_eq_u32 vcc, 6, v224
s_nop 1
v_cndmask_b32 v222, 0, v225, vcc
s_waitcnt lgkmcnt(4)
v_mfma_f32_32x32x16_bf16 v[32:47], v[60:63], v[164:167], v[32:47]
ds_read_b64_tr_b16 v[56:57], v179 offset:40960
ds_read_b64_tr_b16 v[58:59], v179 offset:41984
s_add_u32 m0, s59, 4096
s_nop 0
buffer_load_dwordx4 v3, s[16:19], s54 offen offset:0 lds
v_cmp_eq_u32 vcc, 7, v224
s_nop 1
v_cndmask_b32 v223, 0, v225, vcc
s_waitcnt lgkmcnt(4)
v_mfma_f32_32x32x16_bf16 v[32:47], v[48:51], v[144:147], v[32:47]
ds_read_b64_tr_b16 v[60:61], v179 offset:43008
ds_read_b64_tr_b16 v[62:63], v179 offset:44032
s_waitcnt lgkmcnt(4)
v_mfma_f32_32x32x16_bf16 v[32:47], v[52:55], v[148:151], v[32:47]
s_waitcnt vmcnt(6)
s_barrier
ds_read_b64_tr_b16 v[48:49], v180 offset:0
ds_read_b64_tr_b16 v[50:51], v180 offset:1024
buffer_load_dwordx4 v3, s[16:19], s55 offen offset:1024 lds
s_waitcnt lgkmcnt(4)
v_mfma_f32_32x32x16_bf16 v[32:47], v[56:59], v[152:155], v[32:47]
ds_read_b64_tr_b16 v[52:53], v180 offset:2048
ds_read_b64_tr_b16 v[54:55], v180 offset:3072
s_waitcnt lgkmcnt(4)
v_mfma_f32_32x32x16_bf16 v[32:47], v[60:63], v[156:159], v[32:47]
ds_read_b64_tr_b16 v[56:57], v180 offset:8192
ds_read_b64_tr_b16 v[58:59], v180 offset:9216
s_waitcnt lgkmcnt(4)
v_mfma_f32_32x32x16_bf16 v[16:31], v[48:51], v[72:75], 0
ds_read_b64_tr_b16 v[60:61], v180 offset:10240
ds_read_b64_tr_b16 v[62:63], v180 offset:11264
s_waitcnt lgkmcnt(4)
v_mfma_f32_32x32x16_bf16 v[16:31], v[52:55], v[76:79], v[16:31]
ds_read_b64_tr_b16 v[48:49], v180 offset:16384
ds_read_b64_tr_b16 v[50:51], v180 offset:17408
s_waitcnt lgkmcnt(4)
v_mfma_f32_32x32x16_bf16 v[16:31], v[56:59], v[80:83], v[16:31]
ds_read_b64_tr_b16 v[52:53], v180 offset:18432
ds_read_b64_tr_b16 v[54:55], v180 offset:19456
s_mov_b32 s12, s96
s_mov_b32 s13, s97
s_mov_b32 s14, 4718592
s_mov_b32 s15, 0x20000
s_cmp_ge_u32 s4, 2
s_cselect_b64 s[24:25], s[94:95], s[84:85]
s_movk_i32 s26, 1152
s_lshr_b32 s28, s7, 2
v_cvt_pk_bf16_f32 v168, v32, v33
v_cvt_pk_bf16_f32 v169, v34, v35
v_cvt_pk_bf16_f32 v170, v36, v37
v_cvt_pk_bf16_f32 v171, v38, v39
s_waitcnt lgkmcnt(4)
v_mfma_f32_32x32x16_bf16 v[16:31], v[60:63], v[84:87], v[16:31]
ds_read_b64_tr_b16 v[56:57], v180 offset:24576
ds_read_b64_tr_b16 v[58:59], v180 offset:25600
s_mul_i32 s28, s28, 3
s_add_u32 s28, s28, s6
s_cmp_ge_u32 s28, 9
s_cselect_b32 s29, 9, 0
s_sub_u32 s28, s28, s29
s_cmp_ge_u32 s28, 9
s_cselect_b32 s29, 9, 0
s_cmp_lg_u32 s70, 0
s_cbranch_scc1 L_rm3
buffer_store_dwordx4 v[168:171], v8, s[20:23], s75 offen offset:0
s_branch L_rm3e
L_rm3:
buffer_store_dwordx4 v[168:171], v8, s[20:23], s75 offen offset:0 sc0 sc1
L_rm3e:
v_cvt_pk_bf16_f32 v172, v40, v41
v_cvt_pk_bf16_f32 v173, v42, v43
s_waitcnt lgkmcnt(4)
v_mfma_f32_32x32x16_bf16 v[16:31], v[48:51], v[88:91], v[16:31]
ds_read_b64_tr_b16 v[60:61], v180 offset:26624
ds_read_b64_tr_b16 v[62:63], v180 offset:27648
s_sub_u32 s28, s28, s29
s_lshl_b32 s44, s28, 7
s_add_u32 s28, s28, 1
s_cmp_ge_u32 s28, 9
s_cselect_b32 s29, 9, 0
s_sub_u32 s28, s28, s29
s_lshl_b32 s45, s28, 7
v_cvt_pk_bf16_f32 v174, v44, v45
v_cvt_pk_bf16_f32 v175, v46, v47
s_cmp_lg_u32 s70, 0
s_cbranch_scc1 L_rm4
buffer_store_dwordx4 v[172:175], v8, s[20:23], s75 offen offset:1024
s_branch L_rm4e
L_rm4:
buffer_store_dwordx4 v[172:175], v8, s[20:23], s75 offen offset:1024 sc0 sc1
L_rm4e:
s_waitcnt lgkmcnt(4)
v_mfma_f32_32x32x16_bf16 v[16:31], v[52:55], v[92:95], v[16:31]
ds_read_b64_tr_b16 v[48:49], v180 offset:32768
ds_read_b64_tr_b16 v[50:51], v180 offset:33792
s_add_u32 s28, s28, 1
s_cmp_ge_u32 s28, 9
s_cselect_b32 s29, 9, 0
s_sub_u32 s28, s28, s29
s_lshl_b32 s46, s28, 7
s_add_u32 s28, s28, 1
v_and_b32 v232, 1, v1
s_add_u32 s60, s60, 32768
s_cmp_ge_u32 s60, 294912
s_cselect_b32 s60, 0, s60
s_add_u32 s75, s60, 18874368
s_waitcnt lgkmcnt(4)
v_mfma_f32_32x32x16_bf16 v[16:31], v[56:59], v[96:99], v[16:31]
ds_read_b64_tr_b16 v[52:53], v180 offset:34816
ds_read_b64_tr_b16 v[54:55], v180 offset:35840
v_lshlrev_b32 v232, 4, v232
s_movk_i32 s28, 0x3f80
v_lshlrev_b32 v232, v232, s28
v_bfe_u32 v233, v1, 1, 3
v_cmp_eq_u32 vcc, 0, v233
s_nop 1
v_cndmask_b32 v192, 0, v232, vcc
v_cmp_eq_u32 vcc, 1, v233
s_nop 1
v_cndmask_b32 v193, 0, v232, vcc
s_waitcnt lgkmcnt(4)
v_mfma_f32_32x32x16_bf16 v[16:31], v[60:63], v[100:103], v[16:31]
ds_read_b64_tr_b16 v[56:57], v181 offset:0
ds_read_b64_tr_b16 v[58:59], v181 offset:1024
v_cmp_eq_u32 vcc, 2, v233
s_nop 1
v_cndmask_b32 v194, 0, v232, vcc
v_cmp_eq_u32 vcc, 3, v233
s_nop 1
v_cndmask_b32 v195, 0, v232, vcc
v_cmp_eq_u32 vcc, 4, v233
s_nop 1
v_cndmask_b32 v196, 0, v232, vcc
s_waitcnt lgkmcnt(4)
v_mfma_f32_32x32x16_bf16 v[16:31], v[48:51], v[104:107], v[16:31]
ds_read_b64_tr_b16 v[60:61], v181 offset:2048
ds_read_b64_tr_b16 v[62:63], v181 offset:3072
v_cmp_eq_u32 vcc, 5, v233
s_nop 1
v_cndmask_b32 v197, 0, v232, vcc
v_cmp_eq_u32 vcc, 6, v233
s_nop 1
v_cndmask_b32 v198, 0, v232, vcc
v_cmp_eq_u32 vcc, 7, v233
s_nop 1
v_cndmask_b32 v199, 0, v232, vcc
v_lshrrev_b32 v234, 4, v1
v_and_b32 v235, 15, v1
s_waitcnt lgkmcnt(4)
v_mfma_f32_32x32x16_bf16 v[16:31], v[52:55], v[108:111], v[16:31]
ds_read_b64_tr_b16 v[48:49], v181 offset:8192
ds_read_b64_tr_b16 v[50:51], v181 offset:9216
s_add_u32 s58, s58, 128
s_cmp_ge_u32 s58, 1152
s_cselect_b32 s58, 0, s58
v_add_u32 v3, s58, v2
v_lshlrev_b32 v235, 4, v235
v_lshl_add_u32 v200, v234, 11, v235
s_lshl_b32 s28, s6, 2
s_add_u32 s28, s28, s4
s_mul_i32 s29, s28, 18
s_add_u32 s29, s29, s5
s_lshl_b32 s29, s29, 6
s_mov_b64 exec, 1
buffer_load_dword v205, off, s[20:23], s72 sc0 sc1
s_mov_b64 exec, -1
s_waitcnt lgkmcnt(4)
v_mfma_f32_32x32x16_bf16 v[16:31], v[56:59], v[112:115], v[16:31]
ds_read_b64_tr_b16 v[52:53], v181 offset:10240
ds_read_b64_tr_b16 v[54:55], v181 offset:11264
s_add_u32 m0, s59, 49152
s_nop 0
buffer_load_dwordx4 v3, s[16:19], s50 offen offset:0 lds
s_and_b32 s30, s7, 3
s_add_u32 s29, s29, s30
s_lshl_b32 s29, s29, 8
v_add_u32 v200, s29, v200
v_and_b32 v235, 1, v1
v_lshlrev_b32 v235, 5, v235
v_lshl_add_u32 v235, v234, 3, v235
s_waitcnt lgkmcnt(4)
v_mfma_f32_32x32x16_bf16 v[16:31], v[60:63], v[116:119], v[16:31]
ds_read_b64_tr_b16 v[56:57], v181 offset:16384
ds_read_b64_tr_b16 v[58:59], v181 offset:17408
buffer_load_dwordx4 v3, s[16:19], s51 offen offset:1024 lds
v_lshl_add_u32 v201, v233, 6, v235
s_mul_i32 s29, s3, 1536
s_add_u32 s29, s29, 147456
v_add_u32 v201, s29, v201
s_lshl_b32 s29, s5, 6
v_add_u32 v235, s29, v235
v_add_u32 v202, 159744, v235
s_waitcnt lgkmcnt(4)
v_mfma_f32_32x32x16_bf16 v[16:31], v[48:51], v[120:123], v[16:31]
ds_read_b64_tr_b16 v[60:61], v181 offset:18432
ds_read_b64_tr_b16 v[62:63], v181 offset:19456
buffer_load_dwordx4 v3, s[16:19], s52 offen offset:2048 lds
s_lshl_b32 s28, s28, 2
s_add_u32 s28, s28, s30
s_lshl_b32 s28, s28, 3
v_add_u32 v233, s28, v233
v_mul_u32_u24 v203, 1152, v233
v_add_u32 v203, v203, v235
v_lshlrev_b32 v203, 1, v203
s_waitcnt lgkmcnt(4)
v_mfma_f32_32x32x16_bf16 v[16:31], v[52:55], v[124:127], v[16:31]
ds_read_b64_tr_b16 v[48:49], v181 offset:24576
ds_read_b64_tr_b16 v[50:51], v181 offset:25600
buffer_load_dwordx4 v3, s[16:19], s53 offen offset:3072 lds
v_and_b32 v233, 127, v233
v_lshlrev_b32 v233, 3, v233
s_mul_i32 s31, s28, 1152
s_add_u32 s31, s31, s29
s_lshl_b32 s28, s2, 10
s_add_u32 s28, s28, 37748736
buffer_load_dwordx2 v[206:207], v233, s[20:23], s28 offen
s_waitcnt lgkmcnt(4)
v_mfma_f32_32x32x16_bf16 v[16:31], v[56:59], v[128:131], v[16:31]
ds_read_b64_tr_b16 v[52:53], v181 offset:26624
ds_read_b64_tr_b16 v[54:55], v181 offset:27648
s_add_u32 m0, s59, 53248
s_nop 0
buffer_load_dwordx4 v3, s[16:19], s54 offen offset:0 lds
s_waitcnt lgkmcnt(4)
v_mfma_f32_32x32x16_bf16 v[16:31], v[60:63], v[132:135], v[16:31]
ds_read_b64_tr_b16 v[56:57], v180 offset:40960
ds_read_b64_tr_b16 v[58:59], v180 offset:41984
buffer_load_dwordx4 v3, s[16:19], s55 offen offset:1024 lds
s_add_u32 s28, s73, 2
v_mov_b32 v204, s28
s_waitcnt vmcnt(8)
s_mov_b64 exec, 1
s_cmp_lg_u32 s70, 0
s_cbranch_scc1 L_rm14
buffer_store_dword v204, off, s[20:23], s71
s_branch L_rm14e
L_rm14:
buffer_store_dword v204, off, s[20:23], s71 sc0 sc1
L_rm14e:
s_mov_b64 exec, -1
s_waitcnt lgkmcnt(4)
v_mfma_f32_32x32x16_bf16 v[16:31], v[48:51], v[136:139], v[16:31]
ds_read_b64_tr_b16 v[60:61], v180 offset:43008
ds_read_b64_tr_b16 v[62:63], v180 offset:44032
s_waitcnt lgkmcnt(4)
v_mfma_f32_32x32x16_bf16 v[16:31], v[52:55], v[140:143], v[16:31]
ds_read_b64_tr_b16 v[48:49], v181 offset:32768
ds_read_b64_tr_b16 v[50:51], v181 offset:33792
s_waitcnt lgkmcnt(4)
v_mfma_f32_32x32x16_bf16 v[16:31], v[56:59], v[160:163], v[16:31]
ds_read_b64_tr_b16 v[52:53], v181 offset:34816
ds_read_b64_tr_b16 v[54:55], v181 offset:35840
s_waitcnt lgkmcnt(4)
v_mfma_f32_32x32x16_bf16 v[16:31], v[60:63], v[164:167], v[16:31]
ds_read_b64_tr_b16 v[56:57], v181 offset:40960
ds_read_b64_tr_b16 v[58:59], v181 offset:41984
s_waitcnt lgkmcnt(4)
v_mfma_f32_32x32x16_bf16 v[16:31], v[48:51], v[144:147], v[16:31]
ds_read_b64_tr_b16 v[60:61], v181 offset:43008
ds_read_b64_tr_b16 v[62:63], v181 offset:44032
v_bfe_u32 v236, v1, 2, 3
v_mul_u32_u24 v236, 1152, v236
v_and_b32 v237, 3, v1
v_lshl_add_u32 v236, v237, 4, v236
s_sub_u32 s28, s45, s44
v_lshrrev_b32 v237, 5, v1
v_mul_i32_i24 v237, s28, v237
v_add3_u32 v237, v237, s44, v236
s_mul_i32 s29, s3, 1536
s_add_u32 m0, s29, 147456
s_nop 0
buffer_load_dwordx4 v237, s[8:11], s31 offen lds
s_add_u32 s28, s31, s46
s_add_u32 m0, s29, 148480
s_mov_b32 exec_hi, 0
buffer_load_dwordx4 v236, s[8:11], s28 offen lds
s_mov_b64 exec, -1
v_lshlrev_b32 v238, 4, v1
s_and_b32 s28, s3, 1
s_lshl_b32 s28, s28, 10
s_lshl_b32 s29, s4, 10
s_add_u32 m0, s29, 159744
s_nop 0
buffer_load_dwordx4 v238, s[24:27], s28 offen lds
s_waitcnt lgkmcnt(4)
v_mfma_f32_32x32x16_bf16 v[16:31], v[52:55], v[148:151], v[16:31]
s_barrier
ds_read_b64_tr_b16 v[48:49], v176 offset:0
ds_read_b64_tr_b16 v[50:51], v176 offset:1024
s_waitcnt lgkmcnt(4)
v_mfma_f32_32x32x16_bf16 v[16:31], v[56:59], v[152:155], v[16:31]
ds_read_b64_tr_b16 v[52:53], v176 offset:2048
ds_read_b64_tr_b16 v[54:55], v176 offset:3072
s_waitcnt lgkmcnt(4)
v_mfma_f32_32x32x16_bf16 v[16:31], v[60:63], v[156:159], v[16:31]
ds_read_b64_tr_b16 v[56:57], v176 offset:8192
ds_read_b64_tr_b16 v[58:59], v176 offset:9216
s_waitcnt lgkmcnt(4)
v_mfma_f32_32x32x16_bf16 v[32:47], v[48:51], v[72:75], 0
ds_read_b64_tr_b16 v[60:61], v176 offset:10240
ds_read_b64_tr_b16 v[62:63], v176 offset:11264
s_waitcnt vmcnt(11)
s_movk_i32 s29, 0x4000
v_readfirstlane_b32 s28, v205
s_and_b32 s28, s28, 15
s_cmp_lt_u32 s28, 1
s_cbranch_scc0 L_rm19d
L_rm19:
s_mov_b64 exec, 1
buffer_load_dword v205, off, s[20:23], s72 sc0 sc1
s_mov_b64 exec, -1
s_waitcnt vmcnt(0)
s_sub_u32 s29, s29, 1
s_cbranch_scc1 L_rm19d
v_readfirstlane_b32 s28, v205
s_and_b32 s28, s28, 15
s_cmp_lt_u32 s28, 1
s_cbranch_scc1 L_rm19
L_rm19d:
s_add_u32 s30, s60, 32768
s_cmp_ge_u32 s30, 294912
s_cselect_b32 s31, 294912, 0
s_sub_u32 s30, s30, s31
s_add_u32 s30, s30, 18874368
buffer_load_dwordx4 v[208:211], v8, s[20:23], s30 offen offset:0 sc0 sc1
buffer_load_dwordx4 v[212:215], v8, s[20:23], s30 offen offset:1024 sc0 sc1
s_waitcnt lgkmcnt(4)
v_mfma_f32_32x32x16_bf16 v[32:47], v[52:55], v[76:79], v[32:47]
ds_read_b64_tr_b16 v[48:49], v176 offset:16384
ds_read_b64_tr_b16 v[50:51], v176 offset:17408
s_waitcnt lgkmcnt(4)
v_mfma_f32_32x32x16_bf16 v[32:47], v[56:59], v[80:83], v[32:47]
ds_read_b64_tr_b16 v[52:53], v176 offset:18432
ds_read_b64_tr_b16 v[54:55], v176 offset:19456
v_cvt_pk_bf16_f32 v168, v16, v17
v_cvt_pk_bf16_f32 v169, v18, v19
v_cvt_pk_bf16_f32 v170, v20, v21
v_cvt_pk_bf16_f32 v171, v22, v23
s_waitcnt lgkmcnt(4)
v_mfma_f32_32x32x16_bf16 v[32:47], v[60:63], v[84:87], v[32:47]
ds_read_b64_tr_b16 v[56:57], v176 offset:24576
ds_read_b64_tr_b16 v[58:59], v176 offset:25600
s_cmp_lg_u32 s70, 0
s_cbranch_scc1 L_rm5
buffer_store_dwordx4 v[168:171], v8, s[20:23], s75 offen offset:0
s_branch L_rm5e
L_rm5:
buffer_store_dwordx4 v[168:171], v8, s[20:23], s75 offen offset:0 sc0 sc1
L_rm5e:
v_cvt_pk_bf16_f32 v172, v24, v25
v_cvt_pk_bf16_f32 v173, v26, v27
s_waitcnt lgkmcnt(4)
v_mfma_f32_32x32x16_bf16 v[32:47], v[48:51], v[88:91], v[32:47]
ds_read_b64_tr_b16 v[60:61], v176 offset:26624
ds_read_b64_tr_b16 v[62:63], v176 offset:27648
v_cvt_pk_bf16_f32 v174, v28, v29
v_cvt_pk_bf16_f32 v175, v30, v31
s_cmp_lg_u32 s70, 0
s_cbranch_scc1 L_rm6
buffer_store_dwordx4 v[172:175], v8, s[20:23], s75 offen offset:1024
s_branch L_rm6e
L_rm6:
buffer_store_dwordx4 v[172:175], v8, s[20:23], s75 offen offset:1024 sc0 sc1
L_rm6e:
s_waitcnt lgkmcnt(4)
v_mfma_f32_32x32x16_bf16 v[32:47], v[52:55], v[92:95], v[32:47]
ds_read_b64_tr_b16 v[48:49], v176 offset:32768
ds_read_b64_tr_b16 v[50:51], v176 offset:33792
s_add_u32 s60, s60, 32768
s_cmp_ge_u32 s60, 294912
s_cselect_b32 s60, 0, s60
s_add_u32 s75, s60, 18874368
s_waitcnt lgkmcnt(4)
v_mfma_f32_32x32x16_bf16 v[32:47], v[56:59], v[96:99], v[32:47]
ds_read_b64_tr_b16 v[52:53], v176 offset:34816
ds_read_b64_tr_b16 v[54:55], v176 offset:35840
s_waitcnt lgkmcnt(4)
v_mfma_f32_32x32x16_bf16 v[32:47], v[60:63], v[100:103], v[32:47]
ds_read_b64_tr_b16 v[56:57], v177 offset:0
ds_read_b64_tr_b16 v[58:59], v177 offset:1024
s_waitcnt lgkmcnt(4)
v_mfma_f32_32x32x16_bf16 v[32:47], v[48:51], v[104:107], v[32:47]
ds_read_b64_tr_b16 v[60:61], v177 offset:2048
ds_read_b64_tr_b16 v[62:63], v177 offset:3072
s_waitcnt lgkmcnt(4)
v_mfma_f32_32x32x16_bf16 v[32:47], v[52:55], v[108:111], v[32:47]
ds_read_b64_tr_b16 v[48:49], v177 offset:8192
ds_read_b64_tr_b16 v[50:51], v177 offset:9216
s_add_u32 s58, s58, 128
s_cmp_ge_u32 s58, 1152
s_cselect_b32 s58, 0, s58
v_add_u32 v3, s58, v2
s_mov_b64 exec, 1
buffer_load_dword v205, off, s[20:23], s72 sc0 sc1
s_mov_b64 exec, -1
s_waitcnt lgkmcnt(4)
v_mfma_f32_32x32x16_bf16 v[32:47], v[56:59], v[112:115], v[32:47]
ds_read_b64_tr_b16 v[52:53], v177 offset:10240
ds_read_b64_tr_b16 v[54:55], v177 offset:11264
s_add_u32 m0, s59, 98304
s_nop 0
buffer_load_dwordx4 v3, s[16:19], s50 offen offset:0 lds
s_waitcnt lgkmcnt(4)
v_mfma_f32_32x32x16_bf16 v[32:47], v[60:63], v[116:119], v[32:47]
ds_read_b64_tr_b16 v[56:57], v177 offset:16384
ds_read_b64_tr_b16 v[58:59], v177 offset:17408
buffer_load_dwordx4 v3, s[16:19], s51 offen offset:1024 lds
s_waitcnt lgkmcnt(4)
v_mfma_f32_32x32x16_bf16 v[32:47], v[48:51], v[120:123], v[32:47]
ds_read_b64_tr_b16 v[60:61], v177 offset:18432
ds_read_b64_tr_b16 v[62:63], v177 offset:19456
buffer_load_dwordx4 v3, s[16:19], s52 offen offset:2048 lds
s_waitcnt lgkmcnt(4)
v_mfma_f32_32x32x16_bf16 v[32:47], v[52:55], v[124:127], v[32:47]
ds_read_b64_tr_b16 v[48:49], v177 offset:24576
ds_read_b64_tr_b16 v[50:51], v177 offset:25600
buffer_load_dwordx4 v3, s[16:19], s53 offen offset:3072 lds
s_waitcnt lgkmcnt(4)
v_mfma_f32_32x32x16_bf16 v[32:47], v[56:59], v[128:131], v[32:47]
ds_read_b64_tr_b16 v[52:53], v177 offset:26624
ds_read_b64_tr_b16 v[54:55], v177 offset:27648
s_add_u32 m0, s59, 102400
s_nop 0
buffer_load_dwordx4 v3, s[16:19], s54 offen offset:0 lds
s_waitcnt lgkmcnt(4)
v_mfma_f32_32x32x16_bf16 v[32:47], v[60:63], v[132:135], v[32:47]
ds_read_b64_tr_b16 v[56:57], v176 offset:40960
ds_read_b64_tr_b16 v[58:59], v176 offset:41984
buffer_load_dwordx4 v3, s[16:19], s55 offen offset:1024 lds
s_add_u32 s28, s73, 3
v_mov_b32 v204, s28
s_waitcnt vmcnt(7)
s_mov_b64 exec, 1
s_cmp_lg_u32 s70, 0
s_cbranch_scc1 L_rm15
buffer_store_dword v204, off, s[20:23], s71
s_branch L_rm15e
L_rm15:
buffer_store_dword v204, off, s[20:23], s71 sc0 sc1
L_rm15e:
s_mov_b64 exec, -1
s_waitcnt lgkmcnt(4)
v_mfma_f32_32x32x16_bf16 v[32:47], v[48:51], v[136:139], v[32:47]
ds_read_b64_tr_b16 v[60:61], v176 offset:43008
ds_read_b64_tr_b16 v[62:63], v176 offset:44032
s_waitcnt lgkmcnt(4)
v_mfma_f32_32x32x16_bf16 v[32:47], v[52:55], v[140:143], v[32:47]
ds_read_b64_tr_b16 v[48:49], v177 offset:32768
ds_read_b64_tr_b16 v[50:51], v177 offset:33792
v_mfma_f32_32x32x16_bf16 v[32:47], v[216:219], v[208:211], v[32:47]
s_waitcnt lgkmcnt(4)
v_mfma_f32_32x32x16_bf16 v[32:47], v[56:59], v[160:163], v[32:47]
ds_read_b64_tr_b16 v[52:53], v177 offset:34816
ds_read_b64_tr_b16 v[54:55], v177 offset:35840
s_waitcnt lgkmcnt(4)
v_mfma_f32_32x32x16_bf16 v[32:47], v[60:63], v[164:167], v[32:47]
ds_read_b64_tr_b16 v[56:57], v177 offset:40960
ds_read_b64_tr_b16 v[58:59], v177 offset:41984
v_mfma_f32_32x32x16_bf16 v[32:47], v[220:223], v[212:215], v[32:47]
s_waitcnt lgkmcnt(4)
v_mfma_f32_32x32x16_bf16 v[32:47], v[48:51], v[144:147], v[32:47]
ds_read_b64_tr_b16 v[60:61], v177 offset:43008
ds_read_b64_tr_b16 v[62:63], v177 offset:44032
s_waitcnt lgkmcnt(4)
v_mfma_f32_32x32x16_bf16 v[32:47], v[52:55], v[148:151], v[32:47]
s_barrier
ds_read_b64_tr_b16 v[48:49], v178 offset:0
ds_read_b64_tr_b16 v[50:51], v178 offset:1024
s_waitcnt lgkmcnt(4)
v_mfma_f32_32x32x16_bf16 v[32:47], v[56:59], v[152:155], v[32:47]
ds_read_b64_tr_b16 v[52:53], v178 offset:2048
ds_read_b64_tr_b16 v[54:55], v178 offset:3072
s_waitcnt lgkmcnt(4)
v_mfma_f32_32x32x16_bf16 v[32:47], v[60:63], v[156:159], v[32:47]
ds_read_b64_tr_b16 v[56:57], v178 offset:8192
ds_read_b64_tr_b16 v[58:59], v178 offset:9216
s_waitcnt lgkmcnt(4)
v_mfma_f32_32x32x16_bf16 v[16:31], v[48:51], v[72:75], 0
ds_read_b64_tr_b16 v[60:61], v178 offset:10240
ds_read_b64_tr_b16 v[62:63], v178 offset:11264
s_waitcnt vmcnt(7)
s_movk_i32 s29, 0x4000
v_readfirstlane_b32 s28, v205
s_and_b32 s28, s28, 15
s_cmp_lt_u32 s28, 2
s_cbranch_scc0 L_rm20d
L_rm20:
s_mov_b64 exec, 1
buffer_load_dword v205, off, s[20:23], s72 sc0 sc1
s_mov_b64 exec, -1
s_waitcnt vmcnt(0)
s_sub_u32 s29, s29, 1
s_cbranch_scc1 L_rm20d
v_readfirstlane_b32 s28, v205
s_and_b32 s28, s28, 15
s_cmp_lt_u32 s28, 2
s_cbranch_scc1 L_rm20
L_rm20d:
s_add_u32 s30, s60, 32768
s_cmp_ge_u32 s30, 294912
s_cselect_b32 s31, 294912, 0
s_sub_u32 s30, s30, s31
s_add_u32 s30, s30, 18874368
buffer_load_dwordx4 v[208:211], v8, s[20:23], s30 offen offset:0 sc0 sc1
buffer_load_dwordx4 v[212:215], v8, s[20:23], s30 offen offset:1024 sc0 sc1
s_waitcnt lgkmcnt(4)
v_mfma_f32_32x32x16_bf16 v[16:31], v[52:55], v[76:79], v[16:31]
ds_read_b64_tr_b16 v[48:49], v178 offset:16384
ds_read_b64_tr_b16 v[50:51], v178 offset:17408
s_waitcnt lgkmcnt(4)
v_mfma_f32_32x32x16_bf16 v[16:31], v[56:59], v[80:83], v[16:31]
ds_read_b64_tr_b16 v[52:53], v178 offset:18432
ds_read_b64_tr_b16 v[54:55], v178 offset:19456
v_cvt_pk_bf16_f32 v168, v32, v33
v_cvt_pk_bf16_f32 v169, v34, v35
v_cvt_pk_bf16_f32 v170, v36, v37
v_cvt_pk_bf16_f32 v171, v38, v39
s_waitcnt lgkmcnt(4)
v_mfma_f32_32x32x16_bf16 v[16:31], v[60:63], v[84:87], v[16:31]
ds_read_b64_tr_b16 v[56:57], v178 offset:24576
ds_read_b64_tr_b16 v[58:59], v178 offset:25600
s_cmp_lg_u32 s70, 0
s_cbranch_scc1 L_rm7
buffer_store_dwordx4 v[168:171], v8, s[20:23], s75 offen offset:0
s_branch L_rm7e
L_rm7:
buffer_store_dwordx4 v[168:171], v8, s[20:23], s75 offen offset:0 sc0 sc1
L_rm7e:
v_cvt_pk_bf16_f32 v172, v40, v41
v_cvt_pk_bf16_f32 v173, v42, v43
s_waitcnt lgkmcnt(4)
v_mfma_f32_32x32x16_bf16 v[16:31], v[48:51], v[88:91], v[16:31]
ds_read_b64_tr_b16 v[60:61], v178 offset:26624
ds_read_b64_tr_b16 v[62:63], v178 offset:27648
v_cvt_pk_bf16_f32 v174, v44, v45
v_cvt_pk_bf16_f32 v175, v46, v47
s_cmp_lg_u32 s70, 0
s_cbranch_scc1 L_rm8
buffer_store_dwordx4 v[172:175], v8, s[20:23], s75 offen offset:1024
s_branch L_rm8e
L_rm8:
buffer_store_dwordx4 v[172:175], v8, s[20:23], s75 offen offset:1024 sc0 sc1
L_rm8e:
s_waitcnt lgkmcnt(4)
v_mfma_f32_32x32x16_bf16 v[16:31], v[52:55], v[92:95], v[16:31]
ds_read_b64_tr_b16 v[48:49], v178 offset:32768
ds_read_b64_tr_b16 v[50:51], v178 offset:33792
s_add_u32 s60, s60, 32768
s_cmp_ge_u32 s60, 294912
s_cselect_b32 s60, 0, s60
s_add_u32 s75, s60, 18874368
s_waitcnt lgkmcnt(4)
v_mfma_f32_32x32x16_bf16 v[16:31], v[56:59], v[96:99], v[16:31]
ds_read_b64_tr_b16 v[52:53], v178 offset:34816
ds_read_b64_tr_b16 v[54:55], v178 offset:35840
s_waitcnt lgkmcnt(4)
v_mfma_f32_32x32x16_bf16 v[16:31], v[60:63], v[100:103], v[16:31]
ds_read_b64_tr_b16 v[56:57], v179 offset:0
ds_read_b64_tr_b16 v[58:59], v179 offset:1024
s_waitcnt lgkmcnt(4)
v_mfma_f32_32x32x16_bf16 v[16:31], v[48:51], v[104:107], v[16:31]
ds_read_b64_tr_b16 v[60:61], v179 offset:2048
ds_read_b64_tr_b16 v[62:63], v179 offset:3072
s_waitcnt lgkmcnt(4)
v_mfma_f32_32x32x16_bf16 v[16:31], v[52:55], v[108:111], v[16:31]
ds_read_b64_tr_b16 v[48:49], v179 offset:8192
ds_read_b64_tr_b16 v[50:51], v179 offset:9216
s_add_u32 s58, s58, 128
s_cmp_ge_u32 s58, 1152
s_cselect_b32 s58, 0, s58
v_add_u32 v3, s58, v2
s_mov_b64 exec, 1
buffer_load_dword v205, off, s[20:23], s72 sc0 sc1
s_mov_b64 exec, -1
s_waitcnt lgkmcnt(4)
v_mfma_f32_32x32x16_bf16 v[16:31], v[56:59], v[112:115], v[16:31]
ds_read_b64_tr_b16 v[52:53], v179 offset:10240
ds_read_b64_tr_b16 v[54:55], v179 offset:11264
s_add_u32 m0, s59, 0
s_nop 0
buffer_load_dwordx4 v3, s[16:19], s50 offen offset:0 lds
s_waitcnt lgkmcnt(4)
v_mfma_f32_32x32x16_bf16 v[16:31], v[60:63], v[116:119], v[16:31]
ds_read_b64_tr_b16 v[56:57], v179 offset:16384
ds_read_b64_tr_b16 v[58:59], v179 offset:17408
buffer_load_dwordx4 v3, s[16:19], s51 offen offset:1024 lds
s_waitcnt lgkmcnt(4)
v_mfma_f32_32x32x16_bf16 v[16:31], v[48:51], v[120:123], v[16:31]
ds_read_b64_tr_b16 v[60:61], v179 offset:18432
ds_read_b64_tr_b16 v[62:63], v179 offset:19456
buffer_load_dwordx4 v3, s[16:19], s52 offen offset:2048 lds
s_waitcnt lgkmcnt(4)
v_mfma_f32_32x32x16_bf16 v[16:31], v[52:55], v[124:127], v[16:31]
ds_read_b64_tr_b16 v[48:49], v179 offset:24576
ds_read_b64_tr_b16 v[50:51], v179 offset:25600
buffer_load_dwordx4 v3, s[16:19], s53 offen offset:3072 lds
s_waitcnt lgkmcnt(4)
v_mfma_f32_32x32x16_bf16 v[16:31], v[56:59], v[128:131], v[16:31]
ds_read_b64_tr_b16 v[52:53], v179 offset:26624
ds_read_b64_tr_b16 v[54:55], v179 offset:27648
s_add_u32 m0, s59, 4096
s_nop 0
buffer_load_dwordx4 v3, s[16:19], s54 offen offset:0 lds
s_waitcnt lgkmcnt(4)
v_mfma_f32_32x32x16_bf16 v[16:31], v[60:63], v[132:135], v[16:31]
ds_read_b64_tr_b16 v[56:57], v178 offset:40960
ds_read_b64_tr_b16 v[58:59], v178 offset:41984
buffer_load_dwordx4 v3, s[16:19], s55 offen offset:1024 lds
s_add_u32 s28, s73, 4
v_mov_b32 v204, s28
s_waitcnt vmcnt(7)
s_mov_b64 exec, 1
s_cmp_lg_u32 s70, 0
s_cbranch_scc1 L_rm16
buffer_store_dword v204, off, s[20:23], s71
s_branch L_rm16e
L_rm16:
buffer_store_dword v204, off, s[20:23], s71 sc0 sc1
L_rm16e:
s_mov_b64 exec, -1
s_waitcnt lgkmcnt(4)
v_mfma_f32_32x32x16_bf16 v[16:31], v[48:51], v[136:139], v[16:31]
ds_read_b64_tr_b16 v[60:61], v178 offset:43008
ds_read_b64_tr_b16 v[62:63], v178 offset:44032
s_waitcnt lgkmcnt(4)
v_mfma_f32_32x32x16_bf16 v[16:31], v[52:55], v[140:143], v[16:31]
ds_read_b64_tr_b16 v[48:49], v179 offset:32768
ds_read_b64_tr_b16 v[50:51], v179 offset:33792
v_mfma_f32_32x32x16_bf16 v[16:31], v[216:219], v[208:211], v[16:31]
s_waitcnt lgkmcnt(4)
v_mfma_f32_32x32x16_bf16 v[16:31], v[56:59], v[160:163], v[16:31]
ds_read_b64_tr_b16 v[52:53], v179 offset:34816
ds_read_b64_tr_b16 v[54:55], v179 offset:35840
s_waitcnt lgkmcnt(4)
v_mfma_f32_32x32x16_bf16 v[16:31], v[60:63], v[164:167], v[16:31]
ds_read_b64_tr_b16 v[56:57], v179 offset:40960
ds_read_b64_tr_b16 v[58:59], v179 offset:41984
v_mfma_f32_32x32x16_bf16 v[16:31], v[220:223], v[212:215], v[16:31]
s_waitcnt lgkmcnt(4)
v_mfma_f32_32x32x16_bf16 v[16:31], v[48:51], v[144:147], v[16:31]
ds_read_b64_tr_b16 v[60:61], v179 offset:43008
ds_read_b64_tr_b16 v[62:63], v179 offset:44032
s_waitcnt lgkmcnt(4)
v_mfma_f32_32x32x16_bf16 v[16:31], v[52:55], v[148:151], v[16:31]
s_barrier
ds_read_b64_tr_b16 v[48:49], v180 offset:0
ds_read_b64_tr_b16 v[50:51], v180 offset:1024
s_waitcnt lgkmcnt(4)
v_mfma_f32_32x32x16_bf16 v[16:31], v[56:59], v[152:155], v[16:31]
ds_read_b64_tr_b16 v[52:53], v180 offset:2048
ds_read_b64_tr_b16 v[54:55], v180 offset:3072
s_waitcnt lgkmcnt(4)
v_mfma_f32_32x32x16_bf16 v[16:31], v[60:63], v[156:159], v[16:31]
ds_read_b64_tr_b16 v[56:57], v180 offset:8192
ds_read_b64_tr_b16 v[58:59], v180 offset:9216
s_waitcnt lgkmcnt(4)
v_mfma_f32_32x32x16_bf16 v[32:47], v[48:51], v[72:75], 0
ds_read_b64_tr_b16 v[60:61], v180 offset:10240
ds_read_b64_tr_b16 v[62:63], v180 offset:11264
s_waitcnt vmcnt(7)
s_movk_i32 s29, 0x4000
v_readfirstlane_b32 s28, v205
s_and_b32 s28, s28, 15
s_cmp_lt_u32 s28, 3
s_cbranch_scc0 L_rm21d
L_rm21:
s_mov_b64 exec, 1
buffer_load_dword v205, off, s[20:23], s72 sc0 sc1
s_mov_b64 exec, -1
s_waitcnt vmcnt(0)
s_sub_u32 s29, s29, 1
s_cbranch_scc1 L_rm21d
v_readfirstlane_b32 s28, v205
s_and_b32 s28, s28, 15
s_cmp_lt_u32 s28, 3
s_cbranch_scc1 L_rm21
L_rm21d:
s_add_u32 s30, s60, 32768
s_cmp_ge_u32 s30, 294912
s_cselect_b32 s31, 294912, 0
s_sub_u32 s30, s30, s31
s_add_u32 s30, s30, 18874368
buffer_load_dwordx4 v[208:211], v8, s[20:23], s30 offen offset:0 sc0 sc1
buffer_load_dwordx4 v[212:215], v8, s[20:23], s30 offen offset:1024 sc0 sc1
s_waitcnt lgkmcnt(4)
v_mfma_f32_32x32x16_bf16 v[32:47], v[52:55], v[76:79], v[32:47]
ds_read_b64_tr_b16 v[48:49], v180 offset:16384
ds_read_b64_tr_b16 v[50:51], v180 offset:17408
s_waitcnt lgkmcnt(4)
v_mfma_f32_32x32x16_bf16 v[32:47], v[56:59], v[80:83], v[32:47]
ds_read_b64_tr_b16 v[52:53], v180 offset:18432
ds_read_b64_tr_b16 v[54:55], v180 offset:19456
v_cvt_pk_bf16_f32 v168, v16, v17
v_cvt_pk_bf16_f32 v169, v18, v19
v_cvt_pk_bf16_f32 v170, v20, v21
v_cvt_pk_bf16_f32 v171, v22, v23
s_waitcnt lgkmcnt(4)
v_mfma_f32_32x32x16_bf16 v[32:47], v[60:63], v[84:87], v[32:47]
ds_read_b64_tr_b16 v[56:57], v180 offset:24576
ds_read_b64_tr_b16 v[58:59], v180 offset:25600
s_cmp_lg_u32 s70, 0
s_cbranch_scc1 L_rm9
buffer_store_dwordx4 v[168:171], v8, s[20:23], s75 offen offset:0
s_branch L_rm9e
L_rm9:
buffer_store_dwordx4 v[168:171], v8, s[20:23], s75 offen offset:0 sc0 sc1
L_rm9e:
v_cvt_pk_bf16_f32 v172, v24, v25
v_cvt_pk_bf16_f32 v173, v26, v27
s_waitcnt lgkmcnt(4)
v_mfma_f32_32x32x16_bf16 v[32:47], v[48:51], v[88:91], v[32:47]
ds_read_b64_tr_b16 v[60:61], v180 offset:26624
ds_read_b64_tr_b16 v[62:63], v180 offset:27648
v_cvt_pk_bf16_f32 v174, v28, v29
v_cvt_pk_bf16_f32 v175, v30, v31
s_cmp_lg_u32 s70, 0
s_cbranch_scc1 L_rm10
buffer_store_dwordx4 v[172:175], v8, s[20:23], s75 offen offset:1024
s_branch L_rm10e
L_rm10:
buffer_store_dwordx4 v[172:175], v8, s[20:23], s75 offen offset:1024 sc0 sc1
L_rm10e:
s_waitcnt lgkmcnt(4)
v_mfma_f32_32x32x16_bf16 v[32:47], v[52:55], v[92:95], v[32:47]
ds_read_b64_tr_b16 v[48:49], v180 offset:32768
ds_read_b64_tr_b16 v[50:51], v180 offset:33792
s_add_u32 s60, s60, 32768
s_cmp_ge_u32 s60, 294912
s_cselect_b32 s60, 0, s60
s_add_u32 s75, s60, 18874368
s_waitcnt lgkmcnt(4)
v_mfma_f32_32x32x16_bf16 v[32:47], v[56:59], v[96:99], v[32:47]
ds_read_b64_tr_b16 v[52:53], v180 offset:34816
ds_read_b64_tr_b16 v[54:55], v180 offset:35840
s_waitcnt lgkmcnt(4)
v_mfma_f32_32x32x16_bf16 v[32:47], v[60:63], v[100:103], v[32:47]
ds_read_b64_tr_b16 v[56:57], v181 offset:0
ds_read_b64_tr_b16 v[58:59], v181 offset:1024
s_waitcnt lgkmcnt(4)
v_mfma_f32_32x32x16_bf16 v[32:47], v[48:51], v[104:107], v[32:47]
ds_read_b64_tr_b16 v[60:61], v181 offset:2048
ds_read_b64_tr_b16 v[62:63], v181 offset:3072
s_mov_b32 s24, s98
s_mov_b32 s25, s99
s_mov_b32 s26, 256
s_mov_b32 s27, 0x20000
s_waitcnt lgkmcnt(4)
v_mfma_f32_32x32x16_bf16 v[32:47], v[52:55], v[108:111], v[32:47]
ds_read_b64_tr_b16 v[48:49], v181 offset:8192
ds_read_b64_tr_b16 v[50:51], v181 offset:9216
s_cmp_lg_u32 s3, 0
s_cbranch_scc1 L_hs3
v_lshlrev_b32 v12, 2, v1
buffer_load_dword v13, v12, s[24:27], 0 offen sc0 sc1
L_hs3:
s_add_u32 s58, s58, 128
s_cmp_ge_u32 s58, 1152
s_cselect_b32 s58, 0, s58
v_add_u32 v3, s58, v2
s_mov_b64 exec, 1
buffer_load_dword v205, off, s[20:23], s72 sc0 sc1
s_mov_b64 exec, -1
s_waitcnt lgkmcnt(4)
v_mfma_f32_32x32x16_bf16 v[32:47], v[56:59], v[112:115], v[32:47]
ds_read_b64_tr_b16 v[52:53], v181 offset:10240
ds_read_b64_tr_b16 v[54:55], v181 offset:11264
s_add_u32 m0, s59, 49152
s_nop 0
buffer_load_dwordx4 v3, s[16:19], s50 offen offset:0 lds
s_waitcnt lgkmcnt(4)
v_mfma_f32_32x32x16_bf16 v[32:47], v[60:63], v[116:119], v[32:47]
ds_read_b64_tr_b16 v[56:57], v181 offset:16384
ds_read_b64_tr_b16 v[58:59], v181 offset:17408
buffer_load_dwordx4 v3, s[16:19], s51 offen offset:1024 lds
s_waitcnt lgkmcnt(4)
v_mfma_f32_32x32x16_bf16 v[32:47], v[48:51], v[120:123], v[32:47]
ds_read_b64_tr_b16 v[60:61], v181 offset:18432
ds_read_b64_tr_b16 v[62:63], v181 offset:19456
buffer_load_dwordx4 v3, s[16:19], s52 offen offset:2048 lds
s_waitcnt lgkmcnt(4)
v_mfma_f32_32x32x16_bf16 v[32:47], v[52:55], v[124:127], v[32:47]
ds_read_b64_tr_b16 v[48:49], v181 offset:24576
ds_read_b64_tr_b16 v[50:51], v181 offset:25600
buffer_load_dwordx4 v3, s[16:19], s53 offen offset:3072 lds
s_waitcnt lgkmcnt(4)
v_mfma_f32_32x32x16_bf16 v[32:47], v[56:59], v[128:131], v[32:47]
ds_read_b64_tr_b16 v[52:53], v181 offset:26624
ds_read_b64_tr_b16 v[54:55], v181 offset:27648
s_add_u32 m0, s59, 53248
s_nop 0
buffer_load_dwordx4 v3, s[16:19], s54 offen offset:0 lds
s_waitcnt lgkmcnt(4)
v_mfma_f32_32x32x16_bf16 v[32:47], v[60:63], v[132:135], v[32:47]
ds_read_b64_tr_b16 v[56:57], v180 offset:40960
ds_read_b64_tr_b16 v[58:59], v180 offset:41984
buffer_load_dwordx4 v3, s[16:19], s55 offen offset:1024 lds
s_add_u32 s28, s73, 5
v_mov_b32 v204, s28
s_waitcnt vmcnt(7)
s_mov_b64 exec, 1
s_cmp_lg_u32 s70, 0
s_cbranch_scc1 L_rm17
buffer_store_dword v204, off, s[20:23], s71
s_branch L_rm17e
L_rm17:
buffer_store_dword v204, off, s[20:23], s71 sc0 sc1
L_rm17e:
s_mov_b64 exec, -1
s_waitcnt lgkmcnt(4)
v_mfma_f32_32x32x16_bf16 v[32:47], v[48:51], v[136:139], v[32:47]
ds_read_b64_tr_b16 v[60:61], v180 offset:43008
ds_read_b64_tr_b16 v[62:63], v180 offset:44032
s_waitcnt lgkmcnt(4)
v_mfma_f32_32x32x16_bf16 v[32:47], v[52:55], v[140:143], v[32:47]
ds_read_b64_tr_b16 v[48:49], v181 offset:32768
ds_read_b64_tr_b16 v[50:51], v181 offset:33792
v_mfma_f32_32x32x16_bf16 v[32:47], v[216:219], v[208:211], v[32:47]
s_waitcnt lgkmcnt(4)
v_mfma_f32_32x32x16_bf16 v[32:47], v[56:59], v[160:163], v[32:47]
ds_read_b64_tr_b16 v[52:53], v181 offset:34816
ds_read_b64_tr_b16 v[54:55], v181 offset:35840
s_waitcnt lgkmcnt(4)
v_mfma_f32_32x32x16_bf16 v[32:47], v[60:63], v[164:167], v[32:47]
ds_read_b64_tr_b16 v[56:57], v181 offset:40960
ds_read_b64_tr_b16 v[58:59], v181 offset:41984
v_mfma_f32_32x32x16_bf16 v[32:47], v[220:223], v[212:215], v[32:47]
s_waitcnt lgkmcnt(4)
v_mfma_f32_32x32x16_bf16 v[32:47], v[48:51], v[144:147], v[32:47]
ds_read_b64_tr_b16 v[60:61], v181 offset:43008
ds_read_b64_tr_b16 v[62:63], v181 offset:44032
s_waitcnt lgkmcnt(4)
v_mfma_f32_32x32x16_bf16 v[32:47], v[52:55], v[148:151], v[32:47]
s_barrier
ds_read_b64_tr_b16 v[48:49], v176 offset:0
ds_read_b64_tr_b16 v[50:51], v176 offset:1024
s_waitcnt lgkmcnt(4)
v_mfma_f32_32x32x16_bf16 v[32:47], v[56:59], v[152:155], v[32:47]
ds_read_b64_tr_b16 v[52:53], v176 offset:2048
ds_read_b64_tr_b16 v[54:55], v176 offset:3072
s_waitcnt lgkmcnt(4)
v_mfma_f32_32x32x16_bf16 v[32:47], v[60:63], v[156:159], v[32:47]
ds_read_b64_tr_b16 v[56:57], v176 offset:8192
ds_read_b64_tr_b16 v[58:59], v176 offset:9216
s_waitcnt lgkmcnt(4)
v_mfma_f32_32x32x16_bf16 v[16:31], v[48:51], v[72:75], 0
ds_read_b64_tr_b16 v[60:61], v176 offset:10240
ds_read_b64_tr_b16 v[62:63], v176 offset:11264
s_waitcnt vmcnt(7)
s_movk_i32 s29, 0x4000
v_readfirstlane_b32 s28, v205
s_and_b32 s28, s28, 15
s_cmp_lt_u32 s28, 4
s_cbranch_scc0 L_rm22d
L_rm22:
s_mov_b64 exec, 1
buffer_load_dword v205, off, s[20:23], s72 sc0 sc1
s_mov_b64 exec, -1
s_waitcnt vmcnt(0)
s_sub_u32 s29, s29, 1
s_cbranch_scc1 L_rm22d
v_readfirstlane_b32 s28, v205
s_and_b32 s28, s28, 15
s_cmp_lt_u32 s28, 4
s_cbranch_scc1 L_rm22
L_rm22d:
s_add_u32 s30, s60, 32768
s_cmp_ge_u32 s30, 294912
s_cselect_b32 s31, 294912, 0
s_sub_u32 s30, s30, s31
s_add_u32 s30, s30, 18874368
buffer_load_dwordx4 v[208:211], v8, s[20:23], s30 offen offset:0 sc0 sc1
buffer_load_dwordx4 v[212:215], v8, s[20:23], s30 offen offset:1024 sc0 sc1
s_waitcnt lgkmcnt(4)
v_mfma_f32_32x32x16_bf16 v[16:31], v[52:55], v[76:79], v[16:31]
ds_read_b64_tr_b16 v[48:49], v176 offset:16384
ds_read_b64_tr_b16 v[50:51], v176 offset:17408
s_waitcnt lgkmcnt(4)
v_mfma_f32_32x32x16_bf16 v[16:31], v[56:59], v[80:83], v[16:31]
ds_read_b64_tr_b16 v[52:53], v176 offset:18432
ds_read_b64_tr_b16 v[54:55], v176 offset:19456
v_cvt_pk_bf16_f32 v168, v32, v33
v_cvt_pk_bf16_f32 v169, v34, v35
v_cvt_pk_bf16_f32 v170, v36, v37
v_cvt_pk_bf16_f32 v171, v38, v39
s_waitcnt lgkmcnt(4)
v_mfma_f32_32x32x16_bf16 v[16:31], v[60:63], v[84:87], v[16:31]
ds_read_b64_tr_b16 v[56:57], v176 offset:24576
ds_read_b64_tr_b16 v[58:59], v176 offset:25600
s_cmp_lg_u32 s70, 0
s_cbranch_scc1 L_rm11
buffer_store_dwordx4 v[168:171], v8, s[20:23], s75 offen offset:0
s_branch L_rm11e
L_rm11:
buffer_store_dwordx4 v[168:171], v8, s[20:23], s75 offen offset:0 sc0 sc1
L_rm11e:
v_cvt_pk_bf16_f32 v172, v40, v41
v_cvt_pk_bf16_f32 v173, v42, v43
s_waitcnt lgkmcnt(4)
v_mfma_f32_32x32x16_bf16 v[16:31], v[48:51], v[88:91], v[16:31]
ds_read_b64_tr_b16 v[60:61], v176 offset:26624
ds_read_b64_tr_b16 v[62:63], v176 offset:27648
v_cvt_pk_bf16_f32 v174, v44, v45
v_cvt_pk_bf16_f32 v175, v46, v47
s_cmp_lg_u32 s70, 0
s_cbranch_scc1 L_rm12
buffer_store_dwordx4 v[172:175], v8, s[20:23], s75 offen offset:1024
s_branch L_rm12e
L_rm12:
buffer_store_dwordx4 v[172:175], v8, s[20:23], s75 offen offset:1024 sc0 sc1
L_rm12e:
s_waitcnt lgkmcnt(4)
v_mfma_f32_32x32x16_bf16 v[16:31], v[52:55], v[92:95], v[16:31]
ds_read_b64_tr_b16 v[48:49], v176 offset:32768
ds_read_b64_tr_b16 v[50:51], v176 offset:33792
s_add_u32 s60, s60, 32768
s_cmp_ge_u32 s60, 294912
s_cselect_b32 s60, 0, s60
s_add_u32 s75, s60, 18874368
s_waitcnt lgkmcnt(4)
v_mfma_f32_32x32x16_bf16 v[16:31], v[56:59], v[96:99], v[16:31]
ds_read_b64_tr_b16 v[52:53], v176 offset:34816
ds_read_b64_tr_b16 v[54:55], v176 offset:35840
s_waitcnt lgkmcnt(4)
v_mfma_f32_32x32x16_bf16 v[16:31], v[60:63], v[100:103], v[16:31]
ds_read_b64_tr_b16 v[56:57], v177 offset:0
ds_read_b64_tr_b16 v[58:59], v177 offset:1024
s_waitcnt lgkmcnt(4)
v_mfma_f32_32x32x16_bf16 v[16:31], v[48:51], v[104:107], v[16:31]
ds_read_b64_tr_b16 v[60:61], v177 offset:2048
ds_read_b64_tr_b16 v[62:63], v177 offset:3072
s_waitcnt lgkmcnt(4)
v_mfma_f32_32x32x16_bf16 v[16:31], v[52:55], v[108:111], v[16:31]
ds_read_b64_tr_b16 v[48:49], v177 offset:8192
ds_read_b64_tr_b16 v[50:51], v177 offset:9216
s_add_u32 s58, s58, 128
s_cmp_ge_u32 s58, 1152
s_cselect_b32 s58, 0, s58
v_add_u32 v3, s58, v2
s_mov_b64 exec, 1
buffer_load_dword v205, off, s[20:23], s72 sc0 sc1
s_mov_b64 exec, -1
s_waitcnt lgkmcnt(4)
v_mfma_f32_32x32x16_bf16 v[16:31], v[56:59], v[112:115], v[16:31]
ds_read_b64_tr_b16 v[52:53], v177 offset:10240
ds_read_b64_tr_b16 v[54:55], v177 offset:11264
s_add_u32 m0, s59, 98304
s_nop 0
buffer_load_dwordx4 v3, s[16:19], s50 offen offset:0 lds
s_waitcnt lgkmcnt(4)
v_mfma_f32_32x32x16_bf16 v[16:31], v[60:63], v[116:119], v[16:31]
ds_read_b64_tr_b16 v[56:57], v177 offset:16384
ds_read_b64_tr_b16 v[58:59], v177 offset:17408
buffer_load_dwordx4 v3, s[16:19], s51 offen offset:1024 lds
s_waitcnt lgkmcnt(4)
v_mfma_f32_32x32x16_bf16 v[16:31], v[48:51], v[120:123], v[16:31]
ds_read_b64_tr_b16 v[60:61], v177 offset:18432
ds_read_b64_tr_b16 v[62:63], v177 offset:19456
buffer_load_dwordx4 v3, s[16:19], s52 offen offset:2048 lds
s_waitcnt lgkmcnt(4)
v_mfma_f32_32x32x16_bf16 v[16:31], v[52:55], v[124:127], v[16:31]
ds_read_b64_tr_b16 v[48:49], v177 offset:24576
ds_read_b64_tr_b16 v[50:51], v177 offset:25600
buffer_load_dwordx4 v3, s[16:19], s53 offen offset:3072 lds
s_waitcnt lgkmcnt(4)
v_mfma_f32_32x32x16_bf16 v[16:31], v[56:59], v[128:131], v[16:31]
ds_read_b64_tr_b16 v[52:53], v177 offset:26624
ds_read_b64_tr_b16 v[54:55], v177 offset:27648
s_add_u32 m0, s59, 102400
s_nop 0
buffer_load_dwordx4 v3, s[16:19], s54 offen offset:0 lds
s_waitcnt lgkmcnt(4)
v_mfma_f32_32x32x16_bf16 v[16:31], v[60:63], v[132:135], v[16:31]
ds_read_b64_tr_b16 v[56:57], v176 offset:40960
ds_read_b64_tr_b16 v[58:59], v176 offset:41984
buffer_load_dwordx4 v3, s[16:19], s55 offen offset:1024 lds
s_add_u32 s28, s73, 6
v_mov_b32 v204, s28
s_waitcnt vmcnt(7)
s_mov_b64 exec, 1
s_cmp_lg_u32 s70, 0
s_cbranch_scc1 L_rm18
buffer_store_dword v204, off, s[20:23], s71
s_branch L_rm18e
L_rm18:
buffer_store_dword v204, off, s[20:23], s71 sc0 sc1
L_rm18e:
s_mov_b64 exec, -1
s_waitcnt lgkmcnt(4)
v_mfma_f32_32x32x16_bf16 v[16:31], v[48:51], v[136:139], v[16:31]
ds_read_b64_tr_b16 v[60:61], v176 offset:43008
ds_read_b64_tr_b16 v[62:63], v176 offset:44032
s_waitcnt lgkmcnt(4)
v_mfma_f32_32x32x16_bf16 v[16:31], v[52:55], v[140:143], v[16:31]
ds_read_b64_tr_b16 v[48:49], v177 offset:32768
ds_read_b64_tr_b16 v[50:51], v177 offset:33792
v_mfma_f32_32x32x16_bf16 v[16:31], v[216:219], v[208:211], v[16:31]
s_waitcnt lgkmcnt(4)
v_mfma_f32_32x32x16_bf16 v[16:31], v[56:59], v[160:163], v[16:31]
ds_read_b64_tr_b16 v[52:53], v177 offset:34816
ds_read_b64_tr_b16 v[54:55], v177 offset:35840
s_waitcnt lgkmcnt(4)
v_mfma_f32_32x32x16_bf16 v[16:31], v[60:63], v[164:167], v[16:31]
ds_read_b64_tr_b16 v[56:57], v177 offset:40960
ds_read_b64_tr_b16 v[58:59], v177 offset:41984
v_mfma_f32_32x32x16_bf16 v[16:31], v[220:223], v[212:215], v[16:31]
s_waitcnt lgkmcnt(4)
v_mfma_f32_32x32x16_bf16 v[16:31], v[48:51], v[144:147], v[16:31]
ds_read_b64_tr_b16 v[60:61], v177 offset:43008
ds_read_b64_tr_b16 v[62:63], v177 offset:44032
s_waitcnt lgkmcnt(4)
v_mfma_f32_32x32x16_bf16 v[16:31], v[52:55], v[148:151], v[16:31]
s_cmp_lg_u32 s3, 0
s_cbranch_scc1 L_hs4
v_and_b32 v13, 0x02020202, v13
v_cmp_ne_u32 vcc, 0x02020202, v13
s_cbranch_vccz L_hs4
v_lshlrev_b32 v12, 2, v1
s_movk_i32 s28, 0x4000
L_hs5:
buffer_load_dword v13, v12, s[24:27], 0 offen sc0 sc1
s_sub_u32 s28, s28, 1
s_cbranch_scc1 L_hs5_d
s_waitcnt vmcnt(0)
v_and_b32 v13, 0x02020202, v13
v_cmp_ne_u32 vcc, 0x02020202, v13
s_cbranch_vccnz L_hs5
L_hs5_d:
s_waitcnt vmcnt(0)
L_hs4:
s_barrier
ds_read_b64_tr_b16 v[48:49], v178 offset:0
ds_read_b64_tr_b16 v[50:51], v178 offset:1024
s_waitcnt lgkmcnt(4)
v_mfma_f32_32x32x16_bf16 v[16:31], v[56:59], v[152:155], v[16:31]
ds_read_b64_tr_b16 v[52:53], v178 offset:2048
ds_read_b64_tr_b16 v[54:55], v178 offset:3072
s_waitcnt lgkmcnt(4)
v_mfma_f32_32x32x16_bf16 v[16:31], v[60:63], v[156:159], v[16:31]
ds_read_b64_tr_b16 v[56:57], v178 offset:8192
ds_read_b64_tr_b16 v[58:59], v178 offset:9216
s_waitcnt lgkmcnt(4)
v_mfma_f32_32x32x16_bf16 v[32:47], v[48:51], v[72:75], 0
ds_read_b64_tr_b16 v[60:61], v178 offset:10240
ds_read_b64_tr_b16 v[62:63], v178 offset:11264
s_waitcnt vmcnt(7)
s_movk_i32 s29, 0x4000
v_readfirstlane_b32 s28, v205
s_and_b32 s28, s28, 15
s_cmp_lt_u32 s28, 5
s_cbranch_scc0 L_rm23d
L_rm23:
s_mov_b64 exec, 1
buffer_load_dword v205, off, s[20:23], s72 sc0 sc1
s_mov_b64 exec, -1
s_waitcnt vmcnt(0)
s_sub_u32 s29, s29, 1
s_cbranch_scc1 L_rm23d
v_readfirstlane_b32 s28, v205
s_and_b32 s28, s28, 15
s_cmp_lt_u32 s28, 5
s_cbranch_scc1 L_rm23
L_rm23d:
s_add_u32 s30, s60, 32768
s_cmp_ge_u32 s30, 294912
s_cselect_b32 s31, 294912, 0
s_sub_u32 s30, s30, s31
s_add_u32 s30, s30, 18874368
buffer_load_dwordx4 v[208:211], v8, s[20:23], s30 offen offset:0 sc0 sc1
buffer_load_dwordx4 v[212:215], v8, s[20:23], s30 offen offset:1024 sc0 sc1
s_waitcnt lgkmcnt(4)
v_mfma_f32_32x32x16_bf16 v[32:47], v[52:55], v[76:79], v[32:47]
ds_read_b64_tr_b16 v[48:49], v178 offset:16384
ds_read_b64_tr_b16 v[50:51], v178 offset:17408
s_waitcnt lgkmcnt(4)
v_mfma_f32_32x32x16_bf16 v[32:47], v[56:59], v[80:83], v[32:47]
ds_read_b64_tr_b16 v[52:53], v178 offset:18432
ds_read_b64_tr_b16 v[54:55], v178 offset:19456
v_cvt_pk_bf16_f32 v168, v16, v17
v_cvt_pk_bf16_f32 v169, v18, v19
s_waitcnt lgkmcnt(4)
v_mfma_f32_32x32x16_bf16 v[32:47], v[60:63], v[84:87], v[32:47]
ds_read_b64_tr_b16 v[56:57], v178 offset:24576
ds_read_b64_tr_b16 v[58:59], v178 offset:25600
v_cvt_pk_bf16_f32 v170, v20, v21
v_cvt_pk_bf16_f32 v171, v22, v23
s_waitcnt lgkmcnt(4)
v_mfma_f32_32x32x16_bf16 v[32:47], v[48:51], v[88:91], v[32:47]
ds_read_b64_tr_b16 v[60:61], v178 offset:26624
ds_read_b64_tr_b16 v[62:63], v178 offset:27648
v_cvt_pk_bf16_f32 v172, v24, v25
v_cvt_pk_bf16_f32 v173, v26, v27
s_waitcnt lgkmcnt(4)
v_mfma_f32_32x32x16_bf16 v[32:47], v[52:55], v[92:95], v[32:47]
ds_read_b64_tr_b16 v[48:49], v178 offset:32768
ds_read_b64_tr_b16 v[50:51], v178 offset:33792
v_cvt_pk_bf16_f32 v174, v28, v29
v_cvt_pk_bf16_f32 v175, v30, v31
s_waitcnt lgkmcnt(4)
v_mfma_f32_32x32x16_bf16 v[32:47], v[56:59], v[96:99], v[32:47]
ds_read_b64_tr_b16 v[52:53], v178 offset:34816
ds_read_b64_tr_b16 v[54:55], v178 offset:35840
s_waitcnt lgkmcnt(4)
v_mfma_f32_32x32x16_bf16 v[32:47], v[60:63], v[100:103], v[32:47]
ds_read_b64_tr_b16 v[56:57], v179 offset:0
ds_read_b64_tr_b16 v[58:59], v179 offset:1024
s_waitcnt lgkmcnt(4)
v_mfma_f32_32x32x16_bf16 v[32:47], v[48:51], v[104:107], v[32:47]
ds_read_b64_tr_b16 v[60:61], v179 offset:2048
ds_read_b64_tr_b16 v[62:63], v179 offset:3072
s_mov_b64 exec, 1
buffer_load_dword v205, off, s[20:23], s72 sc0 sc1
s_mov_b64 exec, -1
s_waitcnt lgkmcnt(4)
v_mfma_f32_32x32x16_bf16 v[32:47], v[52:55], v[108:111], v[32:47]
ds_read_b64_tr_b16 v[48:49], v179 offset:8192
ds_read_b64_tr_b16 v[50:51], v179 offset:9216
s_waitcnt lgkmcnt(4)
v_mfma_f32_32x32x16_bf16 v[32:47], v[56:59], v[112:115], v[32:47]
ds_read_b64_tr_b16 v[52:53], v179 offset:10240
ds_read_b64_tr_b16 v[54:55], v179 offset:11264
s_waitcnt lgkmcnt(4)
v_mfma_f32_32x32x16_bf16 v[32:47], v[60:63], v[116:119], v[32:47]
ds_read_b64_tr_b16 v[56:57], v179 offset:16384
ds_read_b64_tr_b16 v[58:59], v179 offset:17408
s_waitcnt lgkmcnt(4)
v_mfma_f32_32x32x16_bf16 v[32:47], v[48:51], v[120:123], v[32:47]
ds_read_b64_tr_b16 v[60:61], v179 offset:18432
ds_read_b64_tr_b16 v[62:63], v179 offset:19456
s_waitcnt lgkmcnt(4)
v_mfma_f32_32x32x16_bf16 v[32:47], v[52:55], v[124:127], v[32:47]
ds_read_b64_tr_b16 v[48:49], v179 offset:24576
ds_read_b64_tr_b16 v[50:51], v179 offset:25600
s_waitcnt vmcnt(0)
s_movk_i32 s29, 0x4000
v_readfirstlane_b32 s28, v205
s_and_b32 s28, s28, 15
s_cmp_lt_u32 s28, 6
s_cbranch_scc0 L_rm24d
L_rm24:
s_mov_b64 exec, 1
buffer_load_dword v205, off, s[20:23], s72 sc0 sc1
s_mov_b64 exec, -1
s_waitcnt vmcnt(0)
s_sub_u32 s29, s29, 1
s_cbranch_scc1 L_rm24d
v_readfirstlane_b32 s28, v205
s_and_b32 s28, s28, 15
s_cmp_lt_u32 s28, 6
s_cbranch_scc1 L_rm24
L_rm24d:
s_add_u32 s30, s60, 65536
s_cmp_ge_u32 s30, 294912
s_cselect_b32 s31, 294912, 0
s_sub_u32 s30, s30, s31
s_add_u32 s30, s30, 18874368
buffer_load_dwordx4 v[232:235], v8, s[20:23], s30 offen offset:0 sc0 sc1
buffer_load_dwordx4 v[236:239], v8, s[20:23], s30 offen offset:1024 sc0 sc1
s_waitcnt lgkmcnt(4)
v_mfma_f32_32x32x16_bf16 v[32:47], v[56:59], v[128:131], v[32:47]
ds_read_b64_tr_b16 v[52:53], v179 offset:26624
ds_read_b64_tr_b16 v[54:55], v179 offset:27648
buffer_store_dwordx4 v[168:171], v8, s[20:23], s60 offen offset:0 sc0 sc1
s_waitcnt lgkmcnt(4)
v_mfma_f32_32x32x16_bf16 v[32:47], v[60:63], v[132:135], v[32:47]
ds_read_b64_tr_b16 v[56:57], v178 offset:40960
ds_read_b64_tr_b16 v[58:59], v178 offset:41984
buffer_store_dwordx4 v[172:175], v8, s[20:23], s60 offen offset:1024 sc0 sc1
s_add_u32 s60, s60, 32768
s_cmp_ge_u32 s60, 294912
s_cselect_b32 s60, 0, s60
s_add_u32 s75, s60, 18874368
s_waitcnt lgkmcnt(4)
v_mfma_f32_32x32x16_bf16 v[32:47], v[48:51], v[136:139], v[32:47]
ds_read_b64_tr_b16 v[60:61], v178 offset:43008
ds_read_b64_tr_b16 v[62:63], v178 offset:44032
s_waitcnt lgkmcnt(4)
v_mfma_f32_32x32x16_bf16 v[32:47], v[52:55], v[140:143], v[32:47]
ds_read_b64_tr_b16 v[48:49], v179 offset:32768
ds_read_b64_tr_b16 v[50:51], v179 offset:33792
v_mfma_f32_32x32x16_bf16 v[32:47], v[216:219], v[208:211], v[32:47]
s_waitcnt lgkmcnt(4)
v_mfma_f32_32x32x16_bf16 v[32:47], v[56:59], v[160:163], v[32:47]
ds_read_b64_tr_b16 v[52:53], v179 offset:34816
ds_read_b64_tr_b16 v[54:55], v179 offset:35840
s_waitcnt lgkmcnt(4)
v_mfma_f32_32x32x16_bf16 v[32:47], v[60:63], v[164:167], v[32:47]
ds_read_b64_tr_b16 v[56:57], v179 offset:40960
ds_read_b64_tr_b16 v[58:59], v179 offset:41984
v_mfma_f32_32x32x16_bf16 v[32:47], v[220:223], v[212:215], v[32:47]
s_waitcnt lgkmcnt(4)
v_mfma_f32_32x32x16_bf16 v[32:47], v[48:51], v[144:147], v[32:47]
ds_read_b64_tr_b16 v[60:61], v179 offset:43008
ds_read_b64_tr_b16 v[62:63], v179 offset:44032
s_waitcnt lgkmcnt(4)
v_mfma_f32_32x32x16_bf16 v[32:47], v[52:55], v[148:151], v[32:47]
s_barrier
ds_read_b64_tr_b16 v[48:49], v180 offset:0
ds_read_b64_tr_b16 v[50:51], v180 offset:1024
s_waitcnt lgkmcnt(4)
v_mfma_f32_32x32x16_bf16 v[32:47], v[56:59], v[152:155], v[32:47]
ds_read_b64_tr_b16 v[52:53], v180 offset:2048
ds_read_b64_tr_b16 v[54:55], v180 offset:3072
s_waitcnt lgkmcnt(4)
v_mfma_f32_32x32x16_bf16 v[32:47], v[60:63], v[156:159], v[32:47]
ds_read_b64_tr_b16 v[56:57], v180 offset:8192
ds_read_b64_tr_b16 v[58:59], v180 offset:9216
s_waitcnt lgkmcnt(4)
v_mfma_f32_32x32x16_bf16 v[16:31], v[48:51], v[72:75], 0
ds_read_b64_tr_b16 v[60:61], v180 offset:10240
ds_read_b64_tr_b16 v[62:63], v180 offset:11264
s_waitcnt lgkmcnt(4)
v_mfma_f32_32x32x16_bf16 v[16:31], v[52:55], v[76:79], v[16:31]
ds_read_b64_tr_b16 v[48:49], v180 offset:16384
ds_read_b64_tr_b16 v[50:51], v180 offset:17408
s_mov_b64 exec, 1
buffer_load_dword v190, off, s[20:23], s39 offset:12 sc0 sc1
s_mov_b64 exec, -1
s_waitcnt lgkmcnt(4)
v_mfma_f32_32x32x16_bf16 v[16:31], v[56:59], v[80:83], v[16:31]
ds_read_b64_tr_b16 v[52:53], v180 offset:18432
ds_read_b64_tr_b16 v[54:55], v180 offset:19456
v_cvt_pk_bf16_f32 v168, v32, v33
v_cvt_pk_bf16_f32 v169, v34, v35
v_cvt_pk_bf16_f32 v170, v36, v37
v_cvt_pk_bf16_f32 v171, v38, v39
s_waitcnt lgkmcnt(4)
v_mfma_f32_32x32x16_bf16 v[16:31], v[60:63], v[84:87], v[16:31]
ds_read_b64_tr_b16 v[56:57], v180 offset:24576
ds_read_b64_tr_b16 v[58:59], v180 offset:25600
buffer_store_dwordx4 v[168:171], v8, s[20:23], s60 offen offset:0 sc0 sc1
v_cvt_pk_bf16_f32 v172, v40, v41
v_cvt_pk_bf16_f32 v173, v42, v43
s_waitcnt lgkmcnt(4)
v_mfma_f32_32x32x16_bf16 v[16:31], v[48:51], v[88:91], v[16:31]
ds_read_b64_tr_b16 v[60:61], v180 offset:26624
ds_read_b64_tr_b16 v[62:63], v180 offset:27648
v_cvt_pk_bf16_f32 v174, v44, v45
v_cvt_pk_bf16_f32 v175, v46, v47
buffer_store_dwordx4 v[172:175], v8, s[20:23], s60 offen offset:1024 sc0 sc1
s_waitcnt lgkmcnt(4)
v_mfma_f32_32x32x16_bf16 v[16:31], v[52:55], v[92:95], v[16:31]
ds_read_b64_tr_b16 v[48:49], v180 offset:32768
ds_read_b64_tr_b16 v[50:51], v180 offset:33792
s_add_u32 s60, s60, 32768
s_cmp_ge_u32 s60, 294912
s_cselect_b32 s60, 0, s60
s_add_u32 s75, s60, 18874368
s_waitcnt lgkmcnt(4)
v_mfma_f32_32x32x16_bf16 v[16:31], v[56:59], v[96:99], v[16:31]
ds_read_b64_tr_b16 v[52:53], v180 offset:34816
ds_read_b64_tr_b16 v[54:55], v180 offset:35840
s_waitcnt lgkmcnt(4)
v_mfma_f32_32x32x16_bf16 v[16:31], v[60:63], v[100:103], v[16:31]
ds_read_b64_tr_b16 v[56:57], v181 offset:0
ds_read_b64_tr_b16 v[58:59], v181 offset:1024
s_waitcnt lgkmcnt(4)
v_mfma_f32_32x32x16_bf16 v[16:31], v[48:51], v[104:107], v[16:31]
ds_read_b64_tr_b16 v[60:61], v181 offset:2048
ds_read_b64_tr_b16 v[62:63], v181 offset:3072
s_waitcnt lgkmcnt(4)
v_mfma_f32_32x32x16_bf16 v[16:31], v[52:55], v[108:111], v[16:31]
ds_read_b64_tr_b16 v[48:49], v181 offset:8192
ds_read_b64_tr_b16 v[50:51], v181 offset:9216
s_waitcnt lgkmcnt(4)
v_mfma_f32_32x32x16_bf16 v[16:31], v[56:59], v[112:115], v[16:31]
ds_read_b64_tr_b16 v[52:53], v181 offset:10240
ds_read_b64_tr_b16 v[54:55], v181 offset:11264
s_waitcnt lgkmcnt(4)
v_mfma_f32_32x32x16_bf16 v[16:31], v[60:63], v[116:119], v[16:31]
ds_read_b64_tr_b16 v[56:57], v181 offset:16384
ds_read_b64_tr_b16 v[58:59], v181 offset:17408
s_waitcnt lgkmcnt(4)
v_mfma_f32_32x32x16_bf16 v[16:31], v[48:51], v[120:123], v[16:31]
ds_read_b64_tr_b16 v[60:61], v181 offset:18432
ds_read_b64_tr_b16 v[62:63], v181 offset:19456
s_waitcnt lgkmcnt(4)
v_mfma_f32_32x32x16_bf16 v[16:31], v[52:55], v[124:127], v[16:31]
ds_read_b64_tr_b16 v[48:49], v181 offset:24576
ds_read_b64_tr_b16 v[50:51], v181 offset:25600
s_waitcnt lgkmcnt(4)
v_mfma_f32_32x32x16_bf16 v[16:31], v[56:59], v[128:131], v[16:31]
ds_read_b64_tr_b16 v[52:53], v181 offset:26624
ds_read_b64_tr_b16 v[54:55], v181 offset:27648
s_waitcnt lgkmcnt(4)
v_mfma_f32_32x32x16_bf16 v[16:31], v[60:63], v[132:135], v[16:31]
ds_read_b64_tr_b16 v[56:57], v180 offset:40960
ds_read_b64_tr_b16 v[58:59], v180 offset:41984
s_waitcnt lgkmcnt(4)
v_mfma_f32_32x32x16_bf16 v[16:31], v[48:51], v[136:139], v[16:31]
ds_read_b64_tr_b16 v[60:61], v180 offset:43008
ds_read_b64_tr_b16 v[62:63], v180 offset:44032
s_waitcnt lgkmcnt(4)
v_mfma_f32_32x32x16_bf16 v[16:31], v[52:55], v[140:143], v[16:31]
ds_read_b64_tr_b16 v[48:49], v181 offset:32768
ds_read_b64_tr_b16 v[50:51], v181 offset:33792
s_waitcnt vmcnt(5)
v_mfma_f32_32x32x16_bf16 v[16:31], v[216:219], v[232:235], v[16:31]
s_waitcnt lgkmcnt(4)
v_mfma_f32_32x32x16_bf16 v[16:31], v[56:59], v[160:163], v[16:31]
ds_read_b64_tr_b16 v[52:53], v181 offset:34816
ds_read_b64_tr_b16 v[54:55], v181 offset:35840
s_waitcnt lgkmcnt(4)
v_mfma_f32_32x32x16_bf16 v[16:31], v[60:63], v[164:167], v[16:31]
ds_read_b64_tr_b16 v[56:57], v181 offset:40960
ds_read_b64_tr_b16 v[58:59], v181 offset:41984
v_mfma_f32_32x32x16_bf16 v[16:31], v[220:223], v[236:239], v[16:31]
s_waitcnt lgkmcnt(4)
v_mfma_f32_32x32x16_bf16 v[16:31], v[48:51], v[144:147], v[16:31]
ds_read_b64_tr_b16 v[60:61], v181 offset:43008
ds_read_b64_tr_b16 v[62:63], v181 offset:44032
s_waitcnt lgkmcnt(4)
v_mfma_f32_32x32x16_bf16 v[16:31], v[52:55], v[148:151], v[16:31]
s_waitcnt lgkmcnt(2)
v_mfma_f32_32x32x16_bf16 v[16:31], v[56:59], v[152:155], v[16:31]
s_waitcnt lgkmcnt(0)
v_mfma_f32_32x32x16_bf16 v[16:31], v[60:63], v[156:159], v[16:31]
s_nop 7
s_nop 3
v_cvt_pk_bf16_f32 v168, v16, v17
v_cvt_pk_bf16_f32 v169, v18, v19
v_cvt_pk_bf16_f32 v170, v20, v21
v_cvt_pk_bf16_f32 v171, v22, v23
buffer_store_dwordx4 v[168:171], v8, s[20:23], s60 offen offset:0 sc0 sc1
v_cvt_pk_bf16_f32 v172, v24, v25
v_cvt_pk_bf16_f32 v173, v26, v27
v_cvt_pk_bf16_f32 v174, v28, v29
v_cvt_pk_bf16_f32 v175, v30, v31
buffer_store_dwordx4 v[172:175], v8, s[20:23], s60 offen offset:1024 sc0 sc1
s_mov_b32 s30, 0xc0088e99
s_mov_b32 s31, 0xbfb8aa3b
v_add_u32 v46, s44, v202
ds_read_b64 v[40:41], v201 offset:0
ds_read_b64 v[42:43], v46
ds_read_b64 v[44:45], v46 offset:2048
v_add_u32 v54, s45, v202
ds_read_b64 v[48:49], v201 offset:512
ds_read_b64 v[50:51], v54
ds_read_b64 v[52:53], v54 offset:2048
v_add_u32 v62, s46, v202
ds_read_b64 v[56:57], v201 offset:1024
ds_read_b64 v[58:59], v62
ds_read_b64 v[60:61], v62 offset:2048
s_waitcnt lgkmcnt(6)
v_lshlrev_b32 v72, 16, v40
v_and_b32 v73, 0xffff0000, v40
v_lshlrev_b32 v74, 16, v41
v_and_b32 v75, 0xffff0000, v41
v_lshlrev_b32 v76, 16, v42
v_and_b32 v77, 0xffff0000, v42
v_lshlrev_b32 v78, 16, v43
v_and_b32 v79, 0xffff0000, v43
v_lshlrev_b32 v80, 16, v44
v_and_b32 v81, 0xffff0000, v44
v_lshlrev_b32 v82, 16, v45
v_and_b32 v83, 0xffff0000, v45
v_sub_f32 v40, v72, v206
v_sub_f32 v41, v73, v206
v_sub_f32 v42, v74, v206
v_sub_f32 v43, v75, v206
v_mul_f32 v40, v40, v207
v_mul_f32 v41, v41, v207
v_mul_f32 v42, v42, v207
v_mul_f32 v43, v43, v207
v_mul_f32 v76, v76, v40
v_mul_f32 v77, v77, v41
v_mul_f32 v78, v78, v42
v_mul_f32 v79, v79, v43
s_waitcnt lgkmcnt(3)
v_lshlrev_b32 v84, 16, v48
v_and_b32 v85, 0xffff0000, v48
v_lshlrev_b32 v86, 16, v49
v_and_b32 v87, 0xffff0000, v49
v_lshlrev_b32 v88, 16, v50
v_and_b32 v89, 0xffff0000, v50
v_lshlrev_b32 v90, 16, v51
v_and_b32 v91, 0xffff0000, v51
v_lshlrev_b32 v92, 16, v52
v_and_b32 v93, 0xffff0000, v52
v_lshlrev_b32 v94, 16, v53
v_and_b32 v95, 0xffff0000, v53
v_sub_f32 v48, v84, v206
v_sub_f32 v49, v85, v206
v_sub_f32 v50, v86, v206
v_sub_f32 v51, v87, v206
v_mul_f32 v48, v48, v207
v_mul_f32 v49, v49, v207
v_mul_f32 v50, v50, v207
v_mul_f32 v51, v51, v207
v_mul_f32 v88, v88, v48
v_mul_f32 v89, v89, v49
v_mul_f32 v90, v90, v50
v_mul_f32 v91, v91, v51
s_waitcnt lgkmcnt(0)
v_lshlrev_b32 v96, 16, v56
v_and_b32 v97, 0xffff0000, v56
v_lshlrev_b32 v98, 16, v57
v_and_b32 v99, 0xffff0000, v57
v_lshlrev_b32 v100, 16, v58
v_and_b32 v101, 0xffff0000, v58
v_lshlrev_b32 v102, 16, v59
v_and_b32 v103, 0xffff0000, v59
v_lshlrev_b32 v104, 16, v60
v_and_b32 v105, 0xffff0000, v60
v_lshlrev_b32 v106, 16, v61
v_and_b32 v107, 0xffff0000, v61
v_sub_f32 v56, v96, v206
v_sub_f32 v57, v97, v206
v_sub_f32 v58, v98, v206
v_sub_f32 v59, v99, v206
v_mul_f32 v56, v56, v207
v_mul_f32 v57, v57, v207
v_mul_f32 v58, v58, v207
v_mul_f32 v59, v59, v207
v_mul_f32 v100, v100, v56
v_mul_f32 v101, v101, v57
v_mul_f32 v102, v102, v58
v_mul_f32 v103, v103, v59
s_barrier
s_waitcnt vmcnt(4)
s_movk_i32 s29, 0x4000
v_readfirstlane_b32 s28, v190
s_andn2_b32 s28, 0x01010101, s28
s_cbranch_scc0 L_rm25d
L_rm25:
s_mov_b64 exec, 1
buffer_load_dword v190, off, s[20:23], s39 offset:12 sc0 sc1
s_mov_b64 exec, -1
s_waitcnt vmcnt(0)
s_sub_u32 s29, s29, 1
s_cbranch_scc1 L_rm25d
v_readfirstlane_b32 s28, v190
s_andn2_b32 s28, 0x01010101, s28
s_cbranch_scc1 L_rm25
L_rm25d:
s_lshl_b32 s28, s44, 8
s_add_u32 s29, s28, 8192
s_nop 0
buffer_load_dwordx4 v[232:235], v200, s[20:23], s28 offen offset:0 sc0 sc1
buffer_load_dwordx4 v[236:239], v200, s[20:23], s28 offen offset:1024 sc0 sc1
buffer_load_dwordx4 v[240:243], v200, s[20:23], s29 offen offset:0 sc0 sc1
buffer_load_dwordx4 v[244:247], v200, s[20:23], s29 offen offset:1024 sc0 sc1
s_lshl_b32 s28, s45, 8
s_add_u32 s29, s28, 8192
buffer_load_dwordx4 v[128:131], v200, s[20:23], s28 offen offset:0 sc0 sc1
buffer_load_dwordx4 v[132:135], v200, s[20:23], s28 offen offset:1024 sc0 sc1
buffer_load_dwordx4 v[136:139], v200, s[20:23], s29 offen offset:0 sc0 sc1
buffer_load_dwordx4 v[140:143], v200, s[20:23], s29 offen offset:1024 sc0 sc1
s_waitcnt vmcnt(8)
s_lshl_b32 s28, s46, 8
s_add_u32 s29, s28, 8192
buffer_load_dwordx4 v[144:147], v200, s[20:23], s28 offen offset:0 sc0 sc1
buffer_load_dwordx4 v[148:151], v200, s[20:23], s28 offen offset:1024 sc0 sc1
buffer_load_dwordx4 v[152:155], v200, s[20:23], s29 offen offset:0 sc0 sc1
buffer_load_dwordx4 v[156:159], v200, s[20:23], s29 offen offset:1024 sc0 sc1
s_waitcnt vmcnt(10)
v_max3_u32 v188, v232, v233, v234
v_max3_u32 v189, v235, v236, v237
v_max3_u32 v189, v189, v238, v239
v_max_u32 v188, v188, v189
v_cmp_eq_u32 vcc, -1, v188
s_movk_i32 s32, 0x4000
s_cbranch_vccz L_rm26d
s_lshl_b32 s28, s44, 8
s_add_u32 s29, s28, 8192
L_rm26:
s_mov_b64 exec, vcc
buffer_load_dwordx4 v[232:235], v200, s[20:23], s28 offen offset:0 sc0 sc1
buffer_load_dwordx4 v[236:239], v200, s[20:23], s28 offen offset:1024 sc0 sc1
s_mov_b64 exec, -1
s_waitcnt vmcnt(0)
s_sub_u32 s32, s32, 1
s_cbranch_scc1 L_rm26d
v_max3_u32 v188, v232, v233, v234
v_max3_u32 v189, v235, v236, v237
v_max3_u32 v189, v189, v238, v239
v_max_u32 v188, v188, v189
v_cmp_eq_u32 vcc, -1, v188
s_cbranch_vccnz L_rm26
L_rm26d:
v_mfma_f32_16x16x32_bf16 v[16:19], v[192:195], v[232:235], 0
v_mfma_f32_16x16x32_bf16 v[16:19], v[196:199], v[236:239], v[16:19]
s_waitcnt vmcnt(9)
v_mfma_f32_16x16x32_bf16 v[76:79], v[192:195], v[240:243], v[76:79]
s_waitcnt vmcnt(8)
v_mfma_f32_16x16x32_bf16 v[76:79], v[196:199], v[244:247], v[76:79]
s_lshl_b32 s28, s44, 1
s_nop 2
v_fma_f32 v16, v16, s30, v80
v_fma_f32 v17, v17, s30, v81
v_fma_f32 v18, v18, s30, v82
v_fma_f32 v19, v19, s30, v83
v_mul_f32 v80, s31, v16
v_mul_f32 v81, s31, v17
v_mul_f32 v82, s31, v18
v_mul_f32 v83, s31, v19
v_exp_f32 v80, v80
v_exp_f32 v81, v81
v_exp_f32 v82, v82
v_exp_f32 v83, v83
v_mul_f32 v16, v16, v76
v_mul_f32 v17, v17, v77
v_mul_f32 v18, v18, v78
v_mul_f32 v19, v19, v79
v_add_f32 v80, 1.0, v80
v_add_f32 v81, 1.0, v81
v_add_f32 v82, 1.0, v82
v_add_f32 v83, 1.0, v83
v_rcp_f32 v80, v80
v_rcp_f32 v81, v81
v_rcp_f32 v82, v82
v_rcp_f32 v83, v83
v_fma_f32 v16, v16, v80, v72
v_fma_f32 v17, v17, v81, v73
v_fma_f32 v18, v18, v82, v74
v_fma_f32 v19, v19, v83, v75
buffer_store_dwordx4 v[16:19], v203, s[12:15], s28 offen
s_waitcnt vmcnt(7)
v_max3_u32 v188, v128, v129, v130
v_max3_u32 v189, v131, v132, v133
v_max3_u32 v189, v189, v134, v135
v_max_u32 v188, v188, v189
v_cmp_eq_u32 vcc, -1, v188
s_movk_i32 s32, 0x4000
s_cbranch_vccz L_rm27d
s_lshl_b32 s28, s45, 8
s_add_u32 s29, s28, 8192
L_rm27:
s_mov_b64 exec, vcc
buffer_load_dwordx4 v[128:131], v200, s[20:23], s28 offen offset:0 sc0 sc1
buffer_load_dwordx4 v[132:135], v200, s[20:23], s28 offen offset:1024 sc0 sc1
s_mov_b64 exec, -1
s_waitcnt vmcnt(0)
s_sub_u32 s32, s32, 1
s_cbranch_scc1 L_rm27d
v_max3_u32 v188, v128, v129, v130
v_max3_u32 v189, v131, v132, v133
v_max3_u32 v189, v189, v134, v135
v_max_u32 v188, v188, v189
v_cmp_eq_u32 vcc, -1, v188
s_cbranch_vccnz L_rm27
L_rm27d:
v_mfma_f32_16x16x32_bf16 v[20:23], v[192:195], v[128:131], 0
v_mfma_f32_16x16x32_bf16 v[20:23], v[196:199], v[132:135], v[20:23]
s_waitcnt vmcnt(6)
v_mfma_f32_16x16x32_bf16 v[88:91], v[192:195], v[136:139], v[88:91]
s_waitcnt vmcnt(5)
v_mfma_f32_16x16x32_bf16 v[88:91], v[196:199], v[140:143], v[88:91]
s_lshl_b32 s28, s45, 1
s_nop 2
v_fma_f32 v20, v20, s30, v92
v_fma_f32 v21, v21, s30, v93
v_fma_f32 v22, v22, s30, v94
v_fma_f32 v23, v23, s30, v95
v_mul_f32 v92, s31, v20
v_mul_f32 v93, s31, v21
v_mul_f32 v94, s31, v22
v_mul_f32 v95, s31, v23
v_exp_f32 v92, v92
v_exp_f32 v93, v93
v_exp_f32 v94, v94
v_exp_f32 v95, v95
v_mul_f32 v20, v20, v88
v_mul_f32 v21, v21, v89
v_mul_f32 v22, v22, v90
v_mul_f32 v23, v23, v91
v_add_f32 v92, 1.0, v92
v_add_f32 v93, 1.0, v93
v_add_f32 v94, 1.0, v94
v_add_f32 v95, 1.0, v95
v_rcp_f32 v92, v92
v_rcp_f32 v93, v93
v_rcp_f32 v94, v94
v_rcp_f32 v95, v95
v_fma_f32 v20, v20, v92, v84
v_fma_f32 v21, v21, v93, v85
v_fma_f32 v22, v22, v94, v86
v_fma_f32 v23, v23, v95, v87
buffer_store_dwordx4 v[20:23], v203, s[12:15], s28 offen
s_waitcnt vmcnt(2)
v_max3_u32 v188, v144, v145, v146
v_max3_u32 v189, v147, v148, v149
v_max3_u32 v189, v189, v150, v151
v_max3_u32 v188, v188, v152, v153
v_max3_u32 v189, v189, v154, v155
v_max3_u32 v188, v188, v156, v157
v_max3_u32 v189, v189, v158, v159
v_max_u32 v188, v188, v189
v_cmp_eq_u32 vcc, -1, v188
s_movk_i32 s32, 0x4000
s_cbranch_vccz L_rm28d
s_lshl_b32 s28, s46, 8
s_add_u32 s29, s28, 8192
L_rm28:
s_mov_b64 exec, vcc
buffer_load_dwordx4 v[144:147], v200, s[20:23], s28 offen offset:0 sc0 sc1
buffer_load_dwordx4 v[148:151], v200, s[20:23], s28 offen offset:1024 sc0 sc1
buffer_load_dwordx4 v[152:155], v200, s[20:23], s29 offen offset:0 sc0 sc1
buffer_load_dwordx4 v[156:159], v200, s[20:23], s29 offen offset:1024 sc0 sc1
s_mov_b64 exec, -1
s_waitcnt vmcnt(0)
s_sub_u32 s32, s32, 1
s_cbranch_scc1 L_rm28d
v_max3_u32 v188, v144, v145, v146
v_max3_u32 v189, v147, v148, v149
v_max3_u32 v189, v189, v150, v151
v_max3_u32 v188, v188, v152, v153
v_max3_u32 v189, v189, v154, v155
v_max3_u32 v188, v188, v156, v157
v_max3_u32 v189, v189, v158, v159
v_max_u32 v188, v188, v189
v_cmp_eq_u32 vcc, -1, v188
s_cbranch_vccnz L_rm28
L_rm28d:
v_mfma_f32_16x16x32_bf16 v[24:27], v[192:195], v[144:147], 0
v_mfma_f32_16x16x32_bf16 v[24:27], v[196:199], v[148:151], v[24:27]
v_mfma_f32_16x16x32_bf16 v[100:103], v[192:195], v[152:155], v[100:103]
v_mfma_f32_16x16x32_bf16 v[100:103], v[196:199], v[156:159], v[100:103]
s_lshl_b32 s28, s46, 1
s_nop 4
v_fma_f32 v24, v24, s30, v104
v_fma_f32 v25, v25, s30, v105
v_fma_f32 v26, v26, s30, v106
v_fma_f32 v27, v27, s30, v107
v_mul_f32 v104, s31, v24
v_mul_f32 v105, s31, v25
v_mul_f32 v106, s31, v26
v_mul_f32 v107, s31, v27
v_exp_f32 v104, v104
v_exp_f32 v105, v105
v_exp_f32 v106, v106
v_exp_f32 v107, v107
v_mul_f32 v24, v24, v100
v_mul_f32 v25, v25, v101
v_mul_f32 v26, v26, v102
v_mul_f32 v27, v27, v103
v_add_f32 v104, 1.0, v104
v_add_f32 v105, 1.0, v105
v_add_f32 v106, 1.0, v106
v_add_f32 v107, 1.0, v107
v_rcp_f32 v104, v104
v_rcp_f32 v105, v105
v_rcp_f32 v106, v106
v_rcp_f32 v107, v107
v_fma_f32 v24, v24, v104, v96
v_fma_f32 v25, v25, v105, v97
v_fma_f32 v26, v26, v106, v98
v_fma_f32 v27, v27, v107, v99
buffer_store_dwordx4 v[24:27], v203, s[12:15], s28 offen
s_endpgm
L_ssm:
s_sub_u32 s49, s7, 12
v_lshrrev_b32 v9, 5, v0
v_bfe_u32 v10, v0, 1, 4
v_lshl_add_u32 v9, v9, 4, v10
s_mul_i32 s30, s49, 288
v_lshl_add_u32 v54, v9, 1, s30
v_mov_b32 v52, v0
s_bitcmp1_b32 s3, 1
s_cselect_b32 s12, s76, s74
s_cselect_b32 s13, s77, s75
s_sub_u32 s12, s12, 4096
s_subb_u32 s13, s13, 0
s_mov_b32 s14, 667648
s_mov_b32 s15, 0x20000
s_cmp_ge_u32 s3, 4
s_cselect_b32 s16, s80, s78
s_cselect_b32 s17, s81, s79
s_sub_u32 s16, s16, 4096
s_subb_u32 s17, s17, 0
s_mov_b32 s18, 667648
s_mov_b32 s19, 0x20000
s_cmp_ge_u32 s6, 9
s_cselect_b32 s30, 9, 0
s_sub_u32 s57, s6, s30
s_mov_b32 s40, 4096
s_mov_b32 s41, 3200
s_mov_b32 s42, 2304
s_mov_b32 s43, 1408
s_mov_b32 s44, 4608
s_mov_b32 s45, 3712
s_mov_b32 s46, 2816
s_mov_b32 s47, 1920
s_mov_b32 s48, 5120
s_mul_i32 s64, s3, 9216
v_lshrrev_b32 v9, 3, v1
s_and_b32 s30, s3, 1
s_lshl_b32 s30, s30, 3
v_add_u32 v9, s30, v9
v_lshrrev_b32 v10, 1, v9
s_bfe_u32 s31, s3, 0x10001
v_xor_b32 v10, s31, v10
v_and_b32 v11, 7, v1
v_xor_b32 v10, v10, v11
s_mul_i32 s30, s49, 144
s_lshl_b32 s31, s5, 4
s_add_u32 s30, s30, s31
v_add_u32 v9, s30, v9
v_mul_u32_u24 v9, 1152, v9
v_lshl_add_u32 v3, v10, 4, v9
s_and_b32 s30, s6, 7
s_lshl_b32 s30, s30, 2
s_and_b32 s31, s3, 1
s_add_u32 s30, s30, s31
s_lshl_b32 s31, s5, 1
s_add_u32 s30, s30, s31
s_mul_i32 s30, s30, 4032
s_mul_i32 s31, s49, 165888
s_add_u32 s30, s30, s31
s_add_u32 s30, s30, 40960
v_lshl_add_u32 v53, v1, 6, s30
v_and_b32 v9, 1, v1
v_bfe_u32 v10, v1, 1, 4
v_lshrrev_b32 v11, 3, v10
v_lshl_add_u32 v11, v9, 1, v11
s_lshl_b32 s30, s5, 2
v_add_u32 v11, s30, v11
v_mul_u32_u24 v11, 9216, v11
v_and_b32 v12, 7, v10
v_lshl_add_u32 v11, v12, 7, v11
v_lshrrev_b32 v10, 1, v10
v_xor_b32 v10, v10, v9
v_lshrrev_b32 v9, 5, v1
v_xor_b32 v10, v10, v9
v_lshl_add_u32 v4, v10, 4, v11
v_xor_b32 v5, 32, v4
v_xor_b32 v6, 64, v4
v_xor_b32 v7, 96, v4
v_mov_b32 v16, 0
v_mov_b32 v17, 0
v_mov_b32 v18, 0
v_mov_b32 v19, 0
v_lshrrev_b32 v20, 3, v1
s_lshl_b32 s30, s61, 4
s_add_u32 s30, s30, 0
v_add_u32 v20, s30, v20
v_and_b32 v21, 0x63, v20
v_bfe_u32 v22, v20, 2, 2
v_lshl_or_b32 v21, v22, 3, v21
v_bfe_u32 v22, v20, 4, 1
v_lshl_or_b32 v20, v22, 2, v21
v_bfe_u32 v21, v20, 1, 3
v_and_b32 v22, 7, v1
v_xor_b32 v21, v21, v22
v_lshlrev_b32 v21, 4, v21
v_lshl_add_u32 v10, v20, 7, v21
v_add_u32 v10, 73728, v10
v_lshrrev_b32 v20, 3, v1
s_lshl_b32 s30, s61, 4
s_add_u32 s30, s30, 8
v_add_u32 v20, s30, v20
v_and_b32 v21, 0x63, v20
v_bfe_u32 v22, v20, 2, 2
v_lshl_or_b32 v21, v22, 3, v21
v_bfe_u32 v22, v20, 4, 1
v_lshl_or_b32 v20, v22, 2, v21
v_bfe_u32 v21, v20, 1, 3
v_and_b32 v22, 7, v1
v_xor_b32 v21, v21, v22
v_lshlrev_b32 v21, 4, v21
v_lshl_add_u32 v11, v20, 7, v21
v_add_u32 v11, 73728, v11
v_and_b32 v20, 31, v1
v_bfe_u32 v21, v20, 1, 3
v_lshrrev_b32 v22, 5, v1
v_xor_b32 v21, v21, v22
v_lshlrev_b32 v21, 4, v21
s_lshl_b32 s30, s4, 5
v_add_u32 v20, s30, v20
v_lshl_add_u32 v12, v20, 7, v21
v_add_u32 v12, 73728, v12
v_xor_b32 v13, 32, v12
v_xor_b32 v14, 64, v12
v_xor_b32 v15, 96, v12
s_cmp_eq_u32 s5, 0
s_cbranch_scc1 L_x10
buffer_load_dwordx4 v[216:219], v8, s[8:11], s28 offen offset:0
buffer_load_dwordx4 v[220:223], v8, s[8:11], s29 offen offset:0
buffer_load_dwordx4 v[224:227], v8, s[8:11], s28 offen offset:128
buffer_load_dwordx4 v[228:231], v8, s[8:11], s29 offen offset:128
buffer_load_dwordx4 v[232:235], v8, s[8:11], s28 offen offset:256
buffer_load_dwordx4 v[236:239], v8, s[8:11], s29 offen offset:256
buffer_load_dwordx4 v[240:243], v8, s[8:11], s28 offen offset:384
buffer_load_dwordx4 v[244:247], v8, s[8:11], s29 offen offset:384
buffer_load_dwordx4 v[248:251], v8, s[8:11], s28 offen offset:512
buffer_load_dwordx4 v[252:255], v8, s[8:11], s29 offen offset:512
buffer_load_dwordx4 v[72:75], v8, s[8:11], s28 offen offset:640
buffer_load_dwordx4 v[76:79], v8, s[8:11], s29 offen offset:640
buffer_load_dwordx4 v[80:83], v8, s[8:11], s28 offen offset:768
buffer_load_dwordx4 v[84:87], v8, s[8:11], s29 offen offset:768
buffer_load_dwordx4 v[88:91], v8, s[8:11], s28 offen offset:896
buffer_load_dwordx4 v[92:95], v8, s[8:11], s29 offen offset:896
buffer_load_dwordx4 v[96:99], v8, s[8:11], s28 offen offset:1024
buffer_load_dwordx4 v[100:103], v8, s[8:11], s29 offen offset:1024
L_x10:
s_waitcnt vmcnt(16)
v_dot2c_f32_bf16 v16, s63, v216
v_dot2c_f32_bf16 v18, v216, v216
v_dot2c_f32_bf16 v17, s63, v220
v_dot2c_f32_bf16 v19, v220, v220
v_dot2c_f32_bf16 v16, s63, v217
v_dot2c_f32_bf16 v18, v217, v217
v_dot2c_f32_bf16 v17, s63, v221
v_dot2c_f32_bf16 v19, v221, v221
v_dot2c_f32_bf16 v16, s63, v218
v_dot2c_f32_bf16 v18, v218, v218
v_dot2c_f32_bf16 v17, s63, v222
v_dot2c_f32_bf16 v19, v222, v222
v_dot2c_f32_bf16 v16, s63, v219
v_dot2c_f32_bf16 v18, v219, v219
v_dot2c_f32_bf16 v17, s63, v223
v_dot2c_f32_bf16 v19, v223, v223
s_waitcnt vmcnt(14)
v_dot2c_f32_bf16 v16, s63, v224
v_dot2c_f32_bf16 v18, v224, v224
v_dot2c_f32_bf16 v17, s63, v228
v_dot2c_f32_bf16 v19, v228, v228
v_dot2c_f32_bf16 v16, s63, v225
v_dot2c_f32_bf16 v18, v225, v225
v_dot2c_f32_bf16 v17, s63, v229
v_dot2c_f32_bf16 v19, v229, v229
v_dot2c_f32_bf16 v16, s63, v226
v_dot2c_f32_bf16 v18, v226, v226
v_dot2c_f32_bf16 v17, s63, v230
v_dot2c_f32_bf16 v19, v230, v230
v_dot2c_f32_bf16 v16, s63, v227
v_dot2c_f32_bf16 v18, v227, v227
v_dot2c_f32_bf16 v17, s63, v231
v_dot2c_f32_bf16 v19, v231, v231
s_waitcnt vmcnt(12)
v_dot2c_f32_bf16 v16, s63, v232
v_dot2c_f32_bf16 v18, v232, v232
v_dot2c_f32_bf16 v17, s63, v236
v_dot2c_f32_bf16 v19, v236, v236
v_dot2c_f32_bf16 v16, s63, v233
v_dot2c_f32_bf16 v18, v233, v233
v_dot2c_f32_bf16 v17, s63, v237
v_dot2c_f32_bf16 v19, v237, v237
v_dot2c_f32_bf16 v16, s63, v234
v_dot2c_f32_bf16 v18, v234, v234
v_dot2c_f32_bf16 v17, s63, v238
v_dot2c_f32_bf16 v19, v238, v238
v_dot2c_f32_bf16 v16, s63, v235
v_dot2c_f32_bf16 v18, v235, v235
v_dot2c_f32_bf16 v17, s63, v239
v_dot2c_f32_bf16 v19, v239, v239
s_waitcnt vmcnt(10)
v_dot2c_f32_bf16 v16, s63, v240
v_dot2c_f32_bf16 v18, v240, v240
v_dot2c_f32_bf16 v17, s63, v244
v_dot2c_f32_bf16 v19, v244, v244
v_dot2c_f32_bf16 v16, s63, v241
v_dot2c_f32_bf16 v18, v241, v241
v_dot2c_f32_bf16 v17, s63, v245
v_dot2c_f32_bf16 v19, v245, v245
v_dot2c_f32_bf16 v16, s63, v242
v_dot2c_f32_bf16 v18, v242, v242
v_dot2c_f32_bf16 v17, s63, v246
v_dot2c_f32_bf16 v19, v246, v246
v_dot2c_f32_bf16 v16, s63, v243
v_dot2c_f32_bf16 v18, v243, v243
v_dot2c_f32_bf16 v17, s63, v247
v_dot2c_f32_bf16 v19, v247, v247
s_waitcnt vmcnt(8)
v_dot2c_f32_bf16 v16, s63, v248
v_dot2c_f32_bf16 v18, v248, v248
v_dot2c_f32_bf16 v17, s63, v252
v_dot2c_f32_bf16 v19, v252, v252
v_dot2c_f32_bf16 v16, s63, v249
v_dot2c_f32_bf16 v18, v249, v249
v_dot2c_f32_bf16 v17, s63, v253
v_dot2c_f32_bf16 v19, v253, v253
v_dot2c_f32_bf16 v16, s63, v250
v_dot2c_f32_bf16 v18, v250, v250
v_dot2c_f32_bf16 v17, s63, v254
v_dot2c_f32_bf16 v19, v254, v254
v_dot2c_f32_bf16 v16, s63, v251
v_dot2c_f32_bf16 v18, v251, v251
v_dot2c_f32_bf16 v17, s63, v255
v_dot2c_f32_bf16 v19, v255, v255
s_waitcnt vmcnt(6)
v_dot2c_f32_bf16 v16, s63, v72
v_dot2c_f32_bf16 v18, v72, v72
v_dot2c_f32_bf16 v17, s63, v76
v_dot2c_f32_bf16 v19, v76, v76
v_dot2c_f32_bf16 v16, s63, v73
v_dot2c_f32_bf16 v18, v73, v73
v_dot2c_f32_bf16 v17, s63, v77
v_dot2c_f32_bf16 v19, v77, v77
v_dot2c_f32_bf16 v16, s63, v74
v_dot2c_f32_bf16 v18, v74, v74
v_dot2c_f32_bf16 v17, s63, v78
v_dot2c_f32_bf16 v19, v78, v78
v_dot2c_f32_bf16 v16, s63, v75
v_dot2c_f32_bf16 v18, v75, v75
v_dot2c_f32_bf16 v17, s63, v79
v_dot2c_f32_bf16 v19, v79, v79
s_waitcnt vmcnt(4)
v_dot2c_f32_bf16 v16, s63, v80
v_dot2c_f32_bf16 v18, v80, v80
v_dot2c_f32_bf16 v17, s63, v84
v_dot2c_f32_bf16 v19, v84, v84
v_dot2c_f32_bf16 v16, s63, v81
v_dot2c_f32_bf16 v18, v81, v81
v_dot2c_f32_bf16 v17, s63, v85
v_dot2c_f32_bf16 v19, v85, v85
v_dot2c_f32_bf16 v16, s63, v82
v_dot2c_f32_bf16 v18, v82, v82
v_dot2c_f32_bf16 v17, s63, v86
v_dot2c_f32_bf16 v19, v86, v86
v_dot2c_f32_bf16 v16, s63, v83
v_dot2c_f32_bf16 v18, v83, v83
v_dot2c_f32_bf16 v17, s63, v87
v_dot2c_f32_bf16 v19, v87, v87
s_waitcnt vmcnt(2)
v_dot2c_f32_bf16 v16, s63, v88
v_dot2c_f32_bf16 v18, v88, v88
v_dot2c_f32_bf16 v17, s63, v92
v_dot2c_f32_bf16 v19, v92, v92
v_dot2c_f32_bf16 v16, s63, v89
v_dot2c_f32_bf16 v18, v89, v89
v_dot2c_f32_bf16 v17, s63, v93
v_dot2c_f32_bf16 v19, v93, v93
v_dot2c_f32_bf16 v16, s63, v90
v_dot2c_f32_bf16 v18, v90, v90
v_dot2c_f32_bf16 v17, s63, v94
v_dot2c_f32_bf16 v19, v94, v94
v_dot2c_f32_bf16 v16, s63, v91
v_dot2c_f32_bf16 v18, v91, v91
v_dot2c_f32_bf16 v17, s63, v95
v_dot2c_f32_bf16 v19, v95, v95
s_waitcnt vmcnt(0)
v_dot2c_f32_bf16 v16, s63, v96
v_dot2c_f32_bf16 v18, v96, v96
v_dot2c_f32_bf16 v17, s63, v100
v_dot2c_f32_bf16 v19, v100, v100
v_dot2c_f32_bf16 v16, s63, v97
v_dot2c_f32_bf16 v18, v97, v97
v_dot2c_f32_bf16 v17, s63, v101
v_dot2c_f32_bf16 v19, v101, v101
v_dot2c_f32_bf16 v16, s63, v98
v_dot2c_f32_bf16 v18, v98, v98
v_dot2c_f32_bf16 v17, s63, v102
v_dot2c_f32_bf16 v19, v102, v102
v_dot2c_f32_bf16 v16, s63, v99
v_dot2c_f32_bf16 v18, v99, v99
v_dot2c_f32_bf16 v17, s63, v103
v_dot2c_f32_bf16 v19, v103, v103
s_nop 2
v_add_f32_dpp v16, v16, v16 quad_perm:[1,0,3,2] row_mask:0xf bank_mask:0xf
v_add_f32_dpp v17, v17, v17 quad_perm:[1,0,3,2] row_mask:0xf bank_mask:0xf
v_add_f32_dpp v18, v18, v18 quad_perm:[1,0,3,2] row_mask:0xf bank_mask:0xf
v_add_f32_dpp v19, v19, v19 quad_perm:[1,0,3,2] row_mask:0xf bank_mask:0xf
v_add_f32_dpp v16, v16, v16 quad_perm:[2,3,0,1] row_mask:0xf bank_mask:0xf
v_add_f32_dpp v17, v17, v17 quad_perm:[2,3,0,1] row_mask:0xf bank_mask:0xf
v_add_f32_dpp v18, v18, v18 quad_perm:[2,3,0,1] row_mask:0xf bank_mask:0xf
v_add_f32_dpp v19, v19, v19 quad_perm:[2,3,0,1] row_mask:0xf bank_mask:0xf
v_add_f32_dpp v16, v16, v16 row_half_mirror row_mask:0xf bank_mask:0xf
v_add_f32_dpp v17, v17, v17 row_half_mirror row_mask:0xf bank_mask:0xf
v_add_f32_dpp v18, v18, v18 row_half_mirror row_mask:0xf bank_mask:0xf
v_add_f32_dpp v19, v19, v19 row_half_mirror row_mask:0xf bank_mask:0xf
v_mul_f32 v20, 0x3ae38e39, v16
v_mul_f32 v21, 0x3ae38e39, v17
v_mul_f32 v22, 0x3ae38e39, v18
v_mul_f32 v23, 0x3ae38e39, v19
v_fma_f32 v22, -v20, v20, v22
v_fma_f32 v23, -v21, v21, v23
v_max_f32 v22, 0, v22
v_max_f32 v23, 0, v23
v_cvt_pk_bf16_f32 v24, v20, v20
v_cvt_pk_bf16_f32 v25, v21, v21
v_and_b32 v24, 0xffff0000, v24
v_and_b32 v25, 0xffff0000, v25
v_cvt_pk_bf16_f32 v26, v22, v22
v_cvt_pk_bf16_f32 v27, v23, v23
v_and_b32 v26, 0xffff0000, v26
v_and_b32 v27, 0xffff0000, v27
v_add_f32 v26, 0x3727c5ac, v26
v_add_f32 v27, 0x3727c5ac, v27
v_cvt_pk_bf16_f32 v26, v26, v26
v_cvt_pk_bf16_f32 v27, v27, v27
v_and_b32 v26, 0xffff0000, v26
v_and_b32 v27, 0xffff0000, v27
v_sqrt_f32 v26, v26
v_sqrt_f32 v27, v27
v_cvt_pk_bf16_f32 v26, v26, v26
v_cvt_pk_bf16_f32 v27, v27, v27
v_and_b32 v26, 0xffff0000, v26
v_and_b32 v27, 0xffff0000, v27
v_rcp_f32 v28, v26
v_rcp_f32 v29, v27
v_lshrrev_b32 v34, 3, v1
s_lshl_b32 s31, s61, 4
v_add_u32 v34, s31, v34
v_lshlrev_b32 v34, 3, v34
v_mov_b32 v36, v24
v_mov_b32 v38, v25
v_mov_b32 v37, v28
v_mov_b32 v39, v29
s_lshl_b32 s30, s2, 10
s_add_u32 s30, s30, 37748736
buffer_store_dwordx2 v[36:37], v34, s[20:23], s30 offen
buffer_store_dwordx2 v[38:39], v34, s[20:23], s30 offen offset:64
s_nop 1
v_cvt_pk_bf16_f32 v34, v28, v28
v_cvt_pk_bf16_f32 v35, v29, v29
v_and_b32 v34, 0xffff0000, v34
v_and_b32 v35, 0xffff0000, v35
v_lshrrev_b32 v36, 16, v34
v_lshrrev_b32 v37, 16, v35
v_mul_f32 v38, v34, v24
v_mul_f32 v39, v35, v25
v_sub_f32 v38, 0, v38
v_sub_f32 v39, 0, v39
v_dot2_f32_bf16 v40, v216, v36, v38
v_dot2_f32_bf16 v41, v216, v34, v38
v_dot2_f32_bf16 v42, v217, v36, v38
v_dot2_f32_bf16 v43, v217, v34, v38
v_dot2_f32_bf16 v44, v218, v36, v38
v_dot2_f32_bf16 v45, v218, v34, v38
v_dot2_f32_bf16 v46, v219, v36, v38
v_dot2_f32_bf16 v47, v219, v34, v38
s_nop 0
v_cvt_pk_bf16_f32 v216, v40, v41
v_cvt_pk_bf16_f32 v217, v42, v43
v_cvt_pk_bf16_f32 v218, v44, v45
s_nop 0
v_cvt_pk_bf16_f32 v219, v46, v47
ds_write_b128 v10, v[216:219] offset:0
s_add_u32 m0, s64, 0
s_nop 0
buffer_load_dwordx4 v3, s[12:15], s40 offen offset:0 lds
v_dot2_f32_bf16 v40, v220, v37, v39
v_dot2_f32_bf16 v41, v220, v35, v39
v_dot2_f32_bf16 v42, v221, v37, v39
v_dot2_f32_bf16 v43, v221, v35, v39
v_dot2_f32_bf16 v44, v222, v37, v39
v_dot2_f32_bf16 v45, v222, v35, v39
v_dot2_f32_bf16 v46, v223, v37, v39
v_dot2_f32_bf16 v47, v223, v35, v39
s_nop 0
v_cvt_pk_bf16_f32 v220, v40, v41
v_cvt_pk_bf16_f32 v221, v42, v43
v_cvt_pk_bf16_f32 v222, v44, v45
s_nop 0
v_cvt_pk_bf16_f32 v223, v46, v47
ds_write_b128 v11, v[220:223] offset:0
buffer_load_dwordx4 v3, s[12:15], s41 offen offset:1024 lds
v_dot2_f32_bf16 v40, v224, v36, v38
v_dot2_f32_bf16 v41, v224, v34, v38
v_dot2_f32_bf16 v42, v225, v36, v38
v_dot2_f32_bf16 v43, v225, v34, v38
v_dot2_f32_bf16 v44, v226, v36, v38
v_dot2_f32_bf16 v45, v226, v34, v38
v_dot2_f32_bf16 v46, v227, v36, v38
v_dot2_f32_bf16 v47, v227, v34, v38
s_nop 0
v_cvt_pk_bf16_f32 v224, v40, v41
v_cvt_pk_bf16_f32 v225, v42, v43
v_cvt_pk_bf16_f32 v226, v44, v45
s_nop 0
v_cvt_pk_bf16_f32 v227, v46, v47
ds_write_b128 v10, v[224:227] offset:16384
buffer_load_dwordx4 v3, s[12:15], s42 offen offset:2048 lds
v_dot2_f32_bf16 v40, v228, v37, v39
v_dot2_f32_bf16 v41, v228, v35, v39
v_dot2_f32_bf16 v42, v229, v37, v39
v_dot2_f32_bf16 v43, v229, v35, v39
v_dot2_f32_bf16 v44, v230, v37, v39
v_dot2_f32_bf16 v45, v230, v35, v39
v_dot2_f32_bf16 v46, v231, v37, v39
v_dot2_f32_bf16 v47, v231, v35, v39
s_nop 0
v_cvt_pk_bf16_f32 v228, v40, v41
v_cvt_pk_bf16_f32 v229, v42, v43
v_cvt_pk_bf16_f32 v230, v44, v45
s_nop 0
v_cvt_pk_bf16_f32 v231, v46, v47
ds_write_b128 v11, v[228:231] offset:16384
buffer_load_dwordx4 v3, s[12:15], s43 offen offset:3072 lds
v_dot2_f32_bf16 v40, v232, v36, v38
v_dot2_f32_bf16 v41, v232, v34, v38
v_dot2_f32_bf16 v42, v233, v36, v38
v_dot2_f32_bf16 v43, v233, v34, v38
v_dot2_f32_bf16 v44, v234, v36, v38
v_dot2_f32_bf16 v45, v234, v34, v38
v_dot2_f32_bf16 v46, v235, v36, v38
v_dot2_f32_bf16 v47, v235, v34, v38
s_nop 0
v_cvt_pk_bf16_f32 v232, v40, v41
v_cvt_pk_bf16_f32 v233, v42, v43
v_cvt_pk_bf16_f32 v234, v44, v45
s_nop 0
v_cvt_pk_bf16_f32 v235, v46, v47
ds_write_b128 v10, v[232:235] offset:32768
s_add_u32 m0, s64, 4096
s_nop 0
buffer_load_dwordx4 v3, s[12:15], s44 offen offset:0 lds
v_dot2_f32_bf16 v40, v236, v37, v39
v_dot2_f32_bf16 v41, v236, v35, v39
v_dot2_f32_bf16 v42, v237, v37, v39
v_dot2_f32_bf16 v43, v237, v35, v39
v_dot2_f32_bf16 v44, v238, v37, v39
v_dot2_f32_bf16 v45, v238, v35, v39
v_dot2_f32_bf16 v46, v239, v37, v39
v_dot2_f32_bf16 v47, v239, v35, v39
s_nop 0
v_cvt_pk_bf16_f32 v236, v40, v41
v_cvt_pk_bf16_f32 v237, v42, v43
v_cvt_pk_bf16_f32 v238, v44, v45
s_nop 0
v_cvt_pk_bf16_f32 v239, v46, v47
ds_write_b128 v11, v[236:239] offset:32768
buffer_load_dwordx4 v3, s[12:15], s45 offen offset:1024 lds
v_dot2_f32_bf16 v40, v240, v36, v38
v_dot2_f32_bf16 v41, v240, v34, v38
v_dot2_f32_bf16 v42, v241, v36, v38
v_dot2_f32_bf16 v43, v241, v34, v38
v_dot2_f32_bf16 v44, v242, v36, v38
v_dot2_f32_bf16 v45, v242, v34, v38
v_dot2_f32_bf16 v46, v243, v36, v38
v_dot2_f32_bf16 v47, v243, v34, v38
s_nop 0
v_cvt_pk_bf16_f32 v240, v40, v41
v_cvt_pk_bf16_f32 v241, v42, v43
v_cvt_pk_bf16_f32 v242, v44, v45
s_nop 0
v_cvt_pk_bf16_f32 v243, v46, v47
ds_write_b128 v10, v[240:243] offset:49152
buffer_load_dwordx4 v3, s[12:15], s46 offen offset:2048 lds
v_dot2_f32_bf16 v40, v244, v37, v39
v_dot2_f32_bf16 v41, v244, v35, v39
v_dot2_f32_bf16 v42, v245, v37, v39
v_dot2_f32_bf16 v43, v245, v35, v39
v_dot2_f32_bf16 v44, v246, v37, v39
v_dot2_f32_bf16 v45, v246, v35, v39
v_dot2_f32_bf16 v46, v247, v37, v39
v_dot2_f32_bf16 v47, v247, v35, v39
s_nop 0
v_cvt_pk_bf16_f32 v244, v40, v41
v_cvt_pk_bf16_f32 v245, v42, v43
v_cvt_pk_bf16_f32 v246, v44, v45
s_nop 0
v_cvt_pk_bf16_f32 v247, v46, v47
ds_write_b128 v11, v[244:247] offset:49152
buffer_load_dwordx4 v3, s[12:15], s47 offen offset:3072 lds
v_dot2_f32_bf16 v40, v248, v36, v38
v_dot2_f32_bf16 v41, v248, v34, v38
v_dot2_f32_bf16 v42, v249, v36, v38
v_dot2_f32_bf16 v43, v249, v34, v38
v_dot2_f32_bf16 v44, v250, v36, v38
v_dot2_f32_bf16 v45, v250, v34, v38
v_dot2_f32_bf16 v46, v251, v36, v38
v_dot2_f32_bf16 v47, v251, v34, v38
s_nop 0
v_cvt_pk_bf16_f32 v248, v40, v41
v_cvt_pk_bf16_f32 v249, v42, v43
v_cvt_pk_bf16_f32 v250, v44, v45
s_nop 0
v_cvt_pk_bf16_f32 v251, v46, v47
v_add_u32 v48, 0x10000, v10
ds_write_b128 v48, v[248:251]
s_add_u32 m0, s64, 8192
s_nop 0
buffer_load_dwordx4 v3, s[12:15], s48 offen offset:0 lds
v_dot2_f32_bf16 v40, v252, v37, v39
v_dot2_f32_bf16 v41, v252, v35, v39
v_dot2_f32_bf16 v42, v253, v37, v39
v_dot2_f32_bf16 v43, v253, v35, v39
v_dot2_f32_bf16 v44, v254, v37, v39
v_dot2_f32_bf16 v45, v254, v35, v39
v_dot2_f32_bf16 v46, v255, v37, v39
v_dot2_f32_bf16 v47, v255, v35, v39
s_nop 0
v_cvt_pk_bf16_f32 v252, v40, v41
v_cvt_pk_bf16_f32 v253, v42, v43
v_cvt_pk_bf16_f32 v254, v44, v45
s_nop 0
v_cvt_pk_bf16_f32 v255, v46, v47
v_add_u32 v48, 0x10000, v11
ds_write_b128 v48, v[252:255]
s_mov_b32 s24, s70
s_mov_b32 s25, s71
s_mov_b32 s26, 1152
s_mov_b32 s27, 0x20000
buffer_load_ushort v49, v54, s[24:27], 0 offen
s_mov_b32 s24, s72
s_mov_b32 s25, s73
s_mov_b32 s26, 1152
s_mov_b32 s27, 0x20000
buffer_load_ushort v50, v54, s[24:27], 0 offen
s_mov_b32 s24, s82
s_mov_b32 s25, s83
s_mov_b32 s26, 1152
s_mov_b32 s27, 0x20000
buffer_load_ushort v51, v54, s[24:27], 0 offen
s_mov_b32 s24, s98
s_mov_b32 s25, s99
s_mov_b32 s26, 256
s_mov_b32 s27, 0x20000
buffer_load_dword v53, v53, s[12:15], 0 offen
s_waitcnt lgkmcnt(0)
s_barrier
ds_read_b128 v[112:115], v12 offset:0
ds_read_b128 v[116:119], v13 offset:0
ds_read_b128 v[120:123], v14 offset:0
ds_read_b128 v[124:127], v15 offset:0
ds_read_b128 v[128:131], v12 offset:16384
ds_read_b128 v[132:135], v13 offset:16384
ds_read_b128 v[136:139], v14 offset:16384
ds_read_b128 v[140:143], v15 offset:16384
ds_read_b128 v[144:147], v12 offset:32768
ds_read_b128 v[148:151], v13 offset:32768
ds_read_b128 v[152:155], v14 offset:32768
ds_read_b128 v[156:159], v15 offset:32768
ds_read_b128 v[160:163], v12 offset:49152
ds_read_b128 v[164:167], v13 offset:49152
ds_read_b128 v[168:171], v14 offset:49152
ds_read_b128 v[172:175], v15 offset:49152
v_add_u32 v48, 0x10000, v12
ds_read_b128 v[176:179], v48
v_add_u32 v48, 0x10000, v13
ds_read_b128 v[180:183], v48
v_add_u32 v48, 0x10000, v14
ds_read_b128 v[184:187], v48
v_add_u32 v48, 0x10000, v15
ds_read_b128 v[188:191], v48
v_dot2_f32_bf16 v40, v72, v36, v38
v_dot2_f32_bf16 v41, v72, v34, v38
v_dot2_f32_bf16 v42, v73, v36, v38
v_dot2_f32_bf16 v43, v73, v34, v38
v_dot2_f32_bf16 v44, v74, v36, v38
v_dot2_f32_bf16 v45, v74, v34, v38
v_dot2_f32_bf16 v46, v75, v36, v38
v_dot2_f32_bf16 v47, v75, v34, v38
s_nop 0
v_cvt_pk_bf16_f32 v72, v40, v41
v_cvt_pk_bf16_f32 v73, v42, v43
v_cvt_pk_bf16_f32 v74, v44, v45
s_nop 0
v_cvt_pk_bf16_f32 v75, v46, v47
v_dot2_f32_bf16 v40, v76, v37, v39
v_dot2_f32_bf16 v41, v76, v35, v39
v_dot2_f32_bf16 v42, v77, v37, v39
v_dot2_f32_bf16 v43, v77, v35, v39
v_dot2_f32_bf16 v44, v78, v37, v39
v_dot2_f32_bf16 v45, v78, v35, v39
v_dot2_f32_bf16 v46, v79, v37, v39
v_dot2_f32_bf16 v47, v79, v35, v39
s_nop 0
v_cvt_pk_bf16_f32 v76, v40, v41
v_cvt_pk_bf16_f32 v77, v42, v43
v_cvt_pk_bf16_f32 v78, v44, v45
s_nop 0
v_cvt_pk_bf16_f32 v79, v46, v47
v_dot2_f32_bf16 v40, v80, v36, v38
v_dot2_f32_bf16 v41, v80, v34, v38
v_dot2_f32_bf16 v42, v81, v36, v38
v_dot2_f32_bf16 v43, v81, v34, v38
v_dot2_f32_bf16 v44, v82, v36, v38
v_dot2_f32_bf16 v45, v82, v34, v38
v_dot2_f32_bf16 v46, v83, v36, v38
v_dot2_f32_bf16 v47, v83, v34, v38
s_nop 0
v_cvt_pk_bf16_f32 v80, v40, v41
v_cvt_pk_bf16_f32 v81, v42, v43
v_cvt_pk_bf16_f32 v82, v44, v45
s_nop 0
v_cvt_pk_bf16_f32 v83, v46, v47
v_dot2_f32_bf16 v40, v84, v37, v39
v_dot2_f32_bf16 v41, v84, v35, v39
v_dot2_f32_bf16 v42, v85, v37, v39
v_dot2_f32_bf16 v43, v85, v35, v39
v_dot2_f32_bf16 v44, v86, v37, v39
v_dot2_f32_bf16 v45, v86, v35, v39
v_dot2_f32_bf16 v46, v87, v37, v39
v_dot2_f32_bf16 v47, v87, v35, v39
s_nop 0
v_cvt_pk_bf16_f32 v84, v40, v41
v_cvt_pk_bf16_f32 v85, v42, v43
v_cvt_pk_bf16_f32 v86, v44, v45
s_nop 0
v_cvt_pk_bf16_f32 v87, v46, v47
v_dot2_f32_bf16 v40, v88, v36, v38
v_dot2_f32_bf16 v41, v88, v34, v38
v_dot2_f32_bf16 v42, v89, v36, v38
v_dot2_f32_bf16 v43, v89, v34, v38
v_dot2_f32_bf16 v44, v90, v36, v38
v_dot2_f32_bf16 v45, v90, v34, v38
v_dot2_f32_bf16 v46, v91, v36, v38
v_dot2_f32_bf16 v47, v91, v34, v38
s_nop 0
v_cvt_pk_bf16_f32 v88, v40, v41
v_cvt_pk_bf16_f32 v89, v42, v43
v_cvt_pk_bf16_f32 v90, v44, v45
s_nop 0
v_cvt_pk_bf16_f32 v91, v46, v47
v_dot2_f32_bf16 v40, v92, v37, v39
v_dot2_f32_bf16 v41, v92, v35, v39
v_dot2_f32_bf16 v42, v93, v37, v39
v_dot2_f32_bf16 v43, v93, v35, v39
v_dot2_f32_bf16 v44, v94, v37, v39
v_dot2_f32_bf16 v45, v94, v35, v39
v_dot2_f32_bf16 v46, v95, v37, v39
v_dot2_f32_bf16 v47, v95, v35, v39
s_nop 0
v_cvt_pk_bf16_f32 v92, v40, v41
v_cvt_pk_bf16_f32 v93, v42, v43
v_cvt_pk_bf16_f32 v94, v44, v45
s_nop 0
v_cvt_pk_bf16_f32 v95, v46, v47
v_dot2_f32_bf16 v40, v96, v36, v38
v_dot2_f32_bf16 v41, v96, v34, v38
v_dot2_f32_bf16 v42, v97, v36, v38
v_dot2_f32_bf16 v43, v97, v34, v38
v_dot2_f32_bf16 v44, v98, v36, v38
v_dot2_f32_bf16 v45, v98, v34, v38
v_dot2_f32_bf16 v46, v99, v36, v38
v_dot2_f32_bf16 v47, v99, v34, v38
s_nop 0
v_cvt_pk_bf16_f32 v96, v40, v41
v_cvt_pk_bf16_f32 v97, v42, v43
v_cvt_pk_bf16_f32 v98, v44, v45
s_nop 0
v_cvt_pk_bf16_f32 v99, v46, v47
v_dot2_f32_bf16 v40, v100, v37, v39
v_dot2_f32_bf16 v41, v100, v35, v39
v_dot2_f32_bf16 v42, v101, v37, v39
v_dot2_f32_bf16 v43, v101, v35, v39
v_dot2_f32_bf16 v44, v102, v37, v39
v_dot2_f32_bf16 v45, v102, v35, v39
v_dot2_f32_bf16 v46, v103, v37, v39
v_dot2_f32_bf16 v47, v103, v35, v39
s_nop 0
v_cvt_pk_bf16_f32 v100, v40, v41
v_cvt_pk_bf16_f32 v101, v42, v43
v_cvt_pk_bf16_f32 v102, v44, v45
s_nop 0
v_cvt_pk_bf16_f32 v103, v46, v47
s_waitcnt vmcnt(0)
s_lshl_b32 s28, s6, 3
s_add_u32 s28, s28, s3
s_mul_i32 s39, s28, 4352
s_add_u32 s39, s39, 38092800
s_add_u32 s63, s7, s39
v_mov_b32 v9, 0
s_mov_b64 exec, 1
buffer_store_byte v9, off, s[20:23], s63 sc0 sc1
s_mov_b64 exec, -1
s_lshl_b32 s30, s49, 4
s_add_u32 s30, s30, 15
s_sub_u32 s30, s30, s6
s_mul_i32 s38, s30, 1280
s_add_u32 s38, s38, 38010880
s_cmp_ge_u32 s3, 5
s_cbranch_scc1 L_noclr
v_lshlrev_b32 v55, 2, v52
v_mov_b32 v53, -1
buffer_store_dword v53, v55, s[20:23], s38 offen sc0 sc1
L_noclr:
v_add_u32 v3, 36864, v3
s_waitcnt lgkmcnt(0)
s_barrier
ds_write_b128 v10, v[88:91] offset:32768
ds_write_b128 v11, v[92:95] offset:32768
ds_write_b128 v10, v[96:99] offset:49152
ds_write_b128 v11, v[100:103] offset:49152
ds_read_b128 v[96:99], v4 offset:0
ds_read_b128 v[100:103], v5 offset:0
ds_read_b128 v[104:107], v6 offset:0
s_waitcnt lgkmcnt(2)
v_mfma_f32_32x32x16_bf16 v[16:31], v[112:115], v[96:99], 0
ds_read_b128 v[108:111], v7 offset:0
ds_write_b128 v10, v[72:75] offset:0
ds_write_b128 v11, v[76:79] offset:0
s_waitcnt lgkmcnt(4)
v_mfma_f32_32x32x16_bf16 v[16:31], v[116:119], v[100:103], v[16:31]
ds_read_b128 v[96:99], v4 offset:1024
ds_write_b128 v10, v[80:83] offset:16384
ds_write_b128 v11, v[84:87] offset:16384
s_waitcnt lgkmcnt(6)
v_mfma_f32_32x32x16_bf16 v[16:31], v[120:123], v[104:107], v[16:31]
ds_read_b128 v[100:103], v5 offset:1024
s_waitcnt lgkmcnt(6)
v_mfma_f32_32x32x16_bf16 v[16:31], v[124:127], v[108:111], v[16:31]
s_waitcnt lgkmcnt(1)
s_barrier
ds_read_b128 v[104:107], v6 offset:1024
ds_read_b128 v[192:195], v12 offset:0
ds_read_b128 v[196:199], v13 offset:0
ds_read_b128 v[200:203], v14 offset:0
ds_read_b128 v[204:207], v15 offset:0
ds_read_b128 v[208:211], v12 offset:16384
ds_read_b128 v[212:215], v13 offset:16384
v_mfma_f32_32x32x16_bf16 v[16:31], v[128:131], v[96:99], v[16:31]
ds_read_b128 v[108:111], v7 offset:1024
ds_read_b128 v[216:219], v14 offset:16384
ds_read_b128 v[220:223], v15 offset:16384
ds_read_b128 v[224:227], v12 offset:32768
ds_read_b128 v[228:231], v13 offset:32768
ds_read_b128 v[232:235], v14 offset:32768
ds_read_b128 v[236:239], v15 offset:32768
s_waitcnt lgkmcnt(14)
v_mfma_f32_32x32x16_bf16 v[16:31], v[132:135], v[100:103], v[16:31]
ds_read_b128 v[96:99], v4 offset:2048
ds_read_b128 v[240:243], v12 offset:49152
ds_read_b128 v[244:247], v13 offset:49152
ds_read_b128 v[248:251], v14 offset:49152
ds_read_b128 v[252:255], v15 offset:49152
v_lshlrev_b32 v49, 16, v49
v_lshlrev_b32 v50, 16, v50
v_lshlrev_b32 v51, 16, v51
s_waitcnt lgkmcnt(15)
v_mfma_f32_32x32x16_bf16 v[16:31], v[136:139], v[104:107], v[16:31]
ds_read_b128 v[100:103], v5 offset:2048
v_mul_f32 v51, 0x3fb8aa3b, v51
v_exp_f32 v51, v51
s_waitcnt lgkmcnt(12)
v_mfma_f32_32x32x16_bf16 v[16:31], v[140:143], v[108:111], v[16:31]
s_waitcnt lgkmcnt(1)
s_barrier
ds_read_b128 v[104:107], v6 offset:2048
s_add_u32 m0, s64, 73728
s_nop 0
buffer_load_dwordx4 v3, s[12:15], s40 offen offset:0 lds
s_nop 0
v_cvt_pk_bf16_f32 v51, v51, v51
v_mfma_f32_32x32x16_bf16 v[16:31], v[144:147], v[96:99], v[16:31]
ds_read_b128 v[108:111], v7 offset:2048
buffer_load_dwordx4 v3, s[12:15], s41 offen offset:1024 lds
v_and_b32 v51, 0xffff0000, v51
v_mul_f32 v53, v51, v49
v_mul_f32 v54, v51, v50
s_waitcnt lgkmcnt(2)
v_mfma_f32_32x32x16_bf16 v[16:31], v[148:151], v[100:103], v[16:31]
ds_read_b128 v[96:99], v4 offset:3072
buffer_load_dwordx4 v3, s[12:15], s42 offen offset:2048 lds
v_mul_f32 v53, 0x3fb8aa3b, v53
v_mul_f32 v54, 0.15915494, v54
v_exp_f32 v53, v53
s_waitcnt lgkmcnt(2)
v_mfma_f32_32x32x16_bf16 v[16:31], v[152:155], v[104:107], v[16:31]
ds_read_b128 v[100:103], v5 offset:3072
buffer_load_dwordx4 v3, s[12:15], s43 offen offset:3072 lds
v_fract_f32 v54, v54
s_waitcnt lgkmcnt(2)
v_mfma_f32_32x32x16_bf16 v[16:31], v[156:159], v[108:111], v[16:31]
ds_read_b128 v[104:107], v6 offset:3072
s_add_u32 m0, s64, 77824
s_nop 0
buffer_load_dwordx4 v3, s[12:15], s44 offen offset:0 lds
v_cos_f32 v56, v54
v_sin_f32 v57, v54
v_mul_f32 v58, v49, v49
s_waitcnt lgkmcnt(2)
v_mfma_f32_32x32x16_bf16 v[16:31], v[160:163], v[96:99], v[16:31]
ds_read_b128 v[108:111], v7 offset:3072
buffer_load_dwordx4 v3, s[12:15], s45 offen offset:1024 lds
v_fma_f32 v58, v50, v50, v58
v_mul_f32 v56, v56, v53
v_mul_f32 v57, v57, v53
s_waitcnt lgkmcnt(2)
v_mfma_f32_32x32x16_bf16 v[16:31], v[164:167], v[100:103], v[16:31]
ds_read_b128 v[96:99], v4 offset:4096
buffer_load_dwordx4 v3, s[12:15], s46 offen offset:2048 lds
v_rcp_f32 v58, v58
s_waitcnt lgkmcnt(2)
v_mfma_f32_32x32x16_bf16 v[16:31], v[168:171], v[104:107], v[16:31]
ds_read_b128 v[100:103], v5 offset:4096
buffer_load_dwordx4 v3, s[12:15], s47 offen offset:3072 lds
v_add_f32 v59, -1.0, v56
v_mul_f32 v60, v59, v49
v_fma_f32 v60, v57, v50, v60
s_waitcnt lgkmcnt(2)
v_mfma_f32_32x32x16_bf16 v[16:31], v[172:175], v[108:111], v[16:31]
ds_read_b128 v[104:107], v6 offset:4096
s_add_u32 m0, s64, 81920
s_nop 0
buffer_load_dwordx4 v3, s[12:15], s48 offen offset:0 lds
v_mul_f32 v61, v57, v49
v_fma_f32 v61, -v59, v50, v61
v_add_f32 v58, v58, v58
s_waitcnt lgkmcnt(2)
v_mfma_f32_32x32x16_bf16 v[16:31], v[176:179], v[96:99], v[16:31]
ds_read_b128 v[108:111], v7 offset:4096
v_and_b32 v55, 1, v52
v_lshlrev_b32 v55, 31, v55
s_waitcnt lgkmcnt(2)
v_mfma_f32_32x32x16_bf16 v[16:31], v[180:183], v[100:103], v[16:31]
ds_read_b128 v[96:99], v4 offset:5120
v_mul_f32 v60, v60, v58
v_mul_f32 v59, v61, v58
v_xor_b32 v57, v57, v55
s_waitcnt lgkmcnt(2)
v_mfma_f32_32x32x16_bf16 v[16:31], v[184:187], v[104:107], v[16:31]
ds_read_b128 v[100:103], v5 offset:5120
v_xor_b32 v58, v60, v55
v_sub_f32 v59, 0, v59
v_lshlrev_b32 v55, 4, v52
s_waitcnt lgkmcnt(2)
v_mfma_f32_32x32x16_bf16 v[16:31], v[188:191], v[108:111], v[16:31]
ds_read_b128 v[104:107], v6 offset:5120
v_add_u32 v55, 156672, v55
v_cmp_gt_u32 vcc, 288, v52
s_and_saveexec_b64 s[32:33], vcc
ds_write_b128 v55, v[56:59]
s_mov_b64 exec, s[32:33]
v_and_b32 v10, 31, v1
s_waitcnt lgkmcnt(3)
v_mfma_f32_32x32x16_bf16 v[16:31], v[192:195], v[96:99], v[16:31]
ds_read_b128 v[108:111], v7 offset:5120
s_lshl_b32 s30, s5, 5
v_add_u32 v10, s30, v10
v_lshlrev_b32 v8, 4, v10
s_waitcnt lgkmcnt(3)
v_mfma_f32_32x32x16_bf16 v[16:31], v[196:199], v[100:103], v[16:31]
ds_read_b128 v[96:99], v4 offset:6144
v_add_u32 v8, 156672, v8
v_lshrrev_b32 v11, 5, v1
s_lshl_b32 s30, s4, 1
s_waitcnt lgkmcnt(3)
v_mfma_f32_32x32x16_bf16 v[16:31], v[200:203], v[104:107], v[16:31]
ds_read_b128 v[100:103], v5 offset:6144
v_add_u32 v11, s30, v11
v_mul_u32_u24 v11, 288, v11
v_add_u32 v10, v10, v11
s_waitcnt lgkmcnt(2)
v_mfma_f32_32x32x16_bf16 v[16:31], v[204:207], v[108:111], v[16:31]
ds_read_b128 v[104:107], v6 offset:6144
v_lshlrev_b32 v9, 2, v10
v_add_u32 v9, 147456, v9
s_waitcnt lgkmcnt(2)
v_mfma_f32_32x32x16_bf16 v[16:31], v[208:211], v[96:99], v[16:31]
ds_read_b128 v[108:111], v7 offset:6144
v_and_b32 v80, 31, v1
v_lshrrev_b32 v81, 5, v1
v_lshlrev_b32 v80, 5, v80
v_lshl_add_u32 v84, v81, 4, v80
s_lshl_b32 s30, s6, 2
s_add_u32 s30, s30, s4
s_waitcnt lgkmcnt(2)
v_mfma_f32_32x32x16_bf16 v[16:31], v[212:215], v[100:103], v[16:31]
ds_read_b128 v[96:99], v4 offset:7168
s_mul_i32 s30, s30, 294912
s_mul_i32 s31, s49, 2048
s_add_u32 s31, s31, 8192
s_add_u32 s30, s30, s31
s_lshl_b32 s31, s5, 14
s_add_u32 s30, s30, s31
s_waitcnt lgkmcnt(2)
v_mfma_f32_32x32x16_bf16 v[16:31], v[216:219], v[104:107], v[16:31]
ds_read_b128 v[100:103], v5 offset:7168
v_add_u32 v84, s30, v84
v_mov_b32 v80, -1
v_mov_b32 v81, -1
v_mov_b32 v82, -1
v_mov_b32 v83, -1
s_waitcnt lgkmcnt(2)
v_mfma_f32_32x32x16_bf16 v[16:31], v[220:223], v[108:111], v[16:31]
ds_read_b128 v[104:107], v6 offset:7168
s_waitcnt lgkmcnt(2)
v_mfma_f32_32x32x16_bf16 v[16:31], v[224:227], v[96:99], v[16:31]
ds_read_b128 v[108:111], v7 offset:7168
s_add_u32 s36, s57, 2
s_cmp_ge_u32 s36, 9
s_cselect_b32 s37, 9, 0
s_sub_u32 s36, s36, s37
s_lshl_b32 s36, s36, 15
buffer_store_dwordx4 v[80:83], v84, s[20:23], s36 offen offset:0 sc0 sc1
s_waitcnt lgkmcnt(2)
v_mfma_f32_32x32x16_bf16 v[16:31], v[228:231], v[100:103], v[16:31]
ds_read_b128 v[96:99], v4 offset:8192
s_waitcnt lgkmcnt(2)
v_mfma_f32_32x32x16_bf16 v[16:31], v[232:235], v[104:107], v[16:31]
ds_read_b128 v[100:103], v5 offset:8192
s_waitcnt lgkmcnt(2)
v_mfma_f32_32x32x16_bf16 v[16:31], v[236:239], v[108:111], v[16:31]
ds_read_b128 v[104:107], v6 offset:8192
s_add_u32 s36, s57, 2
s_cmp_ge_u32 s36, 9
s_cselect_b32 s37, 9, 0
s_sub_u32 s36, s36, s37
s_lshl_b32 s36, s36, 15
buffer_store_dwordx4 v[80:83], v84, s[20:23], s36 offen offset:1024 sc0 sc1
s_waitcnt lgkmcnt(2)
v_mfma_f32_32x32x16_bf16 v[16:31], v[240:243], v[96:99], v[16:31]
ds_read_b128 v[108:111], v7 offset:8192
s_waitcnt lgkmcnt(2)
v_mfma_f32_32x32x16_bf16 v[16:31], v[244:247], v[100:103], v[16:31]
v_add_u32 v4, 73728, v4
v_add_u32 v5, 73728, v5
v_add_u32 v6, 73728, v6
v_add_u32 v7, 73728, v7
s_waitcnt vmcnt(2)
s_barrier
ds_read_b128 v[96:99], v4 offset:0
s_waitcnt lgkmcnt(2)
v_mfma_f32_32x32x16_bf16 v[16:31], v[248:251], v[104:107], v[16:31]
ds_read_b128 v[100:103], v5 offset:0
v_add_u32 v3, 36864, v3
s_waitcnt lgkmcnt(2)
v_mfma_f32_32x32x16_bf16 v[16:31], v[252:255], v[108:111], v[16:31]
ds_read_b128 v[104:107], v6 offset:0
s_add_u32 m0, s64, 0
s_nop 0
buffer_load_dwordx4 v3, s[12:15], s40 offen offset:0 lds
ds_read_b128 v[12:15], v8 offset:0
s_waitcnt lgkmcnt(3)
v_mfma_f32_32x32x16_bf16 v[32:47], v[112:115], v[96:99], 0
ds_read_b128 v[108:111], v7 offset:0
s_waitcnt lgkmcnt(3)
v_mfma_f32_32x32x16_bf16 v[32:47], v[116:119], v[100:103], v[32:47]
ds_read_b128 v[96:99], v4 offset:1024
buffer_load_dwordx4 v3, s[12:15], s41 offen offset:1024 lds
s_waitcnt lgkmcnt(3)
v_mfma_f32_32x32x16_bf16 v[32:47], v[120:123], v[104:107], v[32:47]
ds_read_b128 v[100:103], v5 offset:1024
s_waitcnt lgkmcnt(2)
v_mfma_f32_32x32x16_bf16 v[32:47], v[124:127], v[108:111], v[32:47]
ds_read_b128 v[104:107], v6 offset:1024
buffer_load_dwordx4 v3, s[12:15], s42 offen offset:2048 lds
v_mul_f32_dpp v2, v16, v15 quad_perm:[1,0,3,2] row_mask:0xf bank_mask:0xf
v_fma_f32 v16, v16, v14, v2
s_waitcnt lgkmcnt(2)
v_mfma_f32_32x32x16_bf16 v[32:47], v[128:131], v[96:99], v[32:47]
ds_read_b128 v[108:111], v7 offset:1024
v_mul_f32_dpp v10, v17, v15 quad_perm:[1,0,3,2] row_mask:0xf bank_mask:0xf
v_fma_f32 v17, v17, v14, v10
s_waitcnt lgkmcnt(2)
v_mfma_f32_32x32x16_bf16 v[32:47], v[132:135], v[100:103], v[32:47]
ds_read_b128 v[96:99], v4 offset:2048
buffer_load_dwordx4 v3, s[12:15], s43 offen offset:3072 lds
v_fma_f32 v11, v12, v16, v17
v_mul_f32_dpp v2, v18, v15 quad_perm:[1,0,3,2] row_mask:0xf bank_mask:0xf
v_fma_f32 v18, v18, v14, v2
s_waitcnt lgkmcnt(2)
v_mfma_f32_32x32x16_bf16 v[32:47], v[136:139], v[104:107], v[32:47]
ds_read_b128 v[100:103], v5 offset:2048
v_fmac_f32_dpp v11, v16, v13 quad_perm:[1,0,3,2] row_mask:0xf bank_mask:0xf
v_fma_f32 v10, v12, v11, v18
s_waitcnt lgkmcnt(2)
v_mfma_f32_32x32x16_bf16 v[32:47], v[140:143], v[108:111], v[32:47]
ds_read_b128 v[104:107], v6 offset:2048
s_add_u32 m0, s64, 4096
s_nop 0
buffer_load_dwordx4 v3, s[12:15], s44 offen offset:0 lds
v_mul_f32_dpp v2, v19, v15 quad_perm:[1,0,3,2] row_mask:0xf bank_mask:0xf
v_fma_f32 v19, v19, v14, v2
v_fmac_f32_dpp v10, v11, v13 quad_perm:[1,0,3,2] row_mask:0xf bank_mask:0xf
s_waitcnt lgkmcnt(2)
v_mfma_f32_32x32x16_bf16 v[32:47], v[144:147], v[96:99], v[32:47]
ds_read_b128 v[108:111], v7 offset:2048
v_fma_f32 v11, v12, v10, v19
v_mul_f32_dpp v2, v20, v15 quad_perm:[1,0,3,2] row_mask:0xf bank_mask:0xf
s_waitcnt lgkmcnt(2)
v_mfma_f32_32x32x16_bf16 v[32:47], v[148:151], v[100:103], v[32:47]
ds_read_b128 v[96:99], v4 offset:3072
buffer_load_dwordx4 v3, s[12:15], s45 offen offset:1024 lds
v_fma_f32 v20, v20, v14, v2
v_fmac_f32_dpp v11, v10, v13 quad_perm:[1,0,3,2] row_mask:0xf bank_mask:0xf
s_waitcnt lgkmcnt(2)
v_mfma_f32_32x32x16_bf16 v[32:47], v[152:155], v[104:107], v[32:47]
ds_read_b128 v[100:103], v5 offset:3072
v_fma_f32 v10, v12, v11, v20
v_mul_f32_dpp v2, v21, v15 quad_perm:[1,0,3,2] row_mask:0xf bank_mask:0xf
v_fma_f32 v21, v21, v14, v2
s_waitcnt lgkmcnt(2)
v_mfma_f32_32x32x16_bf16 v[32:47], v[156:159], v[108:111], v[32:47]
ds_read_b128 v[104:107], v6 offset:3072
buffer_load_dwordx4 v3, s[12:15], s46 offen offset:2048 lds
v_fmac_f32_dpp v10, v11, v13 quad_perm:[1,0,3,2] row_mask:0xf bank_mask:0xf
v_fma_f32 v11, v12, v10, v21
s_waitcnt lgkmcnt(2)
v_mfma_f32_32x32x16_bf16 v[32:47], v[160:163], v[96:99], v[32:47]
ds_read_b128 v[108:111], v7 offset:3072
v_mul_f32_dpp v2, v22, v15 quad_perm:[1,0,3,2] row_mask:0xf bank_mask:0xf
v_fma_f32 v22, v22, v14, v2
v_fmac_f32_dpp v11, v10, v13 quad_perm:[1,0,3,2] row_mask:0xf bank_mask:0xf
s_waitcnt lgkmcnt(2)
v_mfma_f32_32x32x16_bf16 v[32:47], v[164:167], v[100:103], v[32:47]
ds_read_b128 v[96:99], v4 offset:4096
buffer_load_dwordx4 v3, s[12:15], s47 offen offset:3072 lds
v_fma_f32 v10, v12, v11, v22
v_mul_f32_dpp v2, v23, v15 quad_perm:[1,0,3,2] row_mask:0xf bank_mask:0xf
s_waitcnt lgkmcnt(2)
v_mfma_f32_32x32x16_bf16 v[32:47], v[168:171], v[104:107], v[32:47]
ds_read_b128 v[100:103], v5 offset:4096
v_fma_f32 v23, v23, v14, v2
v_fmac_f32_dpp v10, v11, v13 quad_perm:[1,0,3,2] row_mask:0xf bank_mask:0xf
s_waitcnt lgkmcnt(2)
v_mfma_f32_32x32x16_bf16 v[32:47], v[172:175], v[108:111], v[32:47]
ds_read_b128 v[104:107], v6 offset:4096
s_add_u32 m0, s64, 8192
s_nop 0
buffer_load_dwordx4 v3, s[12:15], s48 offen offset:0 lds
v_fma_f32 v11, v12, v10, v23
v_mul_f32_dpp v2, v24, v15 quad_perm:[1,0,3,2] row_mask:0xf bank_mask:0xf
v_fma_f32 v24, v24, v14, v2
s_waitcnt lgkmcnt(2)
v_mfma_f32_32x32x16_bf16 v[32:47], v[176:179], v[96:99], v[32:47]
ds_read_b128 v[108:111], v7 offset:4096
s_cmp_lg_u32 s3, 0
s_cbranch_scc1 L_ann_s
s_lshl_b32 s28, s6, 4
s_add_u32 s28, s28, s7
v_mov_b32 v0, 1
s_mov_b64 exec, 1
buffer_store_byte v0, off, s[24:27], s28 sc0 sc1
s_mov_b64 exec, -1
L_ann_s:
v_fmac_f32_dpp v11, v10, v13 quad_perm:[1,0,3,2] row_mask:0xf bank_mask:0xf
v_fma_f32 v10, v12, v11, v24
s_waitcnt lgkmcnt(2)
v_mfma_f32_32x32x16_bf16 v[32:47], v[180:183], v[100:103], v[32:47]
ds_read_b128 v[96:99], v4 offset:5120
v_mul_f32_dpp v2, v25, v15 quad_perm:[1,0,3,2] row_mask:0xf bank_mask:0xf
v_fma_f32 v25, v25, v14, v2
v_fmac_f32_dpp v10, v11, v13 quad_perm:[1,0,3,2] row_mask:0xf bank_mask:0xf
s_waitcnt lgkmcnt(2)
v_mfma_f32_32x32x16_bf16 v[32:47], v[184:187], v[104:107], v[32:47]
ds_read_b128 v[100:103], v5 offset:5120
s_and_b32 s28, s6, 7
s_lshl_b32 s28, s28, 2
s_add_u32 s28, s28, s4
s_mul_i32 s28, s28, 20736
s_lshl_b32 s29, s49, 8
s_add_u32 s28, s28, s29
s_add_u32 s28, s28, 4096
v_mul_u32_u24 v0, 86, v1
v_lshrrev_b32 v0, 8, v0
v_mul_u32_u24 v0, 6, v0
v_add_u32 v0, v0, v1
v_lshlrev_b32 v0, 7, v0
buffer_load_dword v0, v0, s[16:19], s28 offen
v_fma_f32 v11, v12, v10, v25
v_mul_f32_dpp v2, v26, v15 quad_perm:[1,0,3,2] row_mask:0xf bank_mask:0xf
s_waitcnt lgkmcnt(2)
v_mfma_f32_32x32x16_bf16 v[32:47], v[188:191], v[108:111], v[32:47]
ds_read_b128 v[104:107], v6 offset:5120
s_add_u32 s36, s57, 5
s_cmp_ge_u32 s36, 9
s_cselect_b32 s37, 9, 0
s_sub_u32 s36, s36, s37
s_lshl_b32 s36, s36, 15
buffer_store_dwordx4 v[80:83], v84, s[20:23], s36 offen offset:0 sc0 sc1
v_fma_f32 v26, v26, v14, v2
v_fmac_f32_dpp v11, v10, v13 quad_perm:[1,0,3,2] row_mask:0xf bank_mask:0xf
s_waitcnt lgkmcnt(2)
v_mfma_f32_32x32x16_bf16 v[32:47], v[192:195], v[96:99], v[32:47]
ds_read_b128 v[108:111], v7 offset:5120
v_fma_f32 v10, v12, v11, v26
v_mul_f32_dpp v2, v27, v15 quad_perm:[1,0,3,2] row_mask:0xf bank_mask:0xf
v_fma_f32 v27, v27, v14, v2
s_waitcnt lgkmcnt(2)
v_mfma_f32_32x32x16_bf16 v[32:47], v[196:199], v[100:103], v[32:47]
ds_read_b128 v[96:99], v4 offset:6144
v_fmac_f32_dpp v10, v11, v13 quad_perm:[1,0,3,2] row_mask:0xf bank_mask:0xf
v_fma_f32 v11, v12, v10, v27
s_waitcnt lgkmcnt(2)
v_mfma_f32_32x32x16_bf16 v[32:47], v[200:203], v[104:107], v[32:47]
ds_read_b128 v[100:103], v5 offset:6144
v_mul_f32_dpp v2, v28, v15 quad_perm:[1,0,3,2] row_mask:0xf bank_mask:0xf
v_fma_f32 v28, v28, v14, v2
v_fmac_f32_dpp v11, v10, v13 quad_perm:[1,0,3,2] row_mask:0xf bank_mask:0xf
s_waitcnt lgkmcnt(2)
v_mfma_f32_32x32x16_bf16 v[32:47], v[204:207], v[108:111], v[32:47]
ds_read_b128 v[104:107], v6 offset:6144
s_add_u32 s36, s57, 5
s_cmp_ge_u32 s36, 9
s_cselect_b32 s37, 9, 0
s_sub_u32 s36, s36, s37
s_lshl_b32 s36, s36, 15
buffer_store_dwordx4 v[80:83], v84, s[20:23], s36 offen offset:1024 sc0 sc1
v_fma_f32 v10, v12, v11, v28
v_mul_f32_dpp v2, v29, v15 quad_perm:[1,0,3,2] row_mask:0xf bank_mask:0xf
s_waitcnt lgkmcnt(2)
v_mfma_f32_32x32x16_bf16 v[32:47], v[208:211], v[96:99], v[32:47]
ds_read_b128 v[108:111], v7 offset:6144
v_fma_f32 v29, v29, v14, v2
v_fmac_f32_dpp v10, v11, v13 quad_perm:[1,0,3,2] row_mask:0xf bank_mask:0xf
s_waitcnt lgkmcnt(2)
v_mfma_f32_32x32x16_bf16 v[32:47], v[212:215], v[100:103], v[32:47]
ds_read_b128 v[96:99], v4 offset:7168
v_fma_f32 v11, v12, v10, v29
v_mul_f32_dpp v2, v30, v15 quad_perm:[1,0,3,2] row_mask:0xf bank_mask:0xf
v_fma_f32 v30, v30, v14, v2
s_waitcnt lgkmcnt(2)
v_mfma_f32_32x32x16_bf16 v[32:47], v[216:219], v[104:107], v[32:47]
ds_read_b128 v[100:103], v5 offset:7168
v_fmac_f32_dpp v11, v10, v13 quad_perm:[1,0,3,2] row_mask:0xf bank_mask:0xf
v_fma_f32 v10, v12, v11, v30
s_waitcnt lgkmcnt(2)
v_mfma_f32_32x32x16_bf16 v[32:47], v[220:223], v[108:111], v[32:47]
ds_read_b128 v[104:107], v6 offset:7168
v_mul_f32_dpp v2, v31, v15 quad_perm:[1,0,3,2] row_mask:0xf bank_mask:0xf
v_fma_f32 v31, v31, v14, v2
v_fmac_f32_dpp v10, v11, v13 quad_perm:[1,0,3,2] row_mask:0xf bank_mask:0xf
s_waitcnt lgkmcnt(2)
v_mfma_f32_32x32x16_bf16 v[32:47], v[224:227], v[96:99], v[32:47]
ds_read_b128 v[108:111], v7 offset:7168
v_fma_f32 v11, v12, v10, v31
s_nop 1
s_waitcnt lgkmcnt(2)
v_mfma_f32_32x32x16_bf16 v[32:47], v[228:231], v[100:103], v[32:47]
ds_read_b128 v[96:99], v4 offset:8192
v_fmac_f32_dpp v11, v10, v13 quad_perm:[1,0,3,2] row_mask:0xf bank_mask:0xf
ds_write_b32 v9, v11 offset:0
s_waitcnt lgkmcnt(3)
v_mfma_f32_32x32x16_bf16 v[32:47], v[232:235], v[104:107], v[32:47]
ds_read_b128 v[100:103], v5 offset:8192
s_waitcnt lgkmcnt(3)
v_mfma_f32_32x32x16_bf16 v[32:47], v[236:239], v[108:111], v[32:47]
ds_read_b128 v[104:107], v6 offset:8192
s_waitcnt lgkmcnt(3)
v_mfma_f32_32x32x16_bf16 v[32:47], v[240:243], v[96:99], v[32:47]
ds_read_b128 v[108:111], v7 offset:8192
s_waitcnt lgkmcnt(2)
v_mfma_f32_32x32x16_bf16 v[32:47], v[244:247], v[100:103], v[32:47]
v_subrev_u32 v4, 73728, v4
v_subrev_u32 v5, 73728, v5
v_subrev_u32 v6, 73728, v6
v_subrev_u32 v7, 73728, v7
s_waitcnt vmcnt(3)
s_barrier
ds_read_b128 v[96:99], v4 offset:0
s_waitcnt lgkmcnt(2)
v_mfma_f32_32x32x16_bf16 v[32:47], v[248:251], v[104:107], v[32:47]
ds_read_b128 v[100:103], v5 offset:0
v_add_u32 v3, 36864, v3
s_waitcnt lgkmcnt(2)
v_mfma_f32_32x32x16_bf16 v[32:47], v[252:255], v[108:111], v[32:47]
ds_read_b128 v[104:107], v6 offset:0
s_add_u32 m0, s64, 73728
s_nop 0
buffer_load_dwordx4 v3, s[12:15], s40 offen offset:0 lds
ds_read_b128 v[12:15], v8 offset:1024
s_waitcnt lgkmcnt(3)
v_mfma_f32_32x32x16_bf16 v[48:63], v[112:115], v[96:99], 0
ds_read_b128 v[108:111], v7 offset:0
s_waitcnt lgkmcnt(3)
v_mfma_f32_32x32x16_bf16 v[48:63], v[116:119], v[100:103], v[48:63]
ds_read_b128 v[96:99], v4 offset:1024
buffer_load_dwordx4 v3, s[12:15], s41 offen offset:1024 lds
s_waitcnt lgkmcnt(3)
v_mfma_f32_32x32x16_bf16 v[48:63], v[120:123], v[104:107], v[48:63]
ds_read_b128 v[100:103], v5 offset:1024
s_waitcnt lgkmcnt(2)
v_mfma_f32_32x32x16_bf16 v[48:63], v[124:127], v[108:111], v[48:63]
ds_read_b128 v[104:107], v6 offset:1024
buffer_load_dwordx4 v3, s[12:15], s42 offen offset:2048 lds
v_mul_f32_dpp v2, v32, v15 quad_perm:[1,0,3,2] row_mask:0xf bank_mask:0xf
v_fma_f32 v32, v32, v14, v2
s_waitcnt lgkmcnt(2)
v_mfma_f32_32x32x16_bf16 v[48:63], v[128:131], v[96:99], v[48:63]
ds_read_b128 v[108:111], v7 offset:1024
v_mul_f32_dpp v10, v33, v15 quad_perm:[1,0,3,2] row_mask:0xf bank_mask:0xf
v_fma_f32 v33, v33, v14, v10
s_waitcnt lgkmcnt(2)
v_mfma_f32_32x32x16_bf16 v[48:63], v[132:135], v[100:103], v[48:63]
ds_read_b128 v[96:99], v4 offset:2048
buffer_load_dwordx4 v3, s[12:15], s43 offen offset:3072 lds
v_fma_f32 v11, v12, v32, v33
v_mul_f32_dpp v2, v34, v15 quad_perm:[1,0,3,2] row_mask:0xf bank_mask:0xf
v_fma_f32 v34, v34, v14, v2
s_waitcnt lgkmcnt(2)
v_mfma_f32_32x32x16_bf16 v[48:63], v[136:139], v[104:107], v[48:63]
ds_read_b128 v[100:103], v5 offset:2048
v_fmac_f32_dpp v11, v32, v13 quad_perm:[1,0,3,2] row_mask:0xf bank_mask:0xf
v_fma_f32 v10, v12, v11, v34
s_waitcnt lgkmcnt(2)
v_mfma_f32_32x32x16_bf16 v[48:63], v[140:143], v[108:111], v[48:63]
ds_read_b128 v[104:107], v6 offset:2048
s_add_u32 m0, s64, 77824
s_nop 0
buffer_load_dwordx4 v3, s[12:15], s44 offen offset:0 lds
v_mul_f32_dpp v2, v35, v15 quad_perm:[1,0,3,2] row_mask:0xf bank_mask:0xf
v_fma_f32 v35, v35, v14, v2
v_fmac_f32_dpp v10, v11, v13 quad_perm:[1,0,3,2] row_mask:0xf bank_mask:0xf
s_waitcnt lgkmcnt(2)
v_mfma_f32_32x32x16_bf16 v[48:63], v[144:147], v[96:99], v[48:63]
ds_read_b128 v[108:111], v7 offset:2048
v_fma_f32 v11, v12, v10, v35
v_mul_f32_dpp v2, v36, v15 quad_perm:[1,0,3,2] row_mask:0xf bank_mask:0xf
s_waitcnt lgkmcnt(2)
v_mfma_f32_32x32x16_bf16 v[48:63], v[148:151], v[100:103], v[48:63]
ds_read_b128 v[96:99], v4 offset:3072
buffer_load_dwordx4 v3, s[12:15], s45 offen offset:1024 lds
v_fma_f32 v36, v36, v14, v2
v_fmac_f32_dpp v11, v10, v13 quad_perm:[1,0,3,2] row_mask:0xf bank_mask:0xf
s_waitcnt lgkmcnt(2)
v_mfma_f32_32x32x16_bf16 v[48:63], v[152:155], v[104:107], v[48:63]
ds_read_b128 v[100:103], v5 offset:3072
v_fma_f32 v10, v12, v11, v36
v_mul_f32_dpp v2, v37, v15 quad_perm:[1,0,3,2] row_mask:0xf bank_mask:0xf
v_fma_f32 v37, v37, v14, v2
s_waitcnt lgkmcnt(2)
v_mfma_f32_32x32x16_bf16 v[48:63], v[156:159], v[108:111], v[48:63]
ds_read_b128 v[104:107], v6 offset:3072
buffer_load_dwordx4 v3, s[12:15], s46 offen offset:2048 lds
v_fmac_f32_dpp v10, v11, v13 quad_perm:[1,0,3,2] row_mask:0xf bank_mask:0xf
v_fma_f32 v11, v12, v10, v37
s_waitcnt lgkmcnt(2)
v_mfma_f32_32x32x16_bf16 v[48:63], v[160:163], v[96:99], v[48:63]
ds_read_b128 v[108:111], v7 offset:3072
v_mul_f32_dpp v2, v38, v15 quad_perm:[1,0,3,2] row_mask:0xf bank_mask:0xf
v_fma_f32 v38, v38, v14, v2
v_fmac_f32_dpp v11, v10, v13 quad_perm:[1,0,3,2] row_mask:0xf bank_mask:0xf
s_waitcnt lgkmcnt(2)
v_mfma_f32_32x32x16_bf16 v[48:63], v[164:167], v[100:103], v[48:63]
ds_read_b128 v[96:99], v4 offset:4096
buffer_load_dwordx4 v3, s[12:15], s47 offen offset:3072 lds
v_fma_f32 v10, v12, v11, v38
v_mul_f32_dpp v2, v39, v15 quad_perm:[1,0,3,2] row_mask:0xf bank_mask:0xf
s_waitcnt lgkmcnt(2)
v_mfma_f32_32x32x16_bf16 v[48:63], v[168:171], v[104:107], v[48:63]
ds_read_b128 v[100:103], v5 offset:4096
v_fma_f32 v39, v39, v14, v2
v_fmac_f32_dpp v10, v11, v13 quad_perm:[1,0,3,2] row_mask:0xf bank_mask:0xf
s_waitcnt lgkmcnt(2)
v_mfma_f32_32x32x16_bf16 v[48:63], v[172:175], v[108:111], v[48:63]
ds_read_b128 v[104:107], v6 offset:4096
s_add_u32 m0, s64, 81920
s_nop 0
buffer_load_dwordx4 v3, s[12:15], s48 offen offset:0 lds
v_fma_f32 v11, v12, v10, v39
v_mul_f32_dpp v2, v40, v15 quad_perm:[1,0,3,2] row_mask:0xf bank_mask:0xf
v_fma_f32 v40, v40, v14, v2
s_waitcnt lgkmcnt(2)
v_mfma_f32_32x32x16_bf16 v[48:63], v[176:179], v[96:99], v[48:63]
ds_read_b128 v[108:111], v7 offset:4096
v_fmac_f32_dpp v11, v10, v13 quad_perm:[1,0,3,2] row_mask:0xf bank_mask:0xf
v_fma_f32 v10, v12, v11, v40
s_waitcnt lgkmcnt(2)
v_mfma_f32_32x32x16_bf16 v[48:63], v[180:183], v[100:103], v[48:63]
ds_read_b128 v[96:99], v4 offset:5120
v_mul_f32_dpp v2, v41, v15 quad_perm:[1,0,3,2] row_mask:0xf bank_mask:0xf
v_fma_f32 v41, v41, v14, v2
v_fmac_f32_dpp v10, v11, v13 quad_perm:[1,0,3,2] row_mask:0xf bank_mask:0xf
s_waitcnt lgkmcnt(2)
v_mfma_f32_32x32x16_bf16 v[48:63], v[184:187], v[104:107], v[48:63]
ds_read_b128 v[100:103], v5 offset:5120
s_waitcnt vmcnt(11)
s_and_b32 s28, s6, 7
s_lshl_b32 s28, s28, 2
s_add_u32 s28, s28, s4
s_mul_i32 s28, s28, 20736
s_lshl_b32 s29, s49, 8
s_add_u32 s28, s28, s29
s_add_u32 s28, s28, 4160
v_mul_u32_u24 v0, 86, v1
v_lshrrev_b32 v0, 8, v0
v_mul_u32_u24 v0, 6, v0
v_add_u32 v0, v0, v1
v_lshlrev_b32 v0, 7, v0
buffer_load_dword v0, v0, s[16:19], s28 offen
v_fma_f32 v11, v12, v10, v41
v_mul_f32_dpp v2, v42, v15 quad_perm:[1,0,3,2] row_mask:0xf bank_mask:0xf
s_waitcnt lgkmcnt(2)
v_mfma_f32_32x32x16_bf16 v[48:63], v[188:191], v[108:111], v[48:63]
ds_read_b128 v[104:107], v6 offset:5120
s_add_u32 s36, s57, 8
s_cmp_ge_u32 s36, 9
s_cselect_b32 s37, 9, 0
s_sub_u32 s36, s36, s37
s_lshl_b32 s36, s36, 15
buffer_store_dwordx4 v[80:83], v84, s[20:23], s36 offen offset:0 sc0 sc1
v_fma_f32 v42, v42, v14, v2
v_fmac_f32_dpp v11, v10, v13 quad_perm:[1,0,3,2] row_mask:0xf bank_mask:0xf
s_waitcnt lgkmcnt(2)
v_mfma_f32_32x32x16_bf16 v[48:63], v[192:195], v[96:99], v[48:63]
ds_read_b128 v[108:111], v7 offset:5120
v_fma_f32 v10, v12, v11, v42
v_mul_f32_dpp v2, v43, v15 quad_perm:[1,0,3,2] row_mask:0xf bank_mask:0xf
v_fma_f32 v43, v43, v14, v2
s_waitcnt lgkmcnt(2)
v_mfma_f32_32x32x16_bf16 v[48:63], v[196:199], v[100:103], v[48:63]
ds_read_b128 v[96:99], v4 offset:6144
v_fmac_f32_dpp v10, v11, v13 quad_perm:[1,0,3,2] row_mask:0xf bank_mask:0xf
v_fma_f32 v11, v12, v10, v43
s_waitcnt lgkmcnt(2)
v_mfma_f32_32x32x16_bf16 v[48:63], v[200:203], v[104:107], v[48:63]
ds_read_b128 v[100:103], v5 offset:6144
v_mul_f32_dpp v2, v44, v15 quad_perm:[1,0,3,2] row_mask:0xf bank_mask:0xf
v_fma_f32 v44, v44, v14, v2
v_fmac_f32_dpp v11, v10, v13 quad_perm:[1,0,3,2] row_mask:0xf bank_mask:0xf
s_waitcnt lgkmcnt(2)
v_mfma_f32_32x32x16_bf16 v[48:63], v[204:207], v[108:111], v[48:63]
ds_read_b128 v[104:107], v6 offset:6144
s_add_u32 s36, s57, 8
s_cmp_ge_u32 s36, 9
s_cselect_b32 s37, 9, 0
s_sub_u32 s36, s36, s37
s_lshl_b32 s36, s36, 15
buffer_store_dwordx4 v[80:83], v84, s[20:23], s36 offen offset:1024 sc0 sc1
v_fma_f32 v10, v12, v11, v44
v_mul_f32_dpp v2, v45, v15 quad_perm:[1,0,3,2] row_mask:0xf bank_mask:0xf
s_waitcnt lgkmcnt(2)
v_mfma_f32_32x32x16_bf16 v[48:63], v[208:211], v[96:99], v[48:63]
ds_read_b128 v[108:111], v7 offset:6144
v_fma_f32 v45, v45, v14, v2
v_fmac_f32_dpp v10, v11, v13 quad_perm:[1,0,3,2] row_mask:0xf bank_mask:0xf
s_waitcnt lgkmcnt(2)
v_mfma_f32_32x32x16_bf16 v[48:63], v[212:215], v[100:103], v[48:63]
ds_read_b128 v[96:99], v4 offset:7168
v_fma_f32 v11, v12, v10, v45
v_mul_f32_dpp v2, v46, v15 quad_perm:[1,0,3,2] row_mask:0xf bank_mask:0xf
v_fma_f32 v46, v46, v14, v2
s_waitcnt lgkmcnt(2)
v_mfma_f32_32x32x16_bf16 v[48:63], v[216:219], v[104:107], v[48:63]
ds_read_b128 v[100:103], v5 offset:7168
v_fmac_f32_dpp v11, v10, v13 quad_perm:[1,0,3,2] row_mask:0xf bank_mask:0xf
v_fma_f32 v10, v12, v11, v46
s_waitcnt lgkmcnt(2)
v_mfma_f32_32x32x16_bf16 v[48:63], v[220:223], v[108:111], v[48:63]
ds_read_b128 v[104:107], v6 offset:7168
v_mul_f32_dpp v2, v47, v15 quad_perm:[1,0,3,2] row_mask:0xf bank_mask:0xf
v_fma_f32 v47, v47, v14, v2
v_fmac_f32_dpp v10, v11, v13 quad_perm:[1,0,3,2] row_mask:0xf bank_mask:0xf
s_waitcnt lgkmcnt(2)
v_mfma_f32_32x32x16_bf16 v[48:63], v[224:227], v[96:99], v[48:63]
ds_read_b128 v[108:111], v7 offset:7168
v_fma_f32 v11, v12, v10, v47
s_nop 1
s_waitcnt lgkmcnt(2)
v_mfma_f32_32x32x16_bf16 v[48:63], v[228:231], v[100:103], v[48:63]
ds_read_b128 v[96:99], v4 offset:8192
v_fmac_f32_dpp v11, v10, v13 quad_perm:[1,0,3,2] row_mask:0xf bank_mask:0xf
ds_write_b32 v9, v11 offset:256
s_waitcnt lgkmcnt(3)
v_mfma_f32_32x32x16_bf16 v[48:63], v[232:235], v[104:107], v[48:63]
ds_read_b128 v[100:103], v5 offset:8192
s_waitcnt lgkmcnt(3)
v_mfma_f32_32x32x16_bf16 v[48:63], v[236:239], v[108:111], v[48:63]
ds_read_b128 v[104:107], v6 offset:8192
s_waitcnt lgkmcnt(3)
v_mfma_f32_32x32x16_bf16 v[48:63], v[240:243], v[96:99], v[48:63]
ds_read_b128 v[108:111], v7 offset:8192
s_waitcnt lgkmcnt(2)
v_mfma_f32_32x32x16_bf16 v[48:63], v[244:247], v[100:103], v[48:63]
v_add_u32 v4, 73728, v4
v_add_u32 v5, 73728, v5
v_add_u32 v6, 73728, v6
v_add_u32 v7, 73728, v7
s_waitcnt vmcnt(3)
s_barrier
ds_read_b128 v[96:99], v4 offset:0
s_waitcnt lgkmcnt(2)
v_mfma_f32_32x32x16_bf16 v[48:63], v[248:251], v[104:107], v[48:63]
ds_read_b128 v[100:103], v5 offset:0
s_cmp_lg_u32 s3, 7
s_cbranch_scc1 L_ss0
v_lshlrev_b32 v85, 2, v1
buffer_load_dword v86, v85, s[24:27], 0 offen sc0 sc1
L_ss0:
v_add_u32 v3, 36864, v3
s_waitcnt lgkmcnt(2)
v_mfma_f32_32x32x16_bf16 v[48:63], v[252:255], v[108:111], v[48:63]
ds_read_b128 v[104:107], v6 offset:0
s_add_u32 m0, s64, 0
s_nop 0
buffer_load_dwordx4 v3, s[12:15], s40 offen offset:0 lds
ds_read_b128 v[12:15], v8 offset:2048
s_waitcnt lgkmcnt(3)
v_mfma_f32_32x32x16_bf16 v[64:79], v[112:115], v[96:99], 0
ds_read_b128 v[108:111], v7 offset:0
s_waitcnt lgkmcnt(3)
v_mfma_f32_32x32x16_bf16 v[64:79], v[116:119], v[100:103], v[64:79]
ds_read_b128 v[96:99], v4 offset:1024
buffer_load_dwordx4 v3, s[12:15], s41 offen offset:1024 lds
s_waitcnt lgkmcnt(3)
v_mfma_f32_32x32x16_bf16 v[64:79], v[120:123], v[104:107], v[64:79]
ds_read_b128 v[100:103], v5 offset:1024
s_waitcnt lgkmcnt(2)
v_mfma_f32_32x32x16_bf16 v[64:79], v[124:127], v[108:111], v[64:79]
ds_read_b128 v[104:107], v6 offset:1024
buffer_load_dwordx4 v3, s[12:15], s42 offen offset:2048 lds
v_mul_f32_dpp v2, v48, v15 quad_perm:[1,0,3,2] row_mask:0xf bank_mask:0xf
v_fma_f32 v48, v48, v14, v2
s_waitcnt lgkmcnt(2)
v_mfma_f32_32x32x16_bf16 v[64:79], v[128:131], v[96:99], v[64:79]
ds_read_b128 v[108:111], v7 offset:1024
v_mul_f32_dpp v10, v49, v15 quad_perm:[1,0,3,2] row_mask:0xf bank_mask:0xf
v_fma_f32 v49, v49, v14, v10
s_waitcnt lgkmcnt(2)
v_mfma_f32_32x32x16_bf16 v[64:79], v[132:135], v[100:103], v[64:79]
ds_read_b128 v[96:99], v4 offset:2048
buffer_load_dwordx4 v3, s[12:15], s43 offen offset:3072 lds
v_fma_f32 v11, v12, v48, v49
v_mul_f32_dpp v2, v50, v15 quad_perm:[1,0,3,2] row_mask:0xf bank_mask:0xf
v_fma_f32 v50, v50, v14, v2
s_waitcnt lgkmcnt(2)
v_mfma_f32_32x32x16_bf16 v[64:79], v[136:139], v[104:107], v[64:79]
ds_read_b128 v[100:103], v5 offset:2048
v_fmac_f32_dpp v11, v48, v13 quad_perm:[1,0,3,2] row_mask:0xf bank_mask:0xf
v_fma_f32 v10, v12, v11, v50
s_waitcnt lgkmcnt(2)
v_mfma_f32_32x32x16_bf16 v[64:79], v[140:143], v[108:111], v[64:79]
ds_read_b128 v[104:107], v6 offset:2048
s_add_u32 m0, s64, 4096
s_nop 0
buffer_load_dwordx4 v3, s[12:15], s44 offen offset:0 lds
v_mul_f32_dpp v2, v51, v15 quad_perm:[1,0,3,2] row_mask:0xf bank_mask:0xf
v_fma_f32 v51, v51, v14, v2
v_fmac_f32_dpp v10, v11, v13 quad_perm:[1,0,3,2] row_mask:0xf bank_mask:0xf
s_waitcnt lgkmcnt(2)
v_mfma_f32_32x32x16_bf16 v[64:79], v[144:147], v[96:99], v[64:79]
ds_read_b128 v[108:111], v7 offset:2048
v_fma_f32 v11, v12, v10, v51
v_mul_f32_dpp v2, v52, v15 quad_perm:[1,0,3,2] row_mask:0xf bank_mask:0xf
s_waitcnt lgkmcnt(2)
v_mfma_f32_32x32x16_bf16 v[64:79], v[148:151], v[100:103], v[64:79]
ds_read_b128 v[96:99], v4 offset:3072
buffer_load_dwordx4 v3, s[12:15], s45 offen offset:1024 lds
v_fma_f32 v52, v52, v14, v2
v_fmac_f32_dpp v11, v10, v13 quad_perm:[1,0,3,2] row_mask:0xf bank_mask:0xf
s_waitcnt lgkmcnt(2)
v_mfma_f32_32x32x16_bf16 v[64:79], v[152:155], v[104:107], v[64:79]
ds_read_b128 v[100:103], v5 offset:3072
v_fma_f32 v10, v12, v11, v52
v_mul_f32_dpp v2, v53, v15 quad_perm:[1,0,3,2] row_mask:0xf bank_mask:0xf
v_fma_f32 v53, v53, v14, v2
s_waitcnt lgkmcnt(2)
v_mfma_f32_32x32x16_bf16 v[64:79], v[156:159], v[108:111], v[64:79]
ds_read_b128 v[104:107], v6 offset:3072
buffer_load_dwordx4 v3, s[12:15], s46 offen offset:2048 lds
v_fmac_f32_dpp v10, v11, v13 quad_perm:[1,0,3,2] row_mask:0xf bank_mask:0xf
v_fma_f32 v11, v12, v10, v53
s_waitcnt lgkmcnt(2)
v_mfma_f32_32x32x16_bf16 v[64:79], v[160:163], v[96:99], v[64:79]
ds_read_b128 v[108:111], v7 offset:3072
v_mul_f32_dpp v2, v54, v15 quad_perm:[1,0,3,2] row_mask:0xf bank_mask:0xf
v_fma_f32 v54, v54, v14, v2
v_fmac_f32_dpp v11, v10, v13 quad_perm:[1,0,3,2] row_mask:0xf bank_mask:0xf
s_waitcnt lgkmcnt(2)
v_mfma_f32_32x32x16_bf16 v[64:79], v[164:167], v[100:103], v[64:79]
ds_read_b128 v[96:99], v4 offset:4096
buffer_load_dwordx4 v3, s[12:15], s47 offen offset:3072 lds
v_fma_f32 v10, v12, v11, v54
v_mul_f32_dpp v2, v55, v15 quad_perm:[1,0,3,2] row_mask:0xf bank_mask:0xf
s_waitcnt lgkmcnt(2)
v_mfma_f32_32x32x16_bf16 v[64:79], v[168:171], v[104:107], v[64:79]
ds_read_b128 v[100:103], v5 offset:4096
v_fma_f32 v55, v55, v14, v2
v_fmac_f32_dpp v10, v11, v13 quad_perm:[1,0,3,2] row_mask:0xf bank_mask:0xf
s_waitcnt lgkmcnt(2)
v_mfma_f32_32x32x16_bf16 v[64:79], v[172:175], v[108:111], v[64:79]
ds_read_b128 v[104:107], v6 offset:4096
s_add_u32 m0, s64, 8192
s_nop 0
buffer_load_dwordx4 v3, s[12:15], s48 offen offset:0 lds
v_fma_f32 v11, v12, v10, v55
v_mul_f32_dpp v2, v56, v15 quad_perm:[1,0,3,2] row_mask:0xf bank_mask:0xf
v_fma_f32 v56, v56, v14, v2
s_waitcnt lgkmcnt(2)
v_mfma_f32_32x32x16_bf16 v[64:79], v[176:179], v[96:99], v[64:79]
ds_read_b128 v[108:111], v7 offset:4096
v_fmac_f32_dpp v11, v10, v13 quad_perm:[1,0,3,2] row_mask:0xf bank_mask:0xf
v_fma_f32 v10, v12, v11, v56
s_waitcnt lgkmcnt(2)
v_mfma_f32_32x32x16_bf16 v[64:79], v[180:183], v[100:103], v[64:79]
ds_read_b128 v[96:99], v4 offset:5120
v_mul_f32_dpp v2, v57, v15 quad_perm:[1,0,3,2] row_mask:0xf bank_mask:0xf
v_fma_f32 v57, v57, v14, v2
v_fmac_f32_dpp v10, v11, v13 quad_perm:[1,0,3,2] row_mask:0xf bank_mask:0xf
s_waitcnt lgkmcnt(2)
v_mfma_f32_32x32x16_bf16 v[64:79], v[184:187], v[104:107], v[64:79]
ds_read_b128 v[100:103], v5 offset:5120
v_fma_f32 v11, v12, v10, v57
v_mul_f32_dpp v2, v58, v15 quad_perm:[1,0,3,2] row_mask:0xf bank_mask:0xf
s_waitcnt lgkmcnt(2)
v_mfma_f32_32x32x16_bf16 v[64:79], v[188:191], v[108:111], v[64:79]
ds_read_b128 v[104:107], v6 offset:5120
v_fma_f32 v58, v58, v14, v2
v_fmac_f32_dpp v11, v10, v13 quad_perm:[1,0,3,2] row_mask:0xf bank_mask:0xf
s_waitcnt lgkmcnt(2)
v_mfma_f32_32x32x16_bf16 v[64:79], v[192:195], v[96:99], v[64:79]
ds_read_b128 v[108:111], v7 offset:5120
v_fma_f32 v10, v12, v11, v58
v_mul_f32_dpp v2, v59, v15 quad_perm:[1,0,3,2] row_mask:0xf bank_mask:0xf
v_fma_f32 v59, v59, v14, v2
s_waitcnt lgkmcnt(2)
v_mfma_f32_32x32x16_bf16 v[64:79], v[196:199], v[100:103], v[64:79]
ds_read_b128 v[96:99], v4 offset:6144
v_fmac_f32_dpp v10, v11, v13 quad_perm:[1,0,3,2] row_mask:0xf bank_mask:0xf
v_fma_f32 v11, v12, v10, v59
s_waitcnt lgkmcnt(2)
v_mfma_f32_32x32x16_bf16 v[64:79], v[200:203], v[104:107], v[64:79]
ds_read_b128 v[100:103], v5 offset:6144
v_mul_f32_dpp v2, v60, v15 quad_perm:[1,0,3,2] row_mask:0xf bank_mask:0xf
v_fma_f32 v60, v60, v14, v2
v_fmac_f32_dpp v11, v10, v13 quad_perm:[1,0,3,2] row_mask:0xf bank_mask:0xf
s_waitcnt lgkmcnt(2)
v_mfma_f32_32x32x16_bf16 v[64:79], v[204:207], v[108:111], v[64:79]
ds_read_b128 v[104:107], v6 offset:6144
v_fma_f32 v10, v12, v11, v60
v_mul_f32_dpp v2, v61, v15 quad_perm:[1,0,3,2] row_mask:0xf bank_mask:0xf
s_waitcnt lgkmcnt(2)
v_mfma_f32_32x32x16_bf16 v[64:79], v[208:211], v[96:99], v[64:79]
ds_read_b128 v[108:111], v7 offset:6144
v_fma_f32 v61, v61, v14, v2
v_fmac_f32_dpp v10, v11, v13 quad_perm:[1,0,3,2] row_mask:0xf bank_mask:0xf
s_waitcnt lgkmcnt(2)
v_mfma_f32_32x32x16_bf16 v[64:79], v[212:215], v[100:103], v[64:79]
ds_read_b128 v[96:99], v4 offset:7168
v_fma_f32 v11, v12, v10, v61
v_mul_f32_dpp v2, v62, v15 quad_perm:[1,0,3,2] row_mask:0xf bank_mask:0xf
v_fma_f32 v62, v62, v14, v2
s_waitcnt lgkmcnt(2)
v_mfma_f32_32x32x16_bf16 v[64:79], v[216:219], v[104:107], v[64:79]
ds_read_b128 v[100:103], v5 offset:7168
v_fmac_f32_dpp v11, v10, v13 quad_perm:[1,0,3,2] row_mask:0xf bank_mask:0xf
v_fma_f32 v10, v12, v11, v62
s_waitcnt lgkmcnt(2)
v_mfma_f32_32x32x16_bf16 v[64:79], v[220:223], v[108:111], v[64:79]
ds_read_b128 v[104:107], v6 offset:7168
v_mul_f32_dpp v2, v63, v15 quad_perm:[1,0,3,2] row_mask:0xf bank_mask:0xf
v_fma_f32 v63, v63, v14, v2
v_fmac_f32_dpp v10, v11, v13 quad_perm:[1,0,3,2] row_mask:0xf bank_mask:0xf
s_waitcnt lgkmcnt(2)
v_mfma_f32_32x32x16_bf16 v[64:79], v[224:227], v[96:99], v[64:79]
ds_read_b128 v[108:111], v7 offset:7168
v_fma_f32 v11, v12, v10, v63
s_nop 1
s_waitcnt lgkmcnt(2)
v_mfma_f32_32x32x16_bf16 v[64:79], v[228:231], v[100:103], v[64:79]
ds_read_b128 v[96:99], v4 offset:8192
v_fmac_f32_dpp v11, v10, v13 quad_perm:[1,0,3,2] row_mask:0xf bank_mask:0xf
ds_write_b32 v9, v11 offset:512
s_waitcnt lgkmcnt(3)
v_mfma_f32_32x32x16_bf16 v[64:79], v[232:235], v[104:107], v[64:79]
ds_read_b128 v[100:103], v5 offset:8192
s_waitcnt lgkmcnt(3)
v_mfma_f32_32x32x16_bf16 v[64:79], v[236:239], v[108:111], v[64:79]
ds_read_b128 v[104:107], v6 offset:8192
s_waitcnt lgkmcnt(3)
v_mfma_f32_32x32x16_bf16 v[64:79], v[240:243], v[96:99], v[64:79]
ds_read_b128 v[108:111], v7 offset:8192
s_waitcnt lgkmcnt(2)
v_mfma_f32_32x32x16_bf16 v[64:79], v[244:247], v[100:103], v[64:79]
v_subrev_u32 v4, 73728, v4
v_subrev_u32 v5, 73728, v5
v_subrev_u32 v6, 73728, v6
v_subrev_u32 v7, 73728, v7
s_waitcnt vmcnt(0)
s_cmp_lg_u32 s3, 7
s_cbranch_scc1 L_ss1
v_and_b32 v86, 0x01010101, v86
v_cmp_ne_u32 vcc, 0x01010101, v86
s_cbranch_vccz L_ss1
v_lshlrev_b32 v85, 2, v1
s_movk_i32 s28, 0x4000
L_ss2:
buffer_load_dword v86, v85, s[24:27], 0 offen sc0 sc1
s_sub_u32 s28, s28, 1
s_cbranch_scc1 L_ss2_d
s_waitcnt vmcnt(0)
v_and_b32 v86, 0x01010101, v86
v_cmp_ne_u32 vcc, 0x01010101, v86
s_cbranch_vccnz L_ss2
L_ss2_d:
s_waitcnt vmcnt(0)
L_ss1:
s_barrier
ds_read_b128 v[96:99], v4 offset:0
s_waitcnt lgkmcnt(2)
v_mfma_f32_32x32x16_bf16 v[64:79], v[248:251], v[104:107], v[64:79]
ds_read_b128 v[100:103], v5 offset:0
s_waitcnt lgkmcnt(2)
v_mfma_f32_32x32x16_bf16 v[64:79], v[252:255], v[108:111], v[64:79]
ds_read_b128 v[104:107], v6 offset:0
ds_read_b128 v[12:15], v8 offset:3072
s_cmp_lg_u32 s5, 0
s_cbranch_scc1 L_s4b
s_waitcnt lgkmcnt(3)
v_mfma_f32_32x32x16_bf16 v[80:95], v[112:115], v[96:99], 0
ds_read_b128 v[108:111], v7 offset:0
s_waitcnt lgkmcnt(3)
v_mfma_f32_32x32x16_bf16 v[80:95], v[116:119], v[100:103], v[80:95]
ds_read_b128 v[96:99], v4 offset:1024
s_waitcnt lgkmcnt(3)
v_mfma_f32_32x32x16_bf16 v[80:95], v[120:123], v[104:107], v[80:95]
ds_read_b128 v[100:103], v5 offset:1024
s_and_b32 s30, s3, 1
s_lshl_b32 s30, s30, 8
s_bfe_u32 s31, s3, 0x10001
s_mul_i32 s31, s31, 36864
s_mul_i32 s32, s49, 288
s_add_u32 s31, s31, s32
s_waitcnt lgkmcnt(2)
v_mfma_f32_32x32x16_bf16 v[80:95], v[124:127], v[108:111], v[80:95]
ds_read_b128 v[104:107], v6 offset:1024
s_lshr_b32 s59, s3, 1
s_mul_i32 s59, s59, 9216
s_lshl_b32 s32, s30, 4
s_add_u32 s59, s59, s32
s_mul_i32 s61, s57, 73728
v_mul_f32_dpp v2, v64, v15 quad_perm:[1,0,3,2] row_mask:0xf bank_mask:0xf
v_fma_f32 v64, v64, v14, v2
s_waitcnt lgkmcnt(2)
v_mfma_f32_32x32x16_bf16 v[80:95], v[128:131], v[96:99], v[80:95]
ds_read_b128 v[108:111], v7 offset:1024
s_movk_i32 s33, 3641
v_add_u32 v117, s30, v1
v_add_u32 v117, 0, v117
v_mul_u32_u24 v118, s33, v117
v_lshrrev_b32 v118, 16, v118
v_mul_u32_u24 v119, 18, v118
v_mul_f32_dpp v10, v65, v15 quad_perm:[1,0,3,2] row_mask:0xf bank_mask:0xf
v_fma_f32 v65, v65, v14, v10
s_waitcnt lgkmcnt(2)
v_mfma_f32_32x32x16_bf16 v[80:95], v[132:135], v[100:103], v[80:95]
ds_read_b128 v[96:99], v4 offset:2048
v_sub_u32 v117, v117, v119
v_lshrrev_b32 v119, 4, v118
v_xor_b32 v117, v117, v119
v_and_b32 v112, 3, v118
v_lshrrev_b32 v119, 3, v118
v_fma_f32 v11, v12, v64, v65
v_mul_f32_dpp v2, v66, v15 quad_perm:[1,0,3,2] row_mask:0xf bank_mask:0xf
v_fma_f32 v66, v66, v14, v2
s_waitcnt lgkmcnt(2)
v_mfma_f32_32x32x16_bf16 v[80:95], v[136:139], v[104:107], v[80:95]
ds_read_b128 v[100:103], v5 offset:2048
v_lshl_add_u32 v112, v119, 2, v112
v_bfe_u32 v119, v118, 2, 1
v_lshl_add_u32 v112, v119, 4, v112
v_mul_u32_u24 v112, 1152, v112
v_lshl_add_u32 v112, v117, 4, v112
v_fmac_f32_dpp v11, v64, v13 quad_perm:[1,0,3,2] row_mask:0xf bank_mask:0xf
v_fma_f32 v10, v12, v11, v66
s_waitcnt lgkmcnt(2)
v_mfma_f32_32x32x16_bf16 v[80:95], v[140:143], v[108:111], v[80:95]
ds_read_b128 v[104:107], v6 offset:2048
v_add_u32 v112, s31, v112
v_add_u32 v112, 4096, v112
v_add_u32 v117, s30, v1
v_add_u32 v117, 64, v117
v_mul_u32_u24 v118, s33, v117
v_lshrrev_b32 v118, 16, v118
v_mul_f32_dpp v2, v67, v15 quad_perm:[1,0,3,2] row_mask:0xf bank_mask:0xf
v_fma_f32 v67, v67, v14, v2
v_fmac_f32_dpp v10, v11, v13 quad_perm:[1,0,3,2] row_mask:0xf bank_mask:0xf
s_waitcnt lgkmcnt(2)
v_mfma_f32_32x32x16_bf16 v[80:95], v[144:147], v[96:99], v[80:95]
ds_read_b128 v[108:111], v7 offset:2048
v_mul_u32_u24 v119, 18, v118
v_sub_u32 v117, v117, v119
v_lshrrev_b32 v119, 4, v118
v_xor_b32 v117, v117, v119
v_and_b32 v113, 3, v118
v_fma_f32 v11, v12, v10, v67
v_mul_f32_dpp v2, v68, v15 quad_perm:[1,0,3,2] row_mask:0xf bank_mask:0xf
s_waitcnt lgkmcnt(2)
v_mfma_f32_32x32x16_bf16 v[80:95], v[148:151], v[100:103], v[80:95]
ds_read_b128 v[96:99], v4 offset:3072
v_lshrrev_b32 v119, 3, v118
v_lshl_add_u32 v113, v119, 2, v113
v_bfe_u32 v119, v118, 2, 1
v_lshl_add_u32 v113, v119, 4, v113
v_mul_u32_u24 v113, 1152, v113
v_lshl_add_u32 v113, v117, 4, v113
v_fma_f32 v68, v68, v14, v2
v_fmac_f32_dpp v11, v10, v13 quad_perm:[1,0,3,2] row_mask:0xf bank_mask:0xf
s_waitcnt lgkmcnt(2)
v_mfma_f32_32x32x16_bf16 v[80:95], v[152:155], v[104:107], v[80:95]
ds_read_b128 v[100:103], v5 offset:3072
v_add_u32 v113, s31, v113
v_add_u32 v113, 3072, v113
v_add_u32 v117, s30, v1
v_add_u32 v117, 128, v117
v_mul_u32_u24 v118, s33, v117
v_fma_f32 v10, v12, v11, v68
v_mul_f32_dpp v2, v69, v15 quad_perm:[1,0,3,2] row_mask:0xf bank_mask:0xf
v_fma_f32 v69, v69, v14, v2
s_waitcnt lgkmcnt(2)
v_mfma_f32_32x32x16_bf16 v[80:95], v[156:159], v[108:111], v[80:95]
ds_read_b128 v[104:107], v6 offset:3072
v_lshrrev_b32 v118, 16, v118
v_mul_u32_u24 v119, 18, v118
v_sub_u32 v117, v117, v119
v_lshrrev_b32 v119, 4, v118
v_xor_b32 v117, v117, v119
v_fmac_f32_dpp v10, v11, v13 quad_perm:[1,0,3,2] row_mask:0xf bank_mask:0xf
v_fma_f32 v11, v12, v10, v69
s_waitcnt lgkmcnt(2)
v_mfma_f32_32x32x16_bf16 v[80:95], v[160:163], v[96:99], v[80:95]
ds_read_b128 v[108:111], v7 offset:3072
v_and_b32 v114, 3, v118
v_lshrrev_b32 v119, 3, v118
v_lshl_add_u32 v114, v119, 2, v114
v_bfe_u32 v119, v118, 2, 1
v_lshl_add_u32 v114, v119, 4, v114
v_mul_u32_u24 v114, 1152, v114
v_mul_f32_dpp v2, v70, v15 quad_perm:[1,0,3,2] row_mask:0xf bank_mask:0xf
v_fma_f32 v70, v70, v14, v2
v_fmac_f32_dpp v11, v10, v13 quad_perm:[1,0,3,2] row_mask:0xf bank_mask:0xf
s_waitcnt lgkmcnt(2)
v_mfma_f32_32x32x16_bf16 v[80:95], v[164:167], v[100:103], v[80:95]
ds_read_b128 v[96:99], v4 offset:4096
v_lshl_add_u32 v114, v117, 4, v114
v_add_u32 v114, s31, v114
v_add_u32 v114, 2048, v114
v_add_u32 v117, s30, v1
v_add_u32 v117, 192, v117
v_fma_f32 v10, v12, v11, v70
v_mul_f32_dpp v2, v71, v15 quad_perm:[1,0,3,2] row_mask:0xf bank_mask:0xf
s_waitcnt lgkmcnt(2)
v_mfma_f32_32x32x16_bf16 v[80:95], v[168:171], v[104:107], v[80:95]
ds_read_b128 v[100:103], v5 offset:4096
v_mul_u32_u24 v118, s33, v117
v_lshrrev_b32 v118, 16, v118
v_mul_u32_u24 v119, 18, v118
v_sub_u32 v117, v117, v119
v_lshrrev_b32 v119, 4, v118
v_xor_b32 v117, v117, v119
v_fma_f32 v71, v71, v14, v2
v_fmac_f32_dpp v10, v11, v13 quad_perm:[1,0,3,2] row_mask:0xf bank_mask:0xf
s_waitcnt lgkmcnt(2)
v_mfma_f32_32x32x16_bf16 v[80:95], v[172:175], v[108:111], v[80:95]
ds_read_b128 v[104:107], v6 offset:4096
v_and_b32 v115, 3, v118
v_lshrrev_b32 v119, 3, v118
v_lshl_add_u32 v115, v119, 2, v115
v_bfe_u32 v119, v118, 2, 1
v_lshl_add_u32 v115, v119, 4, v115
v_fma_f32 v11, v12, v10, v71
v_mul_f32_dpp v2, v72, v15 quad_perm:[1,0,3,2] row_mask:0xf bank_mask:0xf
v_fma_f32 v72, v72, v14, v2
s_waitcnt lgkmcnt(2)
v_mfma_f32_32x32x16_bf16 v[80:95], v[176:179], v[96:99], v[80:95]
ds_read_b128 v[108:111], v7 offset:4096
v_mul_u32_u24 v115, 1152, v115
v_lshl_add_u32 v115, v117, 4, v115
v_add_u32 v115, s31, v115
v_add_u32 v115, 1024, v115
v_add_u32 v117, s30, v1
v_fmac_f32_dpp v11, v10, v13 quad_perm:[1,0,3,2] row_mask:0xf bank_mask:0xf
v_fma_f32 v10, v12, v11, v72
s_waitcnt lgkmcnt(2)
v_mfma_f32_32x32x16_bf16 v[80:95], v[180:183], v[100:103], v[80:95]
ds_read_b128 v[96:99], v4 offset:5120
v_add_u32 v117, 256, v117
v_mul_u32_u24 v118, s33, v117
v_lshrrev_b32 v118, 16, v118
v_mul_u32_u24 v119, 18, v118
v_sub_u32 v117, v117, v119
v_lshrrev_b32 v119, 4, v118
v_mul_f32_dpp v2, v73, v15 quad_perm:[1,0,3,2] row_mask:0xf bank_mask:0xf
v_fma_f32 v73, v73, v14, v2
v_fmac_f32_dpp v10, v11, v13 quad_perm:[1,0,3,2] row_mask:0xf bank_mask:0xf
s_waitcnt lgkmcnt(2)
v_mfma_f32_32x32x16_bf16 v[80:95], v[184:187], v[104:107], v[80:95]
ds_read_b128 v[100:103], v5 offset:5120
v_xor_b32 v117, v117, v119
v_and_b32 v116, 3, v118
v_lshrrev_b32 v119, 3, v118
v_lshl_add_u32 v116, v119, 2, v116
v_bfe_u32 v119, v118, 2, 1
v_fma_f32 v11, v12, v10, v73
v_mul_f32_dpp v2, v74, v15 quad_perm:[1,0,3,2] row_mask:0xf bank_mask:0xf
s_waitcnt lgkmcnt(2)
v_mfma_f32_32x32x16_bf16 v[80:95], v[188:191], v[108:111], v[80:95]
ds_read_b128 v[104:107], v6 offset:5120
v_lshl_add_u32 v116, v119, 4, v116
v_mul_u32_u24 v116, 1152, v116
v_lshl_add_u32 v116, v117, 4, v116
v_add_u32 v116, s31, v116
v_add_u32 v116, 4096, v116
v_fma_f32 v74, v74, v14, v2
v_fmac_f32_dpp v11, v10, v13 quad_perm:[1,0,3,2] row_mask:0xf bank_mask:0xf
s_waitcnt lgkmcnt(2)
v_mfma_f32_32x32x16_bf16 v[80:95], v[192:195], v[96:99], v[80:95]
ds_read_b128 v[108:111], v7 offset:5120
v_fma_f32 v10, v12, v11, v74
v_mul_f32_dpp v2, v75, v15 quad_perm:[1,0,3,2] row_mask:0xf bank_mask:0xf
v_fma_f32 v75, v75, v14, v2
s_waitcnt lgkmcnt(2)
v_mfma_f32_32x32x16_bf16 v[80:95], v[196:199], v[100:103], v[80:95]
ds_read_b128 v[96:99], v4 offset:6144
s_add_u32 m0, s59, 73728
s_nop 0
buffer_load_dwordx4 v112, s[16:19], s61 offen offset:0 lds
v_fmac_f32_dpp v10, v11, v13 quad_perm:[1,0,3,2] row_mask:0xf bank_mask:0xf
v_fma_f32 v11, v12, v10, v75
s_waitcnt lgkmcnt(2)
v_mfma_f32_32x32x16_bf16 v[80:95], v[200:203], v[104:107], v[80:95]
ds_read_b128 v[100:103], v5 offset:6144
buffer_load_dwordx4 v113, s[16:19], s61 offen offset:1024 lds
v_mul_f32_dpp v2, v76, v15 quad_perm:[1,0,3,2] row_mask:0xf bank_mask:0xf
v_fma_f32 v76, v76, v14, v2
v_fmac_f32_dpp v11, v10, v13 quad_perm:[1,0,3,2] row_mask:0xf bank_mask:0xf
s_waitcnt lgkmcnt(2)
v_mfma_f32_32x32x16_bf16 v[80:95], v[204:207], v[108:111], v[80:95]
ds_read_b128 v[104:107], v6 offset:6144
buffer_load_dwordx4 v114, s[16:19], s61 offen offset:2048 lds
v_fma_f32 v10, v12, v11, v76
v_mul_f32_dpp v2, v77, v15 quad_perm:[1,0,3,2] row_mask:0xf bank_mask:0xf
s_waitcnt lgkmcnt(2)
v_mfma_f32_32x32x16_bf16 v[80:95], v[208:211], v[96:99], v[80:95]
ds_read_b128 v[108:111], v7 offset:6144
buffer_load_dwordx4 v115, s[16:19], s61 offen offset:3072 lds
v_fma_f32 v77, v77, v14, v2
v_fmac_f32_dpp v10, v11, v13 quad_perm:[1,0,3,2] row_mask:0xf bank_mask:0xf
s_waitcnt lgkmcnt(2)
v_mfma_f32_32x32x16_bf16 v[80:95], v[212:215], v[100:103], v[80:95]
ds_read_b128 v[96:99], v4 offset:7168
s_add_u32 m0, s59, 77824
s_nop 0
buffer_load_dwordx4 v116, s[16:19], s61 offen offset:0 lds
s_add_u32 s61, s61, 221184
s_cmp_ge_u32 s61, 663552
s_cselect_b32 s35, 663552, 0
s_sub_u32 s61, s61, s35
v_fma_f32 v11, v12, v10, v77
v_mul_f32_dpp v2, v78, v15 quad_perm:[1,0,3,2] row_mask:0xf bank_mask:0xf
v_fma_f32 v78, v78, v14, v2
s_waitcnt lgkmcnt(2)
v_mfma_f32_32x32x16_bf16 v[80:95], v[216:219], v[104:107], v[80:95]
ds_read_b128 v[100:103], v5 offset:7168
s_add_u32 m0, s59, 110592
s_nop 0
buffer_load_dwordx4 v112, s[16:19], s61 offen offset:0 lds
v_fmac_f32_dpp v11, v10, v13 quad_perm:[1,0,3,2] row_mask:0xf bank_mask:0xf
v_fma_f32 v10, v12, v11, v78
s_waitcnt lgkmcnt(2)
v_mfma_f32_32x32x16_bf16 v[80:95], v[220:223], v[108:111], v[80:95]
ds_read_b128 v[104:107], v6 offset:7168
buffer_load_dwordx4 v113, s[16:19], s61 offen offset:1024 lds
v_mul_f32_dpp v2, v79, v15 quad_perm:[1,0,3,2] row_mask:0xf bank_mask:0xf
v_fma_f32 v79, v79, v14, v2
v_fmac_f32_dpp v10, v11, v13 quad_perm:[1,0,3,2] row_mask:0xf bank_mask:0xf
s_waitcnt lgkmcnt(2)
v_mfma_f32_32x32x16_bf16 v[80:95], v[224:227], v[96:99], v[80:95]
ds_read_b128 v[108:111], v7 offset:7168
buffer_load_dwordx4 v114, s[16:19], s61 offen offset:2048 lds
v_fma_f32 v11, v12, v10, v79
s_nop 1
s_waitcnt lgkmcnt(2)
v_mfma_f32_32x32x16_bf16 v[80:95], v[228:231], v[100:103], v[80:95]
ds_read_b128 v[96:99], v4 offset:8192
buffer_load_dwordx4 v115, s[16:19], s61 offen offset:3072 lds
v_fmac_f32_dpp v11, v10, v13 quad_perm:[1,0,3,2] row_mask:0xf bank_mask:0xf
ds_write_b32 v9, v11 offset:768
s_waitcnt lgkmcnt(3)
v_mfma_f32_32x32x16_bf16 v[80:95], v[232:235], v[104:107], v[80:95]
ds_read_b128 v[100:103], v5 offset:8192
s_add_u32 m0, s59, 114688
s_nop 0
buffer_load_dwordx4 v116, s[16:19], s61 offen offset:0 lds
s_add_u32 s61, s61, 221184
s_cmp_ge_u32 s61, 663552
s_cselect_b32 s35, 663552, 0
s_sub_u32 s61, s61, s35
s_waitcnt lgkmcnt(3)
v_mfma_f32_32x32x16_bf16 v[80:95], v[236:239], v[108:111], v[80:95]
ds_read_b128 v[104:107], v6 offset:8192
s_waitcnt lgkmcnt(3)
v_mfma_f32_32x32x16_bf16 v[80:95], v[240:243], v[96:99], v[80:95]
ds_read_b128 v[108:111], v7 offset:8192
s_waitcnt lgkmcnt(2)
v_mfma_f32_32x32x16_bf16 v[80:95], v[244:247], v[100:103], v[80:95]
s_waitcnt lgkmcnt(1)
v_mfma_f32_32x32x16_bf16 v[80:95], v[248:251], v[104:107], v[80:95]
ds_read_b128 v[12:15], v8 offset:4096
s_waitcnt lgkmcnt(1)
v_mfma_f32_32x32x16_bf16 v[80:95], v[252:255], v[108:111], v[80:95]
s_nop 7
s_nop 3
s_waitcnt lgkmcnt(0)
v_mul_f32_dpp v2, v80, v15 quad_perm:[1,0,3,2] row_mask:0xf bank_mask:0xf
v_fma_f32 v80, v80, v14, v2
v_mul_f32_dpp v10, v81, v15 quad_perm:[1,0,3,2] row_mask:0xf bank_mask:0xf
v_fma_f32 v81, v81, v14, v10
v_fma_f32 v11, v12, v80, v81
v_mul_f32_dpp v2, v82, v15 quad_perm:[1,0,3,2] row_mask:0xf bank_mask:0xf
v_fma_f32 v82, v82, v14, v2
v_fmac_f32_dpp v11, v80, v13 quad_perm:[1,0,3,2] row_mask:0xf bank_mask:0xf
v_fma_f32 v10, v12, v11, v82
v_mul_f32_dpp v2, v83, v15 quad_perm:[1,0,3,2] row_mask:0xf bank_mask:0xf
v_fma_f32 v83, v83, v14, v2
v_fmac_f32_dpp v10, v11, v13 quad_perm:[1,0,3,2] row_mask:0xf bank_mask:0xf
v_fma_f32 v11, v12, v10, v83
v_mul_f32_dpp v2, v84, v15 quad_perm:[1,0,3,2] row_mask:0xf bank_mask:0xf
v_fma_f32 v84, v84, v14, v2
v_fmac_f32_dpp v11, v10, v13 quad_perm:[1,0,3,2] row_mask:0xf bank_mask:0xf
v_fma_f32 v10, v12, v11, v84
v_mul_f32_dpp v2, v85, v15 quad_perm:[1,0,3,2] row_mask:0xf bank_mask:0xf
v_fma_f32 v85, v85, v14, v2
v_fmac_f32_dpp v10, v11, v13 quad_perm:[1,0,3,2] row_mask:0xf bank_mask:0xf
v_fma_f32 v11, v12, v10, v85
v_mul_f32_dpp v2, v86, v15 quad_perm:[1,0,3,2] row_mask:0xf bank_mask:0xf
v_fma_f32 v86, v86, v14, v2
v_fmac_f32_dpp v11, v10, v13 quad_perm:[1,0,3,2] row_mask:0xf bank_mask:0xf
v_fma_f32 v10, v12, v11, v86
v_mul_f32_dpp v2, v87, v15 quad_perm:[1,0,3,2] row_mask:0xf bank_mask:0xf
v_fma_f32 v87, v87, v14, v2
v_fmac_f32_dpp v10, v11, v13 quad_perm:[1,0,3,2] row_mask:0xf bank_mask:0xf
v_fma_f32 v11, v12, v10, v87
v_mul_f32_dpp v2, v88, v15 quad_perm:[1,0,3,2] row_mask:0xf bank_mask:0xf
v_fma_f32 v88, v88, v14, v2
v_fmac_f32_dpp v11, v10, v13 quad_perm:[1,0,3,2] row_mask:0xf bank_mask:0xf
v_fma_f32 v10, v12, v11, v88
v_mul_f32_dpp v2, v89, v15 quad_perm:[1,0,3,2] row_mask:0xf bank_mask:0xf
v_fma_f32 v89, v89, v14, v2
v_fmac_f32_dpp v10, v11, v13 quad_perm:[1,0,3,2] row_mask:0xf bank_mask:0xf
v_fma_f32 v11, v12, v10, v89
v_mul_f32_dpp v2, v90, v15 quad_perm:[1,0,3,2] row_mask:0xf bank_mask:0xf
v_fma_f32 v90, v90, v14, v2
v_fmac_f32_dpp v11, v10, v13 quad_perm:[1,0,3,2] row_mask:0xf bank_mask:0xf
v_fma_f32 v10, v12, v11, v90
v_mul_f32_dpp v2, v91, v15 quad_perm:[1,0,3,2] row_mask:0xf bank_mask:0xf
v_fma_f32 v91, v91, v14, v2
v_fmac_f32_dpp v10, v11, v13 quad_perm:[1,0,3,2] row_mask:0xf bank_mask:0xf
v_fma_f32 v11, v12, v10, v91
v_mul_f32_dpp v2, v92, v15 quad_perm:[1,0,3,2] row_mask:0xf bank_mask:0xf
v_fma_f32 v92, v92, v14, v2
v_fmac_f32_dpp v11, v10, v13 quad_perm:[1,0,3,2] row_mask:0xf bank_mask:0xf
v_fma_f32 v10, v12, v11, v92
v_mul_f32_dpp v2, v93, v15 quad_perm:[1,0,3,2] row_mask:0xf bank_mask:0xf
v_fma_f32 v93, v93, v14, v2
v_fmac_f32_dpp v10, v11, v13 quad_perm:[1,0,3,2] row_mask:0xf bank_mask:0xf
v_fma_f32 v11, v12, v10, v93
v_mul_f32_dpp v2, v94, v15 quad_perm:[1,0,3,2] row_mask:0xf bank_mask:0xf
v_fma_f32 v94, v94, v14, v2
v_fmac_f32_dpp v11, v10, v13 quad_perm:[1,0,3,2] row_mask:0xf bank_mask:0xf
v_fma_f32 v10, v12, v11, v94
v_mul_f32_dpp v2, v95, v15 quad_perm:[1,0,3,2] row_mask:0xf bank_mask:0xf
v_fma_f32 v95, v95, v14, v2
v_fmac_f32_dpp v10, v11, v13 quad_perm:[1,0,3,2] row_mask:0xf bank_mask:0xf
v_fma_f32 v11, v12, v10, v95
s_nop 1
v_fmac_f32_dpp v11, v10, v13 quad_perm:[1,0,3,2] row_mask:0xf bank_mask:0xf
ds_write_b32 v9, v11 offset:1024
s_waitcnt lgkmcnt(0)
s_branch L_s4j
L_s4b:
s_and_b32 s30, s3, 1
s_lshl_b32 s30, s30, 8
s_bfe_u32 s31, s3, 0x10001
s_mul_i32 s31, s31, 36864
s_mul_i32 s32, s49, 288
s_add_u32 s31, s31, s32
s_lshr_b32 s59, s3, 1
s_mul_i32 s59, s59, 9216
s_lshl_b32 s32, s30, 4
s_add_u32 s59, s59, s32
s_mul_i32 s61, s57, 73728
s_movk_i32 s33, 3641
v_add_u32 v117, s30, v1
v_add_u32 v117, 0, v117
v_mul_u32_u24 v118, s33, v117
v_lshrrev_b32 v118, 16, v118
v_mul_u32_u24 v119, 18, v118
v_sub_u32 v117, v117, v119
v_lshrrev_b32 v119, 4, v118
v_xor_b32 v117, v117, v119
v_and_b32 v112, 3, v118
v_lshrrev_b32 v119, 3, v118
v_lshl_add_u32 v112, v119, 2, v112
v_bfe_u32 v119, v118, 2, 1
v_lshl_add_u32 v112, v119, 4, v112
v_mul_u32_u24 v112, 1152, v112
v_lshl_add_u32 v112, v117, 4, v112
v_add_u32 v112, s31, v112
v_add_u32 v112, 4096, v112
v_add_u32 v117, s30, v1
v_add_u32 v117, 64, v117
v_mul_u32_u24 v118, s33, v117
v_lshrrev_b32 v118, 16, v118
v_mul_u32_u24 v119, 18, v118
v_sub_u32 v117, v117, v119
v_lshrrev_b32 v119, 4, v118
v_xor_b32 v117, v117, v119
v_and_b32 v113, 3, v118
v_lshrrev_b32 v119, 3, v118
v_lshl_add_u32 v113, v119, 2, v113
v_bfe_u32 v119, v118, 2, 1
v_lshl_add_u32 v113, v119, 4, v113
v_mul_u32_u24 v113, 1152, v113
v_lshl_add_u32 v113, v117, 4, v113
v_add_u32 v113, s31, v113
v_add_u32 v113, 3072, v113
v_add_u32 v117, s30, v1
v_add_u32 v117, 128, v117
v_mul_u32_u24 v118, s33, v117
v_lshrrev_b32 v118, 16, v118
v_mul_u32_u24 v119, 18, v118
v_sub_u32 v117, v117, v119
v_lshrrev_b32 v119, 4, v118
v_xor_b32 v117, v117, v119
v_and_b32 v114, 3, v118
v_lshrrev_b32 v119, 3, v118
v_lshl_add_u32 v114, v119, 2, v114
v_bfe_u32 v119, v118, 2, 1
v_lshl_add_u32 v114, v119, 4, v114
v_mul_u32_u24 v114, 1152, v114
v_lshl_add_u32 v114, v117, 4, v114
v_add_u32 v114, s31, v114
v_add_u32 v114, 2048, v114
v_add_u32 v117, s30, v1
v_add_u32 v117, 192, v117
v_mul_u32_u24 v118, s33, v117
v_lshrrev_b32 v118, 16, v118
v_mul_u32_u24 v119, 18, v118
v_sub_u32 v117, v117, v119
v_lshrrev_b32 v119, 4, v118
v_xor_b32 v117, v117, v119
v_and_b32 v115, 3, v118
v_lshrrev_b32 v119, 3, v118
v_lshl_add_u32 v115, v119, 2, v115
v_bfe_u32 v119, v118, 2, 1
v_lshl_add_u32 v115, v119, 4, v115
v_mul_u32_u24 v115, 1152, v115
v_lshl_add_u32 v115, v117, 4, v115
v_add_u32 v115, s31, v115
v_add_u32 v115, 1024, v115
v_add_u32 v117, s30, v1
v_add_u32 v117, 256, v117
v_mul_u32_u24 v118, s33, v117
v_lshrrev_b32 v118, 16, v118
v_mul_u32_u24 v119, 18, v118
v_sub_u32 v117, v117, v119
v_lshrrev_b32 v119, 4, v118
v_xor_b32 v117, v117, v119
v_and_b32 v116, 3, v118
v_lshrrev_b32 v119, 3, v118
v_lshl_add_u32 v116, v119, 2, v116
v_bfe_u32 v119, v118, 2, 1
v_lshl_add_u32 v116, v119, 4, v116
v_mul_u32_u24 v116, 1152, v116
v_lshl_add_u32 v116, v117, 4, v116
v_add_u32 v116, s31, v116
v_add_u32 v116, 4096, v116
s_add_u32 m0, s59, 73728
s_nop 0
buffer_load_dwordx4 v112, s[16:19], s61 offen offset:0 lds
buffer_load_dwordx4 v113, s[16:19], s61 offen offset:1024 lds
buffer_load_dwordx4 v114, s[16:19], s61 offen offset:2048 lds
buffer_load_dwordx4 v115, s[16:19], s61 offen offset:3072 lds
s_add_u32 m0, s59, 77824
s_nop 0
buffer_load_dwordx4 v116, s[16:19], s61 offen offset:0 lds
s_add_u32 s61, s61, 221184
s_cmp_ge_u32 s61, 663552
s_cselect_b32 s35, 663552, 0
s_sub_u32 s61, s61, s35
s_add_u32 m0, s59, 110592
s_nop 0
buffer_load_dwordx4 v112, s[16:19], s61 offen offset:0 lds
buffer_load_dwordx4 v113, s[16:19], s61 offen offset:1024 lds
buffer_load_dwordx4 v114, s[16:19], s61 offen offset:2048 lds
buffer_load_dwordx4 v115, s[16:19], s61 offen offset:3072 lds
s_add_u32 m0, s59, 114688
s_nop 0
buffer_load_dwordx4 v116, s[16:19], s61 offen offset:0 lds
s_add_u32 s61, s61, 221184
s_cmp_ge_u32 s61, 663552
s_cselect_b32 s35, 663552, 0
s_sub_u32 s61, s61, s35
s_waitcnt lgkmcnt(0)
v_mul_f32_dpp v2, v64, v15 quad_perm:[1,0,3,2] row_mask:0xf bank_mask:0xf
v_fma_f32 v64, v64, v14, v2
v_mul_f32_dpp v10, v65, v15 quad_perm:[1,0,3,2] row_mask:0xf bank_mask:0xf
v_fma_f32 v65, v65, v14, v10
v_fma_f32 v11, v12, v64, v65
v_mul_f32_dpp v2, v66, v15 quad_perm:[1,0,3,2] row_mask:0xf bank_mask:0xf
v_fma_f32 v66, v66, v14, v2
v_fmac_f32_dpp v11, v64, v13 quad_perm:[1,0,3,2] row_mask:0xf bank_mask:0xf
v_fma_f32 v10, v12, v11, v66
v_mul_f32_dpp v2, v67, v15 quad_perm:[1,0,3,2] row_mask:0xf bank_mask:0xf
v_fma_f32 v67, v67, v14, v2
v_fmac_f32_dpp v10, v11, v13 quad_perm:[1,0,3,2] row_mask:0xf bank_mask:0xf
v_fma_f32 v11, v12, v10, v67
v_mul_f32_dpp v2, v68, v15 quad_perm:[1,0,3,2] row_mask:0xf bank_mask:0xf
v_fma_f32 v68, v68, v14, v2
v_fmac_f32_dpp v11, v10, v13 quad_perm:[1,0,3,2] row_mask:0xf bank_mask:0xf
v_fma_f32 v10, v12, v11, v68
v_mul_f32_dpp v2, v69, v15 quad_perm:[1,0,3,2] row_mask:0xf bank_mask:0xf
v_fma_f32 v69, v69, v14, v2
v_fmac_f32_dpp v10, v11, v13 quad_perm:[1,0,3,2] row_mask:0xf bank_mask:0xf
v_fma_f32 v11, v12, v10, v69
v_mul_f32_dpp v2, v70, v15 quad_perm:[1,0,3,2] row_mask:0xf bank_mask:0xf
v_fma_f32 v70, v70, v14, v2
v_fmac_f32_dpp v11, v10, v13 quad_perm:[1,0,3,2] row_mask:0xf bank_mask:0xf
v_fma_f32 v10, v12, v11, v70
v_mul_f32_dpp v2, v71, v15 quad_perm:[1,0,3,2] row_mask:0xf bank_mask:0xf
v_fma_f32 v71, v71, v14, v2
v_fmac_f32_dpp v10, v11, v13 quad_perm:[1,0,3,2] row_mask:0xf bank_mask:0xf
v_fma_f32 v11, v12, v10, v71
v_mul_f32_dpp v2, v72, v15 quad_perm:[1,0,3,2] row_mask:0xf bank_mask:0xf
v_fma_f32 v72, v72, v14, v2
v_fmac_f32_dpp v11, v10, v13 quad_perm:[1,0,3,2] row_mask:0xf bank_mask:0xf
v_fma_f32 v10, v12, v11, v72
v_mul_f32_dpp v2, v73, v15 quad_perm:[1,0,3,2] row_mask:0xf bank_mask:0xf
v_fma_f32 v73, v73, v14, v2
v_fmac_f32_dpp v10, v11, v13 quad_perm:[1,0,3,2] row_mask:0xf bank_mask:0xf
v_fma_f32 v11, v12, v10, v73
v_mul_f32_dpp v2, v74, v15 quad_perm:[1,0,3,2] row_mask:0xf bank_mask:0xf
v_fma_f32 v74, v74, v14, v2
v_fmac_f32_dpp v11, v10, v13 quad_perm:[1,0,3,2] row_mask:0xf bank_mask:0xf
v_fma_f32 v10, v12, v11, v74
v_mul_f32_dpp v2, v75, v15 quad_perm:[1,0,3,2] row_mask:0xf bank_mask:0xf
v_fma_f32 v75, v75, v14, v2
v_fmac_f32_dpp v10, v11, v13 quad_perm:[1,0,3,2] row_mask:0xf bank_mask:0xf
v_fma_f32 v11, v12, v10, v75
v_mul_f32_dpp v2, v76, v15 quad_perm:[1,0,3,2] row_mask:0xf bank_mask:0xf
v_fma_f32 v76, v76, v14, v2
v_fmac_f32_dpp v11, v10, v13 quad_perm:[1,0,3,2] row_mask:0xf bank_mask:0xf
v_fma_f32 v10, v12, v11, v76
v_mul_f32_dpp v2, v77, v15 quad_perm:[1,0,3,2] row_mask:0xf bank_mask:0xf
v_fma_f32 v77, v77, v14, v2
v_fmac_f32_dpp v10, v11, v13 quad_perm:[1,0,3,2] row_mask:0xf bank_mask:0xf
v_fma_f32 v11, v12, v10, v77
v_mul_f32_dpp v2, v78, v15 quad_perm:[1,0,3,2] row_mask:0xf bank_mask:0xf
v_fma_f32 v78, v78, v14, v2
v_fmac_f32_dpp v11, v10, v13 quad_perm:[1,0,3,2] row_mask:0xf bank_mask:0xf
v_fma_f32 v10, v12, v11, v78
v_mul_f32_dpp v2, v79, v15 quad_perm:[1,0,3,2] row_mask:0xf bank_mask:0xf
v_fma_f32 v79, v79, v14, v2
v_fmac_f32_dpp v10, v11, v13 quad_perm:[1,0,3,2] row_mask:0xf bank_mask:0xf
v_fma_f32 v11, v12, v10, v79
s_nop 1
v_fmac_f32_dpp v11, v10, v13 quad_perm:[1,0,3,2] row_mask:0xf bank_mask:0xf
ds_write_b32 v9, v11 offset:768
s_waitcnt lgkmcnt(0)
L_s4j:
s_barrier
s_cmp_ge_u32 s3, 5
s_cbranch_scc1 L_carry_done
s_lshl_b32 s30, s3, 6
v_add_u32 v120, s30, v1
v_cmp_gt_u32 vcc, 288, v120
s_and_saveexec_b64 s[36:37], vcc
v_lshlrev_b32 v121, 4, v120
v_add_u32 v121, 156672, v121
v_lshlrev_b32 v120, 2, v120
v_add_u32 v122, 147456, v120
ds_read_b64 v[124:125], v121
ds_read_b32 v132, v122 offset:0
ds_read_b32 v133, v122 offset:1152
ds_read_b32 v134, v122 offset:2304
ds_read_b32 v135, v122 offset:3456
ds_read_b32 v136, v122 offset:4608
ds_read_b32 v137, v122 offset:5760
ds_read_b32 v138, v122 offset:6912
ds_read_b32 v139, v122 offset:8064
s_waitcnt lgkmcnt(8)
v_mul_f32 v123, v125, v125
v_mul_f32 v125, v124, v125
v_fma_f32 v124, v124, v124, -v123
v_add_f32 v125, v125, v125
v_mul_f32 v123, v125, v125
v_mul_f32 v125, v124, v125
v_fma_f32 v124, v124, v124, -v123
v_add_f32 v125, v125, v125
v_mul_f32 v123, v125, v125
v_mul_f32 v125, v124, v125
v_fma_f32 v124, v124, v124, -v123
v_add_f32 v125, v125, v125
v_mul_f32 v123, v125, v125
v_mul_f32 v125, v124, v125
v_fma_f32 v124, v124, v124, -v123
v_add_f32 v125, v125, v125
s_waitcnt lgkmcnt(0)
v_fma_f32 v129, v124, v132, v133
s_nop 1
v_fmac_f32_dpp v129, v132, v125 quad_perm:[1,0,3,2] row_mask:0xf bank_mask:0xf
v_fma_f32 v128, v124, v129, v134
s_nop 1
v_fmac_f32_dpp v128, v129, v125 quad_perm:[1,0,3,2] row_mask:0xf bank_mask:0xf
v_fma_f32 v129, v124, v128, v135
s_nop 1
v_fmac_f32_dpp v129, v128, v125 quad_perm:[1,0,3,2] row_mask:0xf bank_mask:0xf
v_fma_f32 v128, v124, v129, v136
s_nop 1
v_fmac_f32_dpp v128, v129, v125 quad_perm:[1,0,3,2] row_mask:0xf bank_mask:0xf
v_fma_f32 v129, v124, v128, v137
s_nop 1
v_fmac_f32_dpp v129, v128, v125 quad_perm:[1,0,3,2] row_mask:0xf bank_mask:0xf
v_fma_f32 v128, v124, v129, v138
s_nop 1
v_fmac_f32_dpp v128, v129, v125 quad_perm:[1,0,3,2] row_mask:0xf bank_mask:0xf
v_fma_f32 v129, v124, v128, v139
s_nop 1
v_fmac_f32_dpp v129, v128, v125 quad_perm:[1,0,3,2] row_mask:0xf bank_mask:0xf
buffer_store_dword v129, v120, s[20:23], s38 offen sc0 sc1
s_add_u32 s30, s49, 1
s_mul_i32 s30, s30, 20480
s_add_u32 s10, s30, 38010880
s_mov_b32 s8, s20
s_mov_b32 s9, s21
s_add_u32 s30, s38, 1280
s_add_u32 s31, s38, 6400
s_add_u32 s32, s38, 11520
s_add_u32 s33, s38, 16640
s_movk_i32 s34, 0x4000
L_poll:
buffer_load_dword v144, v120, s[8:11], s30 offen offset:0 sc0 sc1
buffer_load_dword v145, v120, s[8:11], s30 offen offset:1280 sc0 sc1
buffer_load_dword v146, v120, s[8:11], s30 offen offset:2560 sc0 sc1
buffer_load_dword v147, v120, s[8:11], s30 offen offset:3840 sc0 sc1
buffer_load_dword v148, v120, s[8:11], s31 offen offset:0 sc0 sc1
buffer_load_dword v149, v120, s[8:11], s31 offen offset:1280 sc0 sc1
buffer_load_dword v150, v120, s[8:11], s31 offen offset:2560 sc0 sc1
buffer_load_dword v151, v120, s[8:11], s31 offen offset:3840 sc0 sc1
buffer_load_dword v152, v120, s[8:11], s32 offen offset:0 sc0 sc1
buffer_load_dword v153, v120, s[8:11], s32 offen offset:1280 sc0 sc1
buffer_load_dword v154, v120, s[8:11], s32 offen offset:2560 sc0 sc1
buffer_load_dword v155, v120, s[8:11], s32 offen offset:3840 sc0 sc1
buffer_load_dword v156, v120, s[8:11], s33 offen offset:0 sc0 sc1
buffer_load_dword v157, v120, s[8:11], s33 offen offset:1280 sc0 sc1
buffer_load_dword v158, v120, s[8:11], s33 offen offset:2560 sc0 sc1
v_mul_f32 v123, v125, v125
v_mul_f32 v127, v124, v125
v_fma_f32 v126, v124, v124, -v123
v_add_f32 v127, v127, v127
v_mul_f32 v123, v127, v127
v_mul_f32 v127, v126, v127
v_fma_f32 v126, v126, v126, -v123
v_add_f32 v127, v127, v127
v_mul_f32 v123, v127, v127
v_mul_f32 v127, v126, v127
v_fma_f32 v126, v126, v126, -v123
v_add_f32 v127, v127, v127
s_sub_u32 s34, s34, 1
s_cbranch_scc1 L_poll_done
s_waitcnt vmcnt(0)
v_max3_u32 v128, v144, v145, v146
v_max3_u32 v128, v128, v147, v148
v_max3_u32 v128, v128, v149, v150
v_max3_u32 v128, v128, v151, v152
v_max3_u32 v128, v128, v153, v154
v_max3_u32 v128, v128, v155, v156
v_max3_u32 v128, v128, v157, v158
v_cmp_eq_u32 vcc, -1, v128
s_cbranch_vccnz L_poll
L_poll_done:
s_waitcnt vmcnt(0)
v_fma_f32 v129, v126, v158, v157
s_nop 1
v_fmac_f32_dpp v129, v158, v127 quad_perm:[1,0,3,2] row_mask:0xf bank_mask:0xf
v_fma_f32 v128, v126, v129, v156
s_nop 1
v_fmac_f32_dpp v128, v129, v127 quad_perm:[1,0,3,2] row_mask:0xf bank_mask:0xf
v_fma_f32 v129, v126, v128, v155
s_nop 1
v_fmac_f32_dpp v129, v128, v127 quad_perm:[1,0,3,2] row_mask:0xf bank_mask:0xf
v_fma_f32 v128, v126, v129, v154
s_nop 1
v_fmac_f32_dpp v128, v129, v127 quad_perm:[1,0,3,2] row_mask:0xf bank_mask:0xf
v_fma_f32 v129, v126, v128, v153
s_nop 1
v_fmac_f32_dpp v129, v128, v127 quad_perm:[1,0,3,2] row_mask:0xf bank_mask:0xf
v_fma_f32 v128, v126, v129, v152
s_nop 1
v_fmac_f32_dpp v128, v129, v127 quad_perm:[1,0,3,2] row_mask:0xf bank_mask:0xf
v_fma_f32 v129, v126, v128, v151
s_nop 1
v_fmac_f32_dpp v129, v128, v127 quad_perm:[1,0,3,2] row_mask:0xf bank_mask:0xf
v_fma_f32 v128, v126, v129, v150
s_nop 1
v_fmac_f32_dpp v128, v129, v127 quad_perm:[1,0,3,2] row_mask:0xf bank_mask:0xf
v_fma_f32 v129, v126, v128, v149
s_nop 1
v_fmac_f32_dpp v129, v128, v127 quad_perm:[1,0,3,2] row_mask:0xf bank_mask:0xf
v_fma_f32 v128, v126, v129, v148
s_nop 1
v_fmac_f32_dpp v128, v129, v127 quad_perm:[1,0,3,2] row_mask:0xf bank_mask:0xf
v_fma_f32 v129, v126, v128, v147
s_nop 1
v_fmac_f32_dpp v129, v128, v127 quad_perm:[1,0,3,2] row_mask:0xf bank_mask:0xf
v_fma_f32 v128, v126, v129, v146
s_nop 1
v_fmac_f32_dpp v128, v129, v127 quad_perm:[1,0,3,2] row_mask:0xf bank_mask:0xf
v_fma_f32 v129, v126, v128, v145
s_nop 1
v_fmac_f32_dpp v129, v128, v127 quad_perm:[1,0,3,2] row_mask:0xf bank_mask:0xf
v_fma_f32 v128, v126, v129, v144
s_nop 1
v_fmac_f32_dpp v128, v129, v127 quad_perm:[1,0,3,2] row_mask:0xf bank_mask:0xf
s_nop 1
ds_write_b32 v122, v128 offset:0
v_fma_f32 v129, v124, v128, v132
s_nop 1
v_fmac_f32_dpp v129, v128, v125 quad_perm:[1,0,3,2] row_mask:0xf bank_mask:0xf
ds_write_b32 v122, v129 offset:1152
v_fma_f32 v128, v124, v129, v133
s_nop 1
v_fmac_f32_dpp v128, v129, v125 quad_perm:[1,0,3,2] row_mask:0xf bank_mask:0xf
ds_write_b32 v122, v128 offset:2304
v_fma_f32 v129, v124, v128, v134
s_nop 1
v_fmac_f32_dpp v129, v128, v125 quad_perm:[1,0,3,2] row_mask:0xf bank_mask:0xf
ds_write_b32 v122, v129 offset:3456
v_fma_f32 v128, v124, v129, v135
s_nop 1
v_fmac_f32_dpp v128, v129, v125 quad_perm:[1,0,3,2] row_mask:0xf bank_mask:0xf
ds_write_b32 v122, v128 offset:4608
v_fma_f32 v129, v124, v128, v136
s_nop 1
v_fmac_f32_dpp v129, v128, v125 quad_perm:[1,0,3,2] row_mask:0xf bank_mask:0xf
ds_write_b32 v122, v129 offset:5760
v_fma_f32 v128, v124, v129, v137
s_nop 1
v_fmac_f32_dpp v128, v129, v125 quad_perm:[1,0,3,2] row_mask:0xf bank_mask:0xf
ds_write_b32 v122, v128 offset:6912
v_fma_f32 v129, v124, v128, v138
s_nop 1
v_fmac_f32_dpp v129, v128, v125 quad_perm:[1,0,3,2] row_mask:0xf bank_mask:0xf
ds_write_b32 v122, v129 offset:8064
s_mov_b64 exec, s[36:37]
s_waitcnt lgkmcnt(0)
L_carry_done:
s_barrier
v_and_b32 v10, 1, v1
v_bfe_u32 v11, v1, 1, 4
v_lshl_add_u32 v11, v10, 4, v11
v_lshlrev_b32 v11, 6, v11
v_lshrrev_b32 v12, 5, v1
v_xor_b32 v10, v10, v12
v_bfe_u32 v12, v1, 2, 1
v_lshl_add_u32 v10, v10, 1, v12
v_lshl_add_u32 v136, v10, 4, v11
s_mul_i32 s30, s4, 18432
s_lshl_b32 s31, s5, 11
s_add_u32 s31, s31, s30
v_add_u32 v136, s31, v136
v_xor_b32 v137, 16, v136
s_cmp_lg_u32 s5, 0
s_cbranch_scc1 L_p2b
ds_read_b64 v[120:121], v8 offset:0
ds_read_b32 v130, v9 offset:0
ds_read_b64 v[122:123], v8 offset:1024
ds_read_b32 v131, v9 offset:256
ds_read_b64 v[124:125], v8 offset:2048
ds_read_b32 v132, v9 offset:512
ds_read_b64 v[126:127], v8 offset:3072
ds_read_b32 v133, v9 offset:768
ds_read_b64 v[128:129], v8 offset:4096
ds_read_b32 v134, v9 offset:1024
s_waitcnt lgkmcnt(0)
v_fmac_f32 v16, v120, v130
v_fmac_f32 v32, v122, v131
v_fmac_f32 v48, v124, v132
v_fmac_f32 v64, v126, v133
v_fmac_f32 v80, v128, v134
v_fmac_f32_dpp v16, v130, v121 quad_perm:[1,0,3,2] row_mask:0xf bank_mask:0xf
v_fmac_f32_dpp v32, v131, v123 quad_perm:[1,0,3,2] row_mask:0xf bank_mask:0xf
v_fmac_f32_dpp v48, v132, v125 quad_perm:[1,0,3,2] row_mask:0xf bank_mask:0xf
v_fmac_f32_dpp v64, v133, v127 quad_perm:[1,0,3,2] row_mask:0xf bank_mask:0xf
v_fmac_f32_dpp v80, v134, v129 quad_perm:[1,0,3,2] row_mask:0xf bank_mask:0xf
v_fmac_f32 v17, v120, v16
v_fmac_f32 v33, v122, v32
v_fmac_f32 v49, v124, v48
v_fmac_f32 v65, v126, v64
v_fmac_f32 v81, v128, v80
v_fmac_f32_dpp v17, v16, v121 quad_perm:[1,0,3,2] row_mask:0xf bank_mask:0xf
v_fmac_f32_dpp v33, v32, v123 quad_perm:[1,0,3,2] row_mask:0xf bank_mask:0xf
v_fmac_f32_dpp v49, v48, v125 quad_perm:[1,0,3,2] row_mask:0xf bank_mask:0xf
v_fmac_f32_dpp v65, v64, v127 quad_perm:[1,0,3,2] row_mask:0xf bank_mask:0xf
v_fmac_f32_dpp v81, v80, v129 quad_perm:[1,0,3,2] row_mask:0xf bank_mask:0xf
v_fmac_f32 v18, v120, v17
v_fmac_f32 v34, v122, v33
v_fmac_f32 v50, v124, v49
v_fmac_f32 v66, v126, v65
v_fmac_f32 v82, v128, v81
v_fmac_f32_dpp v18, v17, v121 quad_perm:[1,0,3,2] row_mask:0xf bank_mask:0xf
v_fmac_f32_dpp v34, v33, v123 quad_perm:[1,0,3,2] row_mask:0xf bank_mask:0xf
v_fmac_f32_dpp v50, v49, v125 quad_perm:[1,0,3,2] row_mask:0xf bank_mask:0xf
v_fmac_f32_dpp v66, v65, v127 quad_perm:[1,0,3,2] row_mask:0xf bank_mask:0xf
v_fmac_f32_dpp v82, v81, v129 quad_perm:[1,0,3,2] row_mask:0xf bank_mask:0xf
v_fmac_f32 v19, v120, v18
v_fmac_f32 v35, v122, v34
v_fmac_f32 v51, v124, v50
v_fmac_f32 v67, v126, v66
v_fmac_f32 v83, v128, v82
v_fmac_f32_dpp v19, v18, v121 quad_perm:[1,0,3,2] row_mask:0xf bank_mask:0xf
v_fmac_f32_dpp v35, v34, v123 quad_perm:[1,0,3,2] row_mask:0xf bank_mask:0xf
v_fmac_f32_dpp v51, v50, v125 quad_perm:[1,0,3,2] row_mask:0xf bank_mask:0xf
v_fmac_f32_dpp v67, v66, v127 quad_perm:[1,0,3,2] row_mask:0xf bank_mask:0xf
v_fmac_f32_dpp v83, v82, v129 quad_perm:[1,0,3,2] row_mask:0xf bank_mask:0xf
v_fmac_f32 v20, v120, v19
v_fmac_f32 v36, v122, v35
v_fmac_f32 v52, v124, v51
v_fmac_f32 v68, v126, v67
v_fmac_f32 v84, v128, v83
v_fmac_f32_dpp v20, v19, v121 quad_perm:[1,0,3,2] row_mask:0xf bank_mask:0xf
v_fmac_f32_dpp v36, v35, v123 quad_perm:[1,0,3,2] row_mask:0xf bank_mask:0xf
v_fmac_f32_dpp v52, v51, v125 quad_perm:[1,0,3,2] row_mask:0xf bank_mask:0xf
v_fmac_f32_dpp v68, v67, v127 quad_perm:[1,0,3,2] row_mask:0xf bank_mask:0xf
v_fmac_f32_dpp v84, v83, v129 quad_perm:[1,0,3,2] row_mask:0xf bank_mask:0xf
v_fmac_f32 v21, v120, v20
v_fmac_f32 v37, v122, v36
v_fmac_f32 v53, v124, v52
v_fmac_f32 v69, v126, v68
v_fmac_f32 v85, v128, v84
v_fmac_f32_dpp v21, v20, v121 quad_perm:[1,0,3,2] row_mask:0xf bank_mask:0xf
v_fmac_f32_dpp v37, v36, v123 quad_perm:[1,0,3,2] row_mask:0xf bank_mask:0xf
v_fmac_f32_dpp v53, v52, v125 quad_perm:[1,0,3,2] row_mask:0xf bank_mask:0xf
v_fmac_f32_dpp v69, v68, v127 quad_perm:[1,0,3,2] row_mask:0xf bank_mask:0xf
v_fmac_f32_dpp v85, v84, v129 quad_perm:[1,0,3,2] row_mask:0xf bank_mask:0xf
v_fmac_f32 v22, v120, v21
v_fmac_f32 v38, v122, v37
v_fmac_f32 v54, v124, v53
v_fmac_f32 v70, v126, v69
v_fmac_f32 v86, v128, v85
v_fmac_f32_dpp v22, v21, v121 quad_perm:[1,0,3,2] row_mask:0xf bank_mask:0xf
v_fmac_f32_dpp v38, v37, v123 quad_perm:[1,0,3,2] row_mask:0xf bank_mask:0xf
v_fmac_f32_dpp v54, v53, v125 quad_perm:[1,0,3,2] row_mask:0xf bank_mask:0xf
v_fmac_f32_dpp v70, v69, v127 quad_perm:[1,0,3,2] row_mask:0xf bank_mask:0xf
v_fmac_f32_dpp v86, v85, v129 quad_perm:[1,0,3,2] row_mask:0xf bank_mask:0xf
v_fmac_f32 v23, v120, v22
v_fmac_f32 v39, v122, v38
v_fmac_f32 v55, v124, v54
v_fmac_f32 v71, v126, v70
v_fmac_f32 v87, v128, v86
v_fmac_f32_dpp v23, v22, v121 quad_perm:[1,0,3,2] row_mask:0xf bank_mask:0xf
v_fmac_f32_dpp v39, v38, v123 quad_perm:[1,0,3,2] row_mask:0xf bank_mask:0xf
v_fmac_f32_dpp v55, v54, v125 quad_perm:[1,0,3,2] row_mask:0xf bank_mask:0xf
v_fmac_f32_dpp v71, v70, v127 quad_perm:[1,0,3,2] row_mask:0xf bank_mask:0xf
v_fmac_f32_dpp v87, v86, v129 quad_perm:[1,0,3,2] row_mask:0xf bank_mask:0xf
v_fmac_f32 v24, v120, v23
v_fmac_f32 v40, v122, v39
v_fmac_f32 v56, v124, v55
v_fmac_f32 v72, v126, v71
v_fmac_f32 v88, v128, v87
v_fmac_f32_dpp v24, v23, v121 quad_perm:[1,0,3,2] row_mask:0xf bank_mask:0xf
v_fmac_f32_dpp v40, v39, v123 quad_perm:[1,0,3,2] row_mask:0xf bank_mask:0xf
v_fmac_f32_dpp v56, v55, v125 quad_perm:[1,0,3,2] row_mask:0xf bank_mask:0xf
v_fmac_f32_dpp v72, v71, v127 quad_perm:[1,0,3,2] row_mask:0xf bank_mask:0xf
v_fmac_f32_dpp v88, v87, v129 quad_perm:[1,0,3,2] row_mask:0xf bank_mask:0xf
v_fmac_f32 v25, v120, v24
v_fmac_f32 v41, v122, v40
v_fmac_f32 v57, v124, v56
v_fmac_f32 v73, v126, v72
v_fmac_f32 v89, v128, v88
v_fmac_f32_dpp v25, v24, v121 quad_perm:[1,0,3,2] row_mask:0xf bank_mask:0xf
v_fmac_f32_dpp v41, v40, v123 quad_perm:[1,0,3,2] row_mask:0xf bank_mask:0xf
v_fmac_f32_dpp v57, v56, v125 quad_perm:[1,0,3,2] row_mask:0xf bank_mask:0xf
v_fmac_f32_dpp v73, v72, v127 quad_perm:[1,0,3,2] row_mask:0xf bank_mask:0xf
v_fmac_f32_dpp v89, v88, v129 quad_perm:[1,0,3,2] row_mask:0xf bank_mask:0xf
v_fmac_f32 v26, v120, v25
v_fmac_f32 v42, v122, v41
v_fmac_f32 v58, v124, v57
v_fmac_f32 v74, v126, v73
v_fmac_f32 v90, v128, v89
v_fmac_f32_dpp v26, v25, v121 quad_perm:[1,0,3,2] row_mask:0xf bank_mask:0xf
v_fmac_f32_dpp v42, v41, v123 quad_perm:[1,0,3,2] row_mask:0xf bank_mask:0xf
v_fmac_f32_dpp v58, v57, v125 quad_perm:[1,0,3,2] row_mask:0xf bank_mask:0xf
v_fmac_f32_dpp v74, v73, v127 quad_perm:[1,0,3,2] row_mask:0xf bank_mask:0xf
v_fmac_f32_dpp v90, v89, v129 quad_perm:[1,0,3,2] row_mask:0xf bank_mask:0xf
v_fmac_f32 v27, v120, v26
v_fmac_f32 v43, v122, v42
v_fmac_f32 v59, v124, v58
v_fmac_f32 v75, v126, v74
v_fmac_f32 v91, v128, v90
v_fmac_f32_dpp v27, v26, v121 quad_perm:[1,0,3,2] row_mask:0xf bank_mask:0xf
v_fmac_f32_dpp v43, v42, v123 quad_perm:[1,0,3,2] row_mask:0xf bank_mask:0xf
v_fmac_f32_dpp v59, v58, v125 quad_perm:[1,0,3,2] row_mask:0xf bank_mask:0xf
v_fmac_f32_dpp v75, v74, v127 quad_perm:[1,0,3,2] row_mask:0xf bank_mask:0xf
v_fmac_f32_dpp v91, v90, v129 quad_perm:[1,0,3,2] row_mask:0xf bank_mask:0xf
v_fmac_f32 v28, v120, v27
v_fmac_f32 v44, v122, v43
v_fmac_f32 v60, v124, v59
v_fmac_f32 v76, v126, v75
v_fmac_f32 v92, v128, v91
v_fmac_f32_dpp v28, v27, v121 quad_perm:[1,0,3,2] row_mask:0xf bank_mask:0xf
v_fmac_f32_dpp v44, v43, v123 quad_perm:[1,0,3,2] row_mask:0xf bank_mask:0xf
v_fmac_f32_dpp v60, v59, v125 quad_perm:[1,0,3,2] row_mask:0xf bank_mask:0xf
v_fmac_f32_dpp v76, v75, v127 quad_perm:[1,0,3,2] row_mask:0xf bank_mask:0xf
v_fmac_f32_dpp v92, v91, v129 quad_perm:[1,0,3,2] row_mask:0xf bank_mask:0xf
v_fmac_f32 v29, v120, v28
v_fmac_f32 v45, v122, v44
v_fmac_f32 v61, v124, v60
v_fmac_f32 v77, v126, v76
v_fmac_f32 v93, v128, v92
v_fmac_f32_dpp v29, v28, v121 quad_perm:[1,0,3,2] row_mask:0xf bank_mask:0xf
v_fmac_f32_dpp v45, v44, v123 quad_perm:[1,0,3,2] row_mask:0xf bank_mask:0xf
v_fmac_f32_dpp v61, v60, v125 quad_perm:[1,0,3,2] row_mask:0xf bank_mask:0xf
v_fmac_f32_dpp v77, v76, v127 quad_perm:[1,0,3,2] row_mask:0xf bank_mask:0xf
v_fmac_f32_dpp v93, v92, v129 quad_perm:[1,0,3,2] row_mask:0xf bank_mask:0xf
v_fmac_f32 v30, v120, v29
v_fmac_f32 v46, v122, v45
v_fmac_f32 v62, v124, v61
v_fmac_f32 v78, v126, v77
v_fmac_f32 v94, v128, v93
v_fmac_f32_dpp v30, v29, v121 quad_perm:[1,0,3,2] row_mask:0xf bank_mask:0xf
v_fmac_f32_dpp v46, v45, v123 quad_perm:[1,0,3,2] row_mask:0xf bank_mask:0xf
v_fmac_f32_dpp v62, v61, v125 quad_perm:[1,0,3,2] row_mask:0xf bank_mask:0xf
v_fmac_f32_dpp v78, v77, v127 quad_perm:[1,0,3,2] row_mask:0xf bank_mask:0xf
v_fmac_f32_dpp v94, v93, v129 quad_perm:[1,0,3,2] row_mask:0xf bank_mask:0xf
v_fmac_f32 v31, v120, v30
v_fmac_f32 v47, v122, v46
v_fmac_f32 v63, v124, v62
v_fmac_f32 v79, v126, v78
v_fmac_f32 v95, v128, v94
v_fmac_f32_dpp v31, v30, v121 quad_perm:[1,0,3,2] row_mask:0xf bank_mask:0xf
v_fmac_f32_dpp v47, v46, v123 quad_perm:[1,0,3,2] row_mask:0xf bank_mask:0xf
v_fmac_f32_dpp v63, v62, v125 quad_perm:[1,0,3,2] row_mask:0xf bank_mask:0xf
v_fmac_f32_dpp v79, v78, v127 quad_perm:[1,0,3,2] row_mask:0xf bank_mask:0xf
v_fmac_f32_dpp v95, v94, v129 quad_perm:[1,0,3,2] row_mask:0xf bank_mask:0xf
v_cvt_pk_bf16_f32 v16, v16, v17
v_cvt_pk_bf16_f32 v17, v18, v19
v_cvt_pk_bf16_f32 v18, v20, v21
v_cvt_pk_bf16_f32 v19, v22, v23
ds_write_b128 v136, v[16:19] offset:0
v_cvt_pk_bf16_f32 v20, v24, v25
v_cvt_pk_bf16_f32 v21, v26, v27
v_cvt_pk_bf16_f32 v22, v28, v29
v_cvt_pk_bf16_f32 v23, v30, v31
ds_write_b128 v137, v[20:23] offset:0
v_cvt_pk_bf16_f32 v32, v32, v33
v_cvt_pk_bf16_f32 v33, v34, v35
v_cvt_pk_bf16_f32 v34, v36, v37
v_cvt_pk_bf16_f32 v35, v38, v39
ds_write_b128 v136, v[32:35] offset:4096
v_cvt_pk_bf16_f32 v36, v40, v41
v_cvt_pk_bf16_f32 v37, v42, v43
v_cvt_pk_bf16_f32 v38, v44, v45
v_cvt_pk_bf16_f32 v39, v46, v47
ds_write_b128 v137, v[36:39] offset:4096
v_cvt_pk_bf16_f32 v48, v48, v49
v_cvt_pk_bf16_f32 v49, v50, v51
v_cvt_pk_bf16_f32 v50, v52, v53
v_cvt_pk_bf16_f32 v51, v54, v55
ds_write_b128 v136, v[48:51] offset:8192
v_cvt_pk_bf16_f32 v52, v56, v57
v_cvt_pk_bf16_f32 v53, v58, v59
v_cvt_pk_bf16_f32 v54, v60, v61
v_cvt_pk_bf16_f32 v55, v62, v63
ds_write_b128 v137, v[52:55] offset:8192
v_cvt_pk_bf16_f32 v64, v64, v65
v_cvt_pk_bf16_f32 v65, v66, v67
v_cvt_pk_bf16_f32 v66, v68, v69
v_cvt_pk_bf16_f32 v67, v70, v71
ds_write_b128 v136, v[64:67] offset:12288
v_cvt_pk_bf16_f32 v68, v72, v73
v_cvt_pk_bf16_f32 v69, v74, v75
v_cvt_pk_bf16_f32 v70, v76, v77
v_cvt_pk_bf16_f32 v71, v78, v79
ds_write_b128 v137, v[68:71] offset:12288
v_cvt_pk_bf16_f32 v80, v80, v81
v_cvt_pk_bf16_f32 v81, v82, v83
v_cvt_pk_bf16_f32 v82, v84, v85
v_cvt_pk_bf16_f32 v83, v86, v87
ds_write_b128 v136, v[80:83] offset:16384
v_cvt_pk_bf16_f32 v84, v88, v89
v_cvt_pk_bf16_f32 v85, v90, v91
v_cvt_pk_bf16_f32 v86, v92, v93
v_cvt_pk_bf16_f32 v87, v94, v95
ds_write_b128 v137, v[84:87] offset:16384
s_waitcnt lgkmcnt(0)
s_branch L_p2j
L_p2b:
ds_read_b64 v[120:121], v8 offset:0
ds_read_b32 v130, v9 offset:0
ds_read_b64 v[122:123], v8 offset:1024
ds_read_b32 v131, v9 offset:256
ds_read_b64 v[124:125], v8 offset:2048
ds_read_b32 v132, v9 offset:512
ds_read_b64 v[126:127], v8 offset:3072
ds_read_b32 v133, v9 offset:768
s_waitcnt lgkmcnt(0)
v_fmac_f32 v16, v120, v130
v_fmac_f32 v32, v122, v131
v_fmac_f32 v48, v124, v132
v_fmac_f32 v64, v126, v133
v_fmac_f32_dpp v16, v130, v121 quad_perm:[1,0,3,2] row_mask:0xf bank_mask:0xf
v_fmac_f32_dpp v32, v131, v123 quad_perm:[1,0,3,2] row_mask:0xf bank_mask:0xf
v_fmac_f32_dpp v48, v132, v125 quad_perm:[1,0,3,2] row_mask:0xf bank_mask:0xf
v_fmac_f32_dpp v64, v133, v127 quad_perm:[1,0,3,2] row_mask:0xf bank_mask:0xf
v_fmac_f32 v17, v120, v16
v_fmac_f32 v33, v122, v32
v_fmac_f32 v49, v124, v48
v_fmac_f32 v65, v126, v64
v_fmac_f32_dpp v17, v16, v121 quad_perm:[1,0,3,2] row_mask:0xf bank_mask:0xf
v_fmac_f32_dpp v33, v32, v123 quad_perm:[1,0,3,2] row_mask:0xf bank_mask:0xf
v_fmac_f32_dpp v49, v48, v125 quad_perm:[1,0,3,2] row_mask:0xf bank_mask:0xf
v_fmac_f32_dpp v65, v64, v127 quad_perm:[1,0,3,2] row_mask:0xf bank_mask:0xf
v_fmac_f32 v18, v120, v17
v_fmac_f32 v34, v122, v33
v_fmac_f32 v50, v124, v49
v_fmac_f32 v66, v126, v65
v_fmac_f32_dpp v18, v17, v121 quad_perm:[1,0,3,2] row_mask:0xf bank_mask:0xf
v_fmac_f32_dpp v34, v33, v123 quad_perm:[1,0,3,2] row_mask:0xf bank_mask:0xf
v_fmac_f32_dpp v50, v49, v125 quad_perm:[1,0,3,2] row_mask:0xf bank_mask:0xf
v_fmac_f32_dpp v66, v65, v127 quad_perm:[1,0,3,2] row_mask:0xf bank_mask:0xf
v_fmac_f32 v19, v120, v18
v_fmac_f32 v35, v122, v34
v_fmac_f32 v51, v124, v50
v_fmac_f32 v67, v126, v66
v_fmac_f32_dpp v19, v18, v121 quad_perm:[1,0,3,2] row_mask:0xf bank_mask:0xf
v_fmac_f32_dpp v35, v34, v123 quad_perm:[1,0,3,2] row_mask:0xf bank_mask:0xf
v_fmac_f32_dpp v51, v50, v125 quad_perm:[1,0,3,2] row_mask:0xf bank_mask:0xf
v_fmac_f32_dpp v67, v66, v127 quad_perm:[1,0,3,2] row_mask:0xf bank_mask:0xf
v_fmac_f32 v20, v120, v19
v_fmac_f32 v36, v122, v35
v_fmac_f32 v52, v124, v51
v_fmac_f32 v68, v126, v67
v_fmac_f32_dpp v20, v19, v121 quad_perm:[1,0,3,2] row_mask:0xf bank_mask:0xf
v_fmac_f32_dpp v36, v35, v123 quad_perm:[1,0,3,2] row_mask:0xf bank_mask:0xf
v_fmac_f32_dpp v52, v51, v125 quad_perm:[1,0,3,2] row_mask:0xf bank_mask:0xf
v_fmac_f32_dpp v68, v67, v127 quad_perm:[1,0,3,2] row_mask:0xf bank_mask:0xf
v_fmac_f32 v21, v120, v20
v_fmac_f32 v37, v122, v36
v_fmac_f32 v53, v124, v52
v_fmac_f32 v69, v126, v68
v_fmac_f32_dpp v21, v20, v121 quad_perm:[1,0,3,2] row_mask:0xf bank_mask:0xf
v_fmac_f32_dpp v37, v36, v123 quad_perm:[1,0,3,2] row_mask:0xf bank_mask:0xf
v_fmac_f32_dpp v53, v52, v125 quad_perm:[1,0,3,2] row_mask:0xf bank_mask:0xf
v_fmac_f32_dpp v69, v68, v127 quad_perm:[1,0,3,2] row_mask:0xf bank_mask:0xf
v_fmac_f32 v22, v120, v21
v_fmac_f32 v38, v122, v37
v_fmac_f32 v54, v124, v53
v_fmac_f32 v70, v126, v69
v_fmac_f32_dpp v22, v21, v121 quad_perm:[1,0,3,2] row_mask:0xf bank_mask:0xf
v_fmac_f32_dpp v38, v37, v123 quad_perm:[1,0,3,2] row_mask:0xf bank_mask:0xf
v_fmac_f32_dpp v54, v53, v125 quad_perm:[1,0,3,2] row_mask:0xf bank_mask:0xf
v_fmac_f32_dpp v70, v69, v127 quad_perm:[1,0,3,2] row_mask:0xf bank_mask:0xf
v_fmac_f32 v23, v120, v22
v_fmac_f32 v39, v122, v38
v_fmac_f32 v55, v124, v54
v_fmac_f32 v71, v126, v70
v_fmac_f32_dpp v23, v22, v121 quad_perm:[1,0,3,2] row_mask:0xf bank_mask:0xf
v_fmac_f32_dpp v39, v38, v123 quad_perm:[1,0,3,2] row_mask:0xf bank_mask:0xf
v_fmac_f32_dpp v55, v54, v125 quad_perm:[1,0,3,2] row_mask:0xf bank_mask:0xf
v_fmac_f32_dpp v71, v70, v127 quad_perm:[1,0,3,2] row_mask:0xf bank_mask:0xf
v_fmac_f32 v24, v120, v23
v_fmac_f32 v40, v122, v39
v_fmac_f32 v56, v124, v55
v_fmac_f32 v72, v126, v71
v_fmac_f32_dpp v24, v23, v121 quad_perm:[1,0,3,2] row_mask:0xf bank_mask:0xf
v_fmac_f32_dpp v40, v39, v123 quad_perm:[1,0,3,2] row_mask:0xf bank_mask:0xf
v_fmac_f32_dpp v56, v55, v125 quad_perm:[1,0,3,2] row_mask:0xf bank_mask:0xf
v_fmac_f32_dpp v72, v71, v127 quad_perm:[1,0,3,2] row_mask:0xf bank_mask:0xf
v_fmac_f32 v25, v120, v24
v_fmac_f32 v41, v122, v40
v_fmac_f32 v57, v124, v56
v_fmac_f32 v73, v126, v72
v_fmac_f32_dpp v25, v24, v121 quad_perm:[1,0,3,2] row_mask:0xf bank_mask:0xf
v_fmac_f32_dpp v41, v40, v123 quad_perm:[1,0,3,2] row_mask:0xf bank_mask:0xf
v_fmac_f32_dpp v57, v56, v125 quad_perm:[1,0,3,2] row_mask:0xf bank_mask:0xf
v_fmac_f32_dpp v73, v72, v127 quad_perm:[1,0,3,2] row_mask:0xf bank_mask:0xf
v_fmac_f32 v26, v120, v25
v_fmac_f32 v42, v122, v41
v_fmac_f32 v58, v124, v57
v_fmac_f32 v74, v126, v73
v_fmac_f32_dpp v26, v25, v121 quad_perm:[1,0,3,2] row_mask:0xf bank_mask:0xf
v_fmac_f32_dpp v42, v41, v123 quad_perm:[1,0,3,2] row_mask:0xf bank_mask:0xf
v_fmac_f32_dpp v58, v57, v125 quad_perm:[1,0,3,2] row_mask:0xf bank_mask:0xf
v_fmac_f32_dpp v74, v73, v127 quad_perm:[1,0,3,2] row_mask:0xf bank_mask:0xf
v_fmac_f32 v27, v120, v26
v_fmac_f32 v43, v122, v42
v_fmac_f32 v59, v124, v58
v_fmac_f32 v75, v126, v74
v_fmac_f32_dpp v27, v26, v121 quad_perm:[1,0,3,2] row_mask:0xf bank_mask:0xf
v_fmac_f32_dpp v43, v42, v123 quad_perm:[1,0,3,2] row_mask:0xf bank_mask:0xf
v_fmac_f32_dpp v59, v58, v125 quad_perm:[1,0,3,2] row_mask:0xf bank_mask:0xf
v_fmac_f32_dpp v75, v74, v127 quad_perm:[1,0,3,2] row_mask:0xf bank_mask:0xf
v_fmac_f32 v28, v120, v27
v_fmac_f32 v44, v122, v43
v_fmac_f32 v60, v124, v59
v_fmac_f32 v76, v126, v75
v_fmac_f32_dpp v28, v27, v121 quad_perm:[1,0,3,2] row_mask:0xf bank_mask:0xf
v_fmac_f32_dpp v44, v43, v123 quad_perm:[1,0,3,2] row_mask:0xf bank_mask:0xf
v_fmac_f32_dpp v60, v59, v125 quad_perm:[1,0,3,2] row_mask:0xf bank_mask:0xf
v_fmac_f32_dpp v76, v75, v127 quad_perm:[1,0,3,2] row_mask:0xf bank_mask:0xf
v_fmac_f32 v29, v120, v28
v_fmac_f32 v45, v122, v44
v_fmac_f32 v61, v124, v60
v_fmac_f32 v77, v126, v76
v_fmac_f32_dpp v29, v28, v121 quad_perm:[1,0,3,2] row_mask:0xf bank_mask:0xf
v_fmac_f32_dpp v45, v44, v123 quad_perm:[1,0,3,2] row_mask:0xf bank_mask:0xf
v_fmac_f32_dpp v61, v60, v125 quad_perm:[1,0,3,2] row_mask:0xf bank_mask:0xf
v_fmac_f32_dpp v77, v76, v127 quad_perm:[1,0,3,2] row_mask:0xf bank_mask:0xf
v_fmac_f32 v30, v120, v29
v_fmac_f32 v46, v122, v45
v_fmac_f32 v62, v124, v61
v_fmac_f32 v78, v126, v77
v_fmac_f32_dpp v30, v29, v121 quad_perm:[1,0,3,2] row_mask:0xf bank_mask:0xf
v_fmac_f32_dpp v46, v45, v123 quad_perm:[1,0,3,2] row_mask:0xf bank_mask:0xf
v_fmac_f32_dpp v62, v61, v125 quad_perm:[1,0,3,2] row_mask:0xf bank_mask:0xf
v_fmac_f32_dpp v78, v77, v127 quad_perm:[1,0,3,2] row_mask:0xf bank_mask:0xf
v_fmac_f32 v31, v120, v30
v_fmac_f32 v47, v122, v46
v_fmac_f32 v63, v124, v62
v_fmac_f32 v79, v126, v78
v_fmac_f32_dpp v31, v30, v121 quad_perm:[1,0,3,2] row_mask:0xf bank_mask:0xf
v_fmac_f32_dpp v47, v46, v123 quad_perm:[1,0,3,2] row_mask:0xf bank_mask:0xf
v_fmac_f32_dpp v63, v62, v125 quad_perm:[1,0,3,2] row_mask:0xf bank_mask:0xf
v_fmac_f32_dpp v79, v78, v127 quad_perm:[1,0,3,2] row_mask:0xf bank_mask:0xf
v_cvt_pk_bf16_f32 v16, v16, v17
v_cvt_pk_bf16_f32 v17, v18, v19
v_cvt_pk_bf16_f32 v18, v20, v21
v_cvt_pk_bf16_f32 v19, v22, v23
ds_write_b128 v136, v[16:19] offset:0
v_cvt_pk_bf16_f32 v20, v24, v25
v_cvt_pk_bf16_f32 v21, v26, v27
v_cvt_pk_bf16_f32 v22, v28, v29
v_cvt_pk_bf16_f32 v23, v30, v31
ds_write_b128 v137, v[20:23] offset:0
v_cvt_pk_bf16_f32 v32, v32, v33
v_cvt_pk_bf16_f32 v33, v34, v35
v_cvt_pk_bf16_f32 v34, v36, v37
v_cvt_pk_bf16_f32 v35, v38, v39
ds_write_b128 v136, v[32:35] offset:4096
v_cvt_pk_bf16_f32 v36, v40, v41
v_cvt_pk_bf16_f32 v37, v42, v43
v_cvt_pk_bf16_f32 v38, v44, v45
v_cvt_pk_bf16_f32 v39, v46, v47
ds_write_b128 v137, v[36:39] offset:4096
v_cvt_pk_bf16_f32 v48, v48, v49
v_cvt_pk_bf16_f32 v49, v50, v51
v_cvt_pk_bf16_f32 v50, v52, v53
v_cvt_pk_bf16_f32 v51, v54, v55
ds_write_b128 v136, v[48:51] offset:8192
v_cvt_pk_bf16_f32 v52, v56, v57
v_cvt_pk_bf16_f32 v53, v58, v59
v_cvt_pk_bf16_f32 v54, v60, v61
v_cvt_pk_bf16_f32 v55, v62, v63
ds_write_b128 v137, v[52:55] offset:8192
v_cvt_pk_bf16_f32 v64, v64, v65
v_cvt_pk_bf16_f32 v65, v66, v67
v_cvt_pk_bf16_f32 v66, v68, v69
v_cvt_pk_bf16_f32 v67, v70, v71
ds_write_b128 v136, v[64:67] offset:12288
v_cvt_pk_bf16_f32 v68, v72, v73
v_cvt_pk_bf16_f32 v69, v74, v75
v_cvt_pk_bf16_f32 v70, v76, v77
v_cvt_pk_bf16_f32 v71, v78, v79
ds_write_b128 v137, v[68:71] offset:12288
s_waitcnt lgkmcnt(0)
L_p2j:
v_lshrrev_b32 v10, 5, v1
v_bfe_u32 v11, v1, 2, 2
v_lshl_add_u32 v10, v10, 3, v11
v_lshlrev_b32 v10, 6, v10
v_bfe_u32 v11, v1, 1, 1
v_bfe_u32 v12, v1, 3, 1
v_xor_b32 v11, v11, v12
v_bfe_u32 v12, v1, 4, 1
v_lshl_add_u32 v11, v12, 1, v11
v_lshl_add_u32 v10, v11, 4, v10
v_and_b32 v11, 1, v1
v_lshl_add_u32 v10, v11, 3, v10
v_add_u32 v4, s30, v10
v_xor_b32 v5, 32, v4
v_and_b32 v10, 31, v1
v_mul_u32_u24 v11, 288, v10
v_lshrrev_b32 v10, 4, v10
v_lshrrev_b32 v12, 5, v1
v_xor_b32 v10, v10, v12
v_lshl_add_u32 v6, v10, 4, v11
s_mul_i32 s31, s5, 9216
v_add_u32 v6, s31, v6
v_add_u32 v7, 73728, v6
v_and_b32 v10, 31, v1
v_lshrrev_b32 v11, 5, v1
v_lshlrev_b32 v10, 5, v10
v_lshl_add_u32 v8, v11, 4, v10
s_lshl_b32 s30, s6, 2
s_add_u32 s30, s30, s4
s_mul_i32 s30, s30, 294912
s_mul_i32 s31, s49, 2048
s_add_u32 s31, s31, 8192
s_add_u32 s30, s30, s31
s_lshl_b32 s31, s5, 14
s_add_u32 s30, s30, s31
v_add_u32 v8, s30, v8
s_lshl_b32 s60, s57, 15
s_waitcnt vmcnt(5)
s_barrier
ds_read_b64_tr_b16 v[184:185], v4 offset:0
ds_read_b64_tr_b16 v[186:187], v4 offset:256
ds_read_b64_tr_b16 v[188:189], v5 offset:1024
ds_read_b64_tr_b16 v[190:191], v5 offset:1280
ds_read_b64_tr_b16 v[192:193], v4 offset:2048
ds_read_b64_tr_b16 v[194:195], v4 offset:2304
ds_read_b64_tr_b16 v[196:197], v5 offset:3072
ds_read_b64_tr_b16 v[198:199], v5 offset:3328
ds_read_b64_tr_b16 v[200:201], v4 offset:4096
ds_read_b64_tr_b16 v[202:203], v4 offset:4352
ds_read_b64_tr_b16 v[204:205], v5 offset:5120
ds_read_b64_tr_b16 v[206:207], v5 offset:5376
ds_read_b64_tr_b16 v[208:209], v4 offset:6144
ds_read_b64_tr_b16 v[210:211], v4 offset:6400
ds_read_b64_tr_b16 v[212:213], v5 offset:7168
ds_read_b64_tr_b16 v[214:215], v5 offset:7424
ds_read_b64_tr_b16 v[216:217], v4 offset:8192
ds_read_b64_tr_b16 v[218:219], v4 offset:8448
ds_read_b64_tr_b16 v[220:221], v5 offset:9216
ds_read_b64_tr_b16 v[222:223], v5 offset:9472
ds_read_b64_tr_b16 v[224:225], v4 offset:10240
ds_read_b64_tr_b16 v[226:227], v4 offset:10496
ds_read_b64_tr_b16 v[228:229], v5 offset:11264
ds_read_b64_tr_b16 v[230:231], v5 offset:11520
ds_read_b64_tr_b16 v[232:233], v4 offset:12288
ds_read_b64_tr_b16 v[234:235], v4 offset:12544
ds_read_b64_tr_b16 v[236:237], v5 offset:13312
ds_read_b64_tr_b16 v[238:239], v5 offset:13568
ds_read_b64_tr_b16 v[240:241], v4 offset:14336
ds_read_b64_tr_b16 v[242:243], v4 offset:14592
ds_read_b64_tr_b16 v[244:245], v5 offset:15360
ds_read_b64_tr_b16 v[246:247], v5 offset:15616
ds_read_b64_tr_b16 v[248:249], v4 offset:16384
ds_read_b64_tr_b16 v[250:251], v4 offset:16640
ds_read_b64_tr_b16 v[252:253], v5 offset:17408
ds_read_b64_tr_b16 v[254:255], v5 offset:17664
ds_read_b128 v[96:99], v7 offset:0
ds_read_b128 v[100:103], v7 offset:18432
ds_read_b128 v[104:107], v7 offset:32
s_waitcnt lgkmcnt(2)
v_mfma_f32_32x32x16_bf16 v[16:31], v[96:99], v[184:187], 0
s_barrier
ds_read_b128 v[108:111], v7 offset:18464
s_waitcnt lgkmcnt(2)
v_mfma_f32_32x32x16_bf16 v[16:31], v[100:103], v[188:191], v[16:31]
ds_read_b128 v[96:99], v7 offset:64
s_add_u32 m0, s59, 0
s_nop 0
buffer_load_dwordx4 v112, s[16:19], s61 offen offset:0 lds
s_waitcnt lgkmcnt(2)
v_mfma_f32_32x32x16_bf16 v[16:31], v[104:107], v[192:195], v[16:31]
ds_read_b128 v[100:103], v7 offset:18496
buffer_load_dwordx4 v113, s[16:19], s61 offen offset:1024 lds
s_waitcnt lgkmcnt(2)
v_mfma_f32_32x32x16_bf16 v[16:31], v[108:111], v[196:199], v[16:31]
ds_read_b128 v[104:107], v7 offset:96
buffer_load_dwordx4 v114, s[16:19], s61 offen offset:2048 lds
s_waitcnt lgkmcnt(2)
v_mfma_f32_32x32x16_bf16 v[16:31], v[96:99], v[200:203], v[16:31]
ds_read_b128 v[108:111], v7 offset:18528
buffer_load_dwordx4 v115, s[16:19], s61 offen offset:3072 lds
s_waitcnt lgkmcnt(2)
v_mfma_f32_32x32x16_bf16 v[16:31], v[100:103], v[204:207], v[16:31]
ds_read_b128 v[96:99], v7 offset:128
s_add_u32 m0, s59, 4096
s_nop 0
buffer_load_dwordx4 v116, s[16:19], s61 offen offset:0 lds
s_add_u32 s61, s61, 294912
s_cmp_ge_u32 s61, 663552
s_cselect_b32 s35, 663552, 0
s_sub_u32 s61, s61, s35
s_waitcnt lgkmcnt(2)
v_mfma_f32_32x32x16_bf16 v[16:31], v[104:107], v[208:211], v[16:31]
ds_read_b128 v[100:103], v7 offset:18560
s_add_u32 m0, s59, 36864
s_nop 0
buffer_load_dwordx4 v112, s[16:19], s61 offen offset:0 lds
s_waitcnt lgkmcnt(2)
v_mfma_f32_32x32x16_bf16 v[16:31], v[108:111], v[212:215], v[16:31]
ds_read_b128 v[104:107], v7 offset:160
buffer_load_dwordx4 v113, s[16:19], s61 offen offset:1024 lds
s_waitcnt lgkmcnt(2)
v_mfma_f32_32x32x16_bf16 v[16:31], v[96:99], v[216:219], v[16:31]
ds_read_b128 v[108:111], v7 offset:18592
buffer_load_dwordx4 v114, s[16:19], s61 offen offset:2048 lds
s_waitcnt lgkmcnt(2)
v_mfma_f32_32x32x16_bf16 v[16:31], v[100:103], v[220:223], v[16:31]
ds_read_b128 v[96:99], v7 offset:192
buffer_load_dwordx4 v115, s[16:19], s61 offen offset:3072 lds
s_waitcnt lgkmcnt(2)
v_mfma_f32_32x32x16_bf16 v[16:31], v[104:107], v[224:227], v[16:31]
ds_read_b128 v[100:103], v7 offset:18624
s_add_u32 m0, s59, 40960
s_nop 0
buffer_load_dwordx4 v116, s[16:19], s61 offen offset:0 lds
s_add_u32 s61, s61, 221184
s_cmp_ge_u32 s61, 663552
s_cselect_b32 s35, 663552, 0
s_sub_u32 s61, s61, s35
s_waitcnt lgkmcnt(2)
v_mfma_f32_32x32x16_bf16 v[16:31], v[108:111], v[228:231], v[16:31]
ds_read_b128 v[104:107], v7 offset:224
s_cmp_lg_u32 s3, 0
s_cbranch_scc1 L_ann_s2
s_lshl_b32 s28, s6, 4
s_add_u32 s28, s28, s7
v_mov_b32 v0, 3
s_mov_b64 exec, 1
buffer_store_byte v0, off, s[24:27], s28 sc0 sc1
s_mov_b64 exec, -1
L_ann_s2:
s_waitcnt lgkmcnt(2)
v_mfma_f32_32x32x16_bf16 v[16:31], v[96:99], v[232:235], v[16:31]
ds_read_b128 v[108:111], v7 offset:18656
s_waitcnt lgkmcnt(2)
v_mfma_f32_32x32x16_bf16 v[16:31], v[100:103], v[236:239], v[16:31]
ds_read_b128 v[96:99], v7 offset:256
s_waitcnt lgkmcnt(2)
v_mfma_f32_32x32x16_bf16 v[16:31], v[104:107], v[240:243], v[16:31]
ds_read_b128 v[100:103], v7 offset:18688
s_waitcnt lgkmcnt(2)
v_mfma_f32_32x32x16_bf16 v[16:31], v[108:111], v[244:247], v[16:31]
s_waitcnt vmcnt(10)
s_barrier
ds_read_b128 v[104:107], v7 offset:36864
s_waitcnt lgkmcnt(2)
v_mfma_f32_32x32x16_bf16 v[16:31], v[96:99], v[248:251], v[16:31]
ds_read_b128 v[108:111], v7 offset:55296
s_waitcnt lgkmcnt(2)
v_mfma_f32_32x32x16_bf16 v[16:31], v[100:103], v[252:255], v[16:31]
ds_read_b128 v[96:99], v7 offset:36896
s_waitcnt lgkmcnt(2)
v_mfma_f32_32x32x16_bf16 v[32:47], v[104:107], v[184:187], 0
ds_read_b128 v[100:103], v7 offset:55328
s_waitcnt lgkmcnt(2)
v_mfma_f32_32x32x16_bf16 v[32:47], v[108:111], v[188:191], v[32:47]
ds_read_b128 v[104:107], v7 offset:36928
s_waitcnt lgkmcnt(2)
v_mfma_f32_32x32x16_bf16 v[32:47], v[96:99], v[192:195], v[32:47]
ds_read_b128 v[108:111], v7 offset:55360
s_nop 1
v_cvt_pk_bf16_f32 v48, v16, v17
v_cvt_pk_bf16_f32 v49, v18, v19
v_cvt_pk_bf16_f32 v50, v20, v21
s_waitcnt lgkmcnt(2)
v_mfma_f32_32x32x16_bf16 v[32:47], v[100:103], v[196:199], v[32:47]
ds_read_b128 v[96:99], v7 offset:36960
v_cvt_pk_bf16_f32 v51, v22, v23
buffer_store_dwordx4 v[48:51], v8, s[20:23], s60 offen sc0 sc1
v_cvt_pk_bf16_f32 v52, v24, v25
s_waitcnt lgkmcnt(2)
v_mfma_f32_32x32x16_bf16 v[32:47], v[104:107], v[200:203], v[32:47]
ds_read_b128 v[100:103], v7 offset:55392
v_cvt_pk_bf16_f32 v53, v26, v27
v_cvt_pk_bf16_f32 v54, v28, v29
s_waitcnt lgkmcnt(2)
v_mfma_f32_32x32x16_bf16 v[32:47], v[108:111], v[204:207], v[32:47]
ds_read_b128 v[104:107], v7 offset:36992
v_cvt_pk_bf16_f32 v55, v30, v31
buffer_store_dwordx4 v[52:55], v8, s[20:23], s60 offen offset:1024 sc0 sc1
s_add_u32 s60, s60, 98304
s_cmp_ge_u32 s60, 294912
s_cselect_b32 s35, 294912, 0
s_sub_u32 s60, s60, s35
s_waitcnt lgkmcnt(2)
v_mfma_f32_32x32x16_bf16 v[32:47], v[96:99], v[208:211], v[32:47]
ds_read_b128 v[108:111], v7 offset:55424
s_add_u32 m0, s59, 73728
s_nop 0
buffer_load_dwordx4 v112, s[16:19], s61 offen offset:0 lds
s_waitcnt lgkmcnt(2)
v_mfma_f32_32x32x16_bf16 v[32:47], v[100:103], v[212:215], v[32:47]
ds_read_b128 v[96:99], v7 offset:37024
s_waitcnt lgkmcnt(2)
v_mfma_f32_32x32x16_bf16 v[32:47], v[104:107], v[216:219], v[32:47]
ds_read_b128 v[100:103], v7 offset:55456
buffer_load_dwordx4 v113, s[16:19], s61 offen offset:1024 lds
s_waitcnt lgkmcnt(2)
v_mfma_f32_32x32x16_bf16 v[32:47], v[108:111], v[220:223], v[32:47]
ds_read_b128 v[104:107], v7 offset:37056
s_waitcnt lgkmcnt(2)
v_mfma_f32_32x32x16_bf16 v[32:47], v[96:99], v[224:227], v[32:47]
ds_read_b128 v[108:111], v7 offset:55488
buffer_load_dwordx4 v114, s[16:19], s61 offen offset:2048 lds
s_waitcnt lgkmcnt(2)
v_mfma_f32_32x32x16_bf16 v[32:47], v[100:103], v[228:231], v[32:47]
ds_read_b128 v[96:99], v7 offset:37088
s_waitcnt lgkmcnt(2)
v_mfma_f32_32x32x16_bf16 v[32:47], v[104:107], v[232:235], v[32:47]
ds_read_b128 v[100:103], v7 offset:55520
buffer_load_dwordx4 v115, s[16:19], s61 offen offset:3072 lds
s_waitcnt lgkmcnt(2)
v_mfma_f32_32x32x16_bf16 v[32:47], v[108:111], v[236:239], v[32:47]
ds_read_b128 v[104:107], v7 offset:37120
s_waitcnt lgkmcnt(2)
v_mfma_f32_32x32x16_bf16 v[32:47], v[96:99], v[240:243], v[32:47]
ds_read_b128 v[108:111], v7 offset:55552
s_add_u32 m0, s59, 77824
s_nop 0
buffer_load_dwordx4 v116, s[16:19], s61 offen offset:0 lds
s_add_u32 s61, s61, 221184
s_cmp_ge_u32 s61, 663552
s_cselect_b32 s35, 663552, 0
s_sub_u32 s61, s61, s35
s_waitcnt lgkmcnt(2)
v_mfma_f32_32x32x16_bf16 v[32:47], v[100:103], v[244:247], v[32:47]
s_waitcnt vmcnt(12)
s_barrier
ds_read_b128 v[96:99], v6 offset:0
s_waitcnt lgkmcnt(2)
v_mfma_f32_32x32x16_bf16 v[32:47], v[104:107], v[248:251], v[32:47]
ds_read_b128 v[100:103], v6 offset:18432
s_waitcnt lgkmcnt(2)
v_mfma_f32_32x32x16_bf16 v[32:47], v[108:111], v[252:255], v[32:47]
ds_read_b128 v[104:107], v6 offset:32
s_waitcnt lgkmcnt(2)
v_mfma_f32_32x32x16_bf16 v[16:31], v[96:99], v[184:187], 0
ds_read_b128 v[108:111], v6 offset:18464
s_waitcnt lgkmcnt(2)
v_mfma_f32_32x32x16_bf16 v[16:31], v[100:103], v[188:191], v[16:31]
ds_read_b128 v[96:99], v6 offset:64
s_waitcnt lgkmcnt(2)
v_mfma_f32_32x32x16_bf16 v[16:31], v[104:107], v[192:195], v[16:31]
ds_read_b128 v[100:103], v6 offset:18496
s_nop 1
v_cvt_pk_bf16_f32 v48, v32, v33
v_cvt_pk_bf16_f32 v49, v34, v35
v_cvt_pk_bf16_f32 v50, v36, v37
s_waitcnt lgkmcnt(2)
v_mfma_f32_32x32x16_bf16 v[16:31], v[108:111], v[196:199], v[16:31]
ds_read_b128 v[104:107], v6 offset:96
v_cvt_pk_bf16_f32 v51, v38, v39
buffer_store_dwordx4 v[48:51], v8, s[20:23], s60 offen sc0 sc1
v_cvt_pk_bf16_f32 v52, v40, v41
s_waitcnt lgkmcnt(2)
v_mfma_f32_32x32x16_bf16 v[16:31], v[96:99], v[200:203], v[16:31]
ds_read_b128 v[108:111], v6 offset:18528
v_cvt_pk_bf16_f32 v53, v42, v43
v_cvt_pk_bf16_f32 v54, v44, v45
s_waitcnt lgkmcnt(2)
v_mfma_f32_32x32x16_bf16 v[16:31], v[100:103], v[204:207], v[16:31]
ds_read_b128 v[96:99], v6 offset:128
v_cvt_pk_bf16_f32 v55, v46, v47
buffer_store_dwordx4 v[52:55], v8, s[20:23], s60 offen offset:1024 sc0 sc1
s_add_u32 s60, s60, 98304
s_cmp_ge_u32 s60, 294912
s_cselect_b32 s35, 294912, 0
s_sub_u32 s60, s60, s35
s_waitcnt lgkmcnt(2)
v_mfma_f32_32x32x16_bf16 v[16:31], v[104:107], v[208:211], v[16:31]
ds_read_b128 v[100:103], v6 offset:18560
s_add_u32 m0, s59, 110592
s_nop 0
buffer_load_dwordx4 v112, s[16:19], s61 offen offset:0 lds
s_waitcnt lgkmcnt(2)
v_mfma_f32_32x32x16_bf16 v[16:31], v[108:111], v[212:215], v[16:31]
ds_read_b128 v[104:107], v6 offset:160
s_waitcnt lgkmcnt(2)
v_mfma_f32_32x32x16_bf16 v[16:31], v[96:99], v[216:219], v[16:31]
ds_read_b128 v[108:111], v6 offset:18592
buffer_load_dwordx4 v113, s[16:19], s61 offen offset:1024 lds
s_waitcnt lgkmcnt(2)
v_mfma_f32_32x32x16_bf16 v[16:31], v[100:103], v[220:223], v[16:31]
ds_read_b128 v[96:99], v6 offset:192
s_waitcnt lgkmcnt(2)
v_mfma_f32_32x32x16_bf16 v[16:31], v[104:107], v[224:227], v[16:31]
ds_read_b128 v[100:103], v6 offset:18624
buffer_load_dwordx4 v114, s[16:19], s61 offen offset:2048 lds
s_waitcnt lgkmcnt(2)
v_mfma_f32_32x32x16_bf16 v[16:31], v[108:111], v[228:231], v[16:31]
ds_read_b128 v[104:107], v6 offset:224
s_waitcnt lgkmcnt(2)
v_mfma_f32_32x32x16_bf16 v[16:31], v[96:99], v[232:235], v[16:31]
ds_read_b128 v[108:111], v6 offset:18656
buffer_load_dwordx4 v115, s[16:19], s61 offen offset:3072 lds
s_waitcnt lgkmcnt(2)
v_mfma_f32_32x32x16_bf16 v[16:31], v[100:103], v[236:239], v[16:31]
ds_read_b128 v[96:99], v6 offset:256
s_waitcnt lgkmcnt(2)
v_mfma_f32_32x32x16_bf16 v[16:31], v[104:107], v[240:243], v[16:31]
ds_read_b128 v[100:103], v6 offset:18688
s_add_u32 m0, s59, 114688
s_nop 0
buffer_load_dwordx4 v116, s[16:19], s61 offen offset:0 lds
s_add_u32 s61, s61, 294912
s_cmp_ge_u32 s61, 663552
s_cselect_b32 s35, 663552, 0
s_sub_u32 s61, s61, s35
s_waitcnt lgkmcnt(2)
v_mfma_f32_32x32x16_bf16 v[16:31], v[108:111], v[244:247], v[16:31]
s_waitcnt vmcnt(14)
s_barrier
ds_read_b128 v[104:107], v6 offset:36864
s_waitcnt lgkmcnt(2)
v_mfma_f32_32x32x16_bf16 v[16:31], v[96:99], v[248:251], v[16:31]
ds_read_b128 v[108:111], v6 offset:55296
s_waitcnt lgkmcnt(2)
v_mfma_f32_32x32x16_bf16 v[16:31], v[100:103], v[252:255], v[16:31]
ds_read_b128 v[96:99], v6 offset:36896
s_waitcnt lgkmcnt(2)
v_mfma_f32_32x32x16_bf16 v[32:47], v[104:107], v[184:187], 0
ds_read_b128 v[100:103], v6 offset:55328
s_waitcnt lgkmcnt(2)
v_mfma_f32_32x32x16_bf16 v[32:47], v[108:111], v[188:191], v[32:47]
ds_read_b128 v[104:107], v6 offset:36928
s_waitcnt lgkmcnt(2)
v_mfma_f32_32x32x16_bf16 v[32:47], v[96:99], v[192:195], v[32:47]
ds_read_b128 v[108:111], v6 offset:55360
s_nop 1
v_cvt_pk_bf16_f32 v48, v16, v17
v_cvt_pk_bf16_f32 v49, v18, v19
v_cvt_pk_bf16_f32 v50, v20, v21
s_waitcnt lgkmcnt(2)
v_mfma_f32_32x32x16_bf16 v[32:47], v[100:103], v[196:199], v[32:47]
ds_read_b128 v[96:99], v6 offset:36960
v_cvt_pk_bf16_f32 v51, v22, v23
buffer_store_dwordx4 v[48:51], v8, s[20:23], s60 offen sc0 sc1
v_cvt_pk_bf16_f32 v52, v24, v25
s_waitcnt lgkmcnt(2)
v_mfma_f32_32x32x16_bf16 v[32:47], v[104:107], v[200:203], v[32:47]
ds_read_b128 v[100:103], v6 offset:55392
v_cvt_pk_bf16_f32 v53, v26, v27
v_cvt_pk_bf16_f32 v54, v28, v29
s_waitcnt lgkmcnt(2)
v_mfma_f32_32x32x16_bf16 v[32:47], v[108:111], v[204:207], v[32:47]
ds_read_b128 v[104:107], v6 offset:36992
v_cvt_pk_bf16_f32 v55, v30, v31
buffer_store_dwordx4 v[52:55], v8, s[20:23], s60 offen offset:1024 sc0 sc1
s_add_u32 s60, s60, 131072
s_cmp_ge_u32 s60, 294912
s_cselect_b32 s35, 294912, 0
s_sub_u32 s60, s60, s35
s_waitcnt lgkmcnt(2)
v_mfma_f32_32x32x16_bf16 v[32:47], v[96:99], v[208:211], v[32:47]
ds_read_b128 v[108:111], v6 offset:55424
s_add_u32 m0, s59, 0
s_nop 0
buffer_load_dwordx4 v112, s[16:19], s61 offen offset:0 lds
s_waitcnt lgkmcnt(2)
v_mfma_f32_32x32x16_bf16 v[32:47], v[100:103], v[212:215], v[32:47]
ds_read_b128 v[96:99], v6 offset:37024
s_waitcnt lgkmcnt(2)
v_mfma_f32_32x32x16_bf16 v[32:47], v[104:107], v[216:219], v[32:47]
ds_read_b128 v[100:103], v6 offset:55456
buffer_load_dwordx4 v113, s[16:19], s61 offen offset:1024 lds
s_waitcnt lgkmcnt(2)
v_mfma_f32_32x32x16_bf16 v[32:47], v[108:111], v[220:223], v[32:47]
ds_read_b128 v[104:107], v6 offset:37056
s_waitcnt lgkmcnt(2)
v_mfma_f32_32x32x16_bf16 v[32:47], v[96:99], v[224:227], v[32:47]
ds_read_b128 v[108:111], v6 offset:55488
buffer_load_dwordx4 v114, s[16:19], s61 offen offset:2048 lds
s_waitcnt lgkmcnt(2)
v_mfma_f32_32x32x16_bf16 v[32:47], v[100:103], v[228:231], v[32:47]
ds_read_b128 v[96:99], v6 offset:37088
s_waitcnt lgkmcnt(2)
v_mfma_f32_32x32x16_bf16 v[32:47], v[104:107], v[232:235], v[32:47]
ds_read_b128 v[100:103], v6 offset:55520
buffer_load_dwordx4 v115, s[16:19], s61 offen offset:3072 lds
s_waitcnt lgkmcnt(2)
v_mfma_f32_32x32x16_bf16 v[32:47], v[108:111], v[236:239], v[32:47]
ds_read_b128 v[104:107], v6 offset:37120
s_waitcnt lgkmcnt(2)
v_mfma_f32_32x32x16_bf16 v[32:47], v[96:99], v[240:243], v[32:47]
ds_read_b128 v[108:111], v6 offset:55552
s_add_u32 m0, s59, 4096
s_nop 0
buffer_load_dwordx4 v116, s[16:19], s61 offen offset:0 lds
s_add_u32 s61, s61, 221184
s_cmp_ge_u32 s61, 663552
s_cselect_b32 s35, 663552, 0
s_sub_u32 s61, s61, s35
s_waitcnt lgkmcnt(2)
v_mfma_f32_32x32x16_bf16 v[32:47], v[100:103], v[244:247], v[32:47]
s_waitcnt vmcnt(14)
s_barrier
ds_read_b128 v[96:99], v7 offset:0
s_waitcnt lgkmcnt(2)
v_mfma_f32_32x32x16_bf16 v[32:47], v[104:107], v[248:251], v[32:47]
ds_read_b128 v[100:103], v7 offset:18432
s_waitcnt lgkmcnt(2)
v_mfma_f32_32x32x16_bf16 v[32:47], v[108:111], v[252:255], v[32:47]
ds_read_b128 v[104:107], v7 offset:32
s_waitcnt lgkmcnt(2)
v_mfma_f32_32x32x16_bf16 v[16:31], v[96:99], v[184:187], 0
ds_read_b128 v[108:111], v7 offset:18464
s_waitcnt lgkmcnt(2)
v_mfma_f32_32x32x16_bf16 v[16:31], v[100:103], v[188:191], v[16:31]
ds_read_b128 v[96:99], v7 offset:64
s_waitcnt lgkmcnt(2)
v_mfma_f32_32x32x16_bf16 v[16:31], v[104:107], v[192:195], v[16:31]
ds_read_b128 v[100:103], v7 offset:18496
s_nop 1
v_cvt_pk_bf16_f32 v48, v32, v33
v_cvt_pk_bf16_f32 v49, v34, v35
v_cvt_pk_bf16_f32 v50, v36, v37
s_waitcnt lgkmcnt(2)
v_mfma_f32_32x32x16_bf16 v[16:31], v[108:111], v[196:199], v[16:31]
ds_read_b128 v[104:107], v7 offset:96
v_cvt_pk_bf16_f32 v51, v38, v39
buffer_store_dwordx4 v[48:51], v8, s[20:23], s60 offen sc0 sc1
v_cvt_pk_bf16_f32 v52, v40, v41
s_waitcnt lgkmcnt(2)
v_mfma_f32_32x32x16_bf16 v[16:31], v[96:99], v[200:203], v[16:31]
ds_read_b128 v[108:111], v7 offset:18528
v_cvt_pk_bf16_f32 v53, v42, v43
v_cvt_pk_bf16_f32 v54, v44, v45
s_waitcnt lgkmcnt(2)
v_mfma_f32_32x32x16_bf16 v[16:31], v[100:103], v[204:207], v[16:31]
ds_read_b128 v[96:99], v7 offset:128
v_cvt_pk_bf16_f32 v55, v46, v47
buffer_store_dwordx4 v[52:55], v8, s[20:23], s60 offen offset:1024 sc0 sc1
s_add_u32 s60, s60, 98304
s_cmp_ge_u32 s60, 294912
s_cselect_b32 s35, 294912, 0
s_sub_u32 s60, s60, s35
s_waitcnt lgkmcnt(2)
v_mfma_f32_32x32x16_bf16 v[16:31], v[104:107], v[208:211], v[16:31]
ds_read_b128 v[100:103], v7 offset:18560
s_add_u32 m0, s59, 36864
s_nop 0
buffer_load_dwordx4 v112, s[16:19], s61 offen offset:0 lds
s_waitcnt lgkmcnt(2)
v_mfma_f32_32x32x16_bf16 v[16:31], v[108:111], v[212:215], v[16:31]
ds_read_b128 v[104:107], v7 offset:160
s_waitcnt lgkmcnt(2)
v_mfma_f32_32x32x16_bf16 v[16:31], v[96:99], v[216:219], v[16:31]
ds_read_b128 v[108:111], v7 offset:18592
buffer_load_dwordx4 v113, s[16:19], s61 offen offset:1024 lds
s_waitcnt lgkmcnt(2)
v_mfma_f32_32x32x16_bf16 v[16:31], v[100:103], v[220:223], v[16:31]
ds_read_b128 v[96:99], v7 offset:192
s_waitcnt lgkmcnt(2)
v_mfma_f32_32x32x16_bf16 v[16:31], v[104:107], v[224:227], v[16:31]
ds_read_b128 v[100:103], v7 offset:18624
buffer_load_dwordx4 v114, s[16:19], s61 offen offset:2048 lds
s_waitcnt lgkmcnt(2)
v_mfma_f32_32x32x16_bf16 v[16:31], v[108:111], v[228:231], v[16:31]
ds_read_b128 v[104:107], v7 offset:224
s_waitcnt lgkmcnt(2)
v_mfma_f32_32x32x16_bf16 v[16:31], v[96:99], v[232:235], v[16:31]
ds_read_b128 v[108:111], v7 offset:18656
buffer_load_dwordx4 v115, s[16:19], s61 offen offset:3072 lds
s_waitcnt lgkmcnt(2)
v_mfma_f32_32x32x16_bf16 v[16:31], v[100:103], v[236:239], v[16:31]
ds_read_b128 v[96:99], v7 offset:256
s_waitcnt lgkmcnt(2)
v_mfma_f32_32x32x16_bf16 v[16:31], v[104:107], v[240:243], v[16:31]
ds_read_b128 v[100:103], v7 offset:18688
s_add_u32 m0, s59, 40960
s_nop 0
buffer_load_dwordx4 v116, s[16:19], s61 offen offset:0 lds
s_add_u32 s61, s61, 221184
s_cmp_ge_u32 s61, 663552
s_cselect_b32 s35, 663552, 0
s_sub_u32 s61, s61, s35
s_waitcnt lgkmcnt(2)
v_mfma_f32_32x32x16_bf16 v[16:31], v[108:111], v[244:247], v[16:31]
s_waitcnt vmcnt(14)
s_barrier
ds_read_b128 v[104:107], v7 offset:36864
s_waitcnt lgkmcnt(2)
v_mfma_f32_32x32x16_bf16 v[16:31], v[96:99], v[248:251], v[16:31]
ds_read_b128 v[108:111], v7 offset:55296
s_waitcnt lgkmcnt(2)
v_mfma_f32_32x32x16_bf16 v[16:31], v[100:103], v[252:255], v[16:31]
ds_read_b128 v[96:99], v7 offset:36896
s_waitcnt lgkmcnt(2)
v_mfma_f32_32x32x16_bf16 v[32:47], v[104:107], v[184:187], 0
ds_read_b128 v[100:103], v7 offset:55328
s_waitcnt lgkmcnt(2)
v_mfma_f32_32x32x16_bf16 v[32:47], v[108:111], v[188:191], v[32:47]
ds_read_b128 v[104:107], v7 offset:36928
s_waitcnt lgkmcnt(2)
v_mfma_f32_32x32x16_bf16 v[32:47], v[96:99], v[192:195], v[32:47]
ds_read_b128 v[108:111], v7 offset:55360
s_nop 1
v_cvt_pk_bf16_f32 v48, v16, v17
v_cvt_pk_bf16_f32 v49, v18, v19
v_cvt_pk_bf16_f32 v50, v20, v21
s_waitcnt lgkmcnt(2)
v_mfma_f32_32x32x16_bf16 v[32:47], v[100:103], v[196:199], v[32:47]
ds_read_b128 v[96:99], v7 offset:36960
v_cvt_pk_bf16_f32 v51, v22, v23
buffer_store_dwordx4 v[48:51], v8, s[20:23], s60 offen sc0 sc1
v_cvt_pk_bf16_f32 v52, v24, v25
s_waitcnt lgkmcnt(2)
v_mfma_f32_32x32x16_bf16 v[32:47], v[104:107], v[200:203], v[32:47]
ds_read_b128 v[100:103], v7 offset:55392
v_cvt_pk_bf16_f32 v53, v26, v27
v_cvt_pk_bf16_f32 v54, v28, v29
s_waitcnt lgkmcnt(2)
v_mfma_f32_32x32x16_bf16 v[32:47], v[108:111], v[204:207], v[32:47]
ds_read_b128 v[104:107], v7 offset:36992
v_cvt_pk_bf16_f32 v55, v30, v31
buffer_store_dwordx4 v[52:55], v8, s[20:23], s60 offen offset:1024 sc0 sc1
s_add_u32 s60, s60, 98304
s_cmp_ge_u32 s60, 294912
s_cselect_b32 s35, 294912, 0
s_sub_u32 s60, s60, s35
s_waitcnt lgkmcnt(2)
v_mfma_f32_32x32x16_bf16 v[32:47], v[96:99], v[208:211], v[32:47]
ds_read_b128 v[108:111], v7 offset:55424
s_add_u32 m0, s59, 73728
s_nop 0
buffer_load_dwordx4 v112, s[16:19], s61 offen offset:0 lds
s_waitcnt lgkmcnt(2)
v_mfma_f32_32x32x16_bf16 v[32:47], v[100:103], v[212:215], v[32:47]
ds_read_b128 v[96:99], v7 offset:37024
s_waitcnt lgkmcnt(2)
v_mfma_f32_32x32x16_bf16 v[32:47], v[104:107], v[216:219], v[32:47]
ds_read_b128 v[100:103], v7 offset:55456
buffer_load_dwordx4 v113, s[16:19], s61 offen offset:1024 lds
s_waitcnt lgkmcnt(2)
v_mfma_f32_32x32x16_bf16 v[32:47], v[108:111], v[220:223], v[32:47]
ds_read_b128 v[104:107], v7 offset:37056
s_waitcnt lgkmcnt(2)
v_mfma_f32_32x32x16_bf16 v[32:47], v[96:99], v[224:227], v[32:47]
ds_read_b128 v[108:111], v7 offset:55488
buffer_load_dwordx4 v114, s[16:19], s61 offen offset:2048 lds
s_waitcnt lgkmcnt(2)
v_mfma_f32_32x32x16_bf16 v[32:47], v[100:103], v[228:231], v[32:47]
ds_read_b128 v[96:99], v7 offset:37088
s_waitcnt lgkmcnt(2)
v_mfma_f32_32x32x16_bf16 v[32:47], v[104:107], v[232:235], v[32:47]
ds_read_b128 v[100:103], v7 offset:55520
buffer_load_dwordx4 v115, s[16:19], s61 offen offset:3072 lds
s_waitcnt lgkmcnt(2)
v_mfma_f32_32x32x16_bf16 v[32:47], v[108:111], v[236:239], v[32:47]
ds_read_b128 v[104:107], v7 offset:37120
s_waitcnt lgkmcnt(2)
v_mfma_f32_32x32x16_bf16 v[32:47], v[96:99], v[240:243], v[32:47]
ds_read_b128 v[108:111], v7 offset:55552
s_add_u32 m0, s59, 77824
s_nop 0
buffer_load_dwordx4 v116, s[16:19], s61 offen offset:0 lds
s_add_u32 s61, s61, 294912
s_cmp_ge_u32 s61, 663552
s_cselect_b32 s35, 663552, 0
s_sub_u32 s61, s61, s35
s_waitcnt lgkmcnt(2)
v_mfma_f32_32x32x16_bf16 v[32:47], v[100:103], v[244:247], v[32:47]
s_waitcnt vmcnt(14)
s_barrier
ds_read_b128 v[96:99], v6 offset:0
s_waitcnt lgkmcnt(2)
v_mfma_f32_32x32x16_bf16 v[32:47], v[104:107], v[248:251], v[32:47]
ds_read_b128 v[100:103], v6 offset:18432
s_waitcnt lgkmcnt(2)
v_mfma_f32_32x32x16_bf16 v[32:47], v[108:111], v[252:255], v[32:47]
ds_read_b128 v[104:107], v6 offset:32
s_waitcnt lgkmcnt(2)
v_mfma_f32_32x32x16_bf16 v[16:31], v[96:99], v[184:187], 0
ds_read_b128 v[108:111], v6 offset:18464
s_waitcnt lgkmcnt(2)
v_mfma_f32_32x32x16_bf16 v[16:31], v[100:103], v[188:191], v[16:31]
ds_read_b128 v[96:99], v6 offset:64
s_waitcnt lgkmcnt(2)
v_mfma_f32_32x32x16_bf16 v[16:31], v[104:107], v[192:195], v[16:31]
ds_read_b128 v[100:103], v6 offset:18496
s_nop 1
v_cvt_pk_bf16_f32 v48, v32, v33
v_cvt_pk_bf16_f32 v49, v34, v35
v_cvt_pk_bf16_f32 v50, v36, v37
s_waitcnt lgkmcnt(2)
v_mfma_f32_32x32x16_bf16 v[16:31], v[108:111], v[196:199], v[16:31]
ds_read_b128 v[104:107], v6 offset:96
v_cvt_pk_bf16_f32 v51, v38, v39
buffer_store_dwordx4 v[48:51], v8, s[20:23], s60 offen sc0 sc1
v_cvt_pk_bf16_f32 v52, v40, v41
s_waitcnt lgkmcnt(2)
v_mfma_f32_32x32x16_bf16 v[16:31], v[96:99], v[200:203], v[16:31]
ds_read_b128 v[108:111], v6 offset:18528
v_cvt_pk_bf16_f32 v53, v42, v43
v_cvt_pk_bf16_f32 v54, v44, v45
s_waitcnt lgkmcnt(2)
v_mfma_f32_32x32x16_bf16 v[16:31], v[100:103], v[204:207], v[16:31]
ds_read_b128 v[96:99], v6 offset:128
v_cvt_pk_bf16_f32 v55, v46, v47
buffer_store_dwordx4 v[52:55], v8, s[20:23], s60 offen offset:1024 sc0 sc1
s_add_u32 s60, s60, 131072
s_cmp_ge_u32 s60, 294912
s_cselect_b32 s35, 294912, 0
s_sub_u32 s60, s60, s35
s_waitcnt lgkmcnt(2)
v_mfma_f32_32x32x16_bf16 v[16:31], v[104:107], v[208:211], v[16:31]
ds_read_b128 v[100:103], v6 offset:18560
s_waitcnt lgkmcnt(2)
v_mfma_f32_32x32x16_bf16 v[16:31], v[108:111], v[212:215], v[16:31]
ds_read_b128 v[104:107], v6 offset:160
s_waitcnt lgkmcnt(2)
v_mfma_f32_32x32x16_bf16 v[16:31], v[96:99], v[216:219], v[16:31]
ds_read_b128 v[108:111], v6 offset:18592
s_waitcnt lgkmcnt(2)
v_mfma_f32_32x32x16_bf16 v[16:31], v[100:103], v[220:223], v[16:31]
ds_read_b128 v[96:99], v6 offset:192
s_waitcnt lgkmcnt(2)
v_mfma_f32_32x32x16_bf16 v[16:31], v[104:107], v[224:227], v[16:31]
ds_read_b128 v[100:103], v6 offset:18624
s_waitcnt lgkmcnt(2)
v_mfma_f32_32x32x16_bf16 v[16:31], v[108:111], v[228:231], v[16:31]
ds_read_b128 v[104:107], v6 offset:224
s_waitcnt lgkmcnt(2)
v_mfma_f32_32x32x16_bf16 v[16:31], v[96:99], v[232:235], v[16:31]
ds_read_b128 v[108:111], v6 offset:18656
s_waitcnt lgkmcnt(2)
v_mfma_f32_32x32x16_bf16 v[16:31], v[100:103], v[236:239], v[16:31]
ds_read_b128 v[96:99], v6 offset:256
s_waitcnt lgkmcnt(2)
v_mfma_f32_32x32x16_bf16 v[16:31], v[104:107], v[240:243], v[16:31]
ds_read_b128 v[100:103], v6 offset:18688
s_waitcnt lgkmcnt(2)
v_mfma_f32_32x32x16_bf16 v[16:31], v[108:111], v[244:247], v[16:31]
s_waitcnt vmcnt(9)
s_barrier
ds_read_b128 v[104:107], v6 offset:36864
s_waitcnt lgkmcnt(2)
v_mfma_f32_32x32x16_bf16 v[16:31], v[96:99], v[248:251], v[16:31]
ds_read_b128 v[108:111], v6 offset:55296
s_waitcnt lgkmcnt(2)
v_mfma_f32_32x32x16_bf16 v[16:31], v[100:103], v[252:255], v[16:31]
ds_read_b128 v[96:99], v6 offset:36896
s_waitcnt lgkmcnt(2)
v_mfma_f32_32x32x16_bf16 v[32:47], v[104:107], v[184:187], 0
ds_read_b128 v[100:103], v6 offset:55328
s_waitcnt lgkmcnt(2)
v_mfma_f32_32x32x16_bf16 v[32:47], v[108:111], v[188:191], v[32:47]
ds_read_b128 v[104:107], v6 offset:36928
v_mov_b32 v60, 1
s_waitcnt vmcnt(0)
s_mov_b64 exec, 1
buffer_store_byte v60, off, s[20:23], s63 sc0 sc1
s_mov_b64 exec, -1
s_waitcnt lgkmcnt(2)
v_mfma_f32_32x32x16_bf16 v[32:47], v[96:99], v[192:195], v[32:47]
ds_read_b128 v[108:111], v6 offset:55360
v_cvt_pk_bf16_f32 v48, v16, v17
v_cvt_pk_bf16_f32 v49, v18, v19
v_cvt_pk_bf16_f32 v50, v20, v21
s_waitcnt lgkmcnt(2)
v_mfma_f32_32x32x16_bf16 v[32:47], v[100:103], v[196:199], v[32:47]
ds_read_b128 v[96:99], v6 offset:36960
v_cvt_pk_bf16_f32 v51, v22, v23
buffer_store_dwordx4 v[48:51], v8, s[20:23], s60 offen sc0 sc1
v_cvt_pk_bf16_f32 v52, v24, v25
s_waitcnt lgkmcnt(2)
v_mfma_f32_32x32x16_bf16 v[32:47], v[104:107], v[200:203], v[32:47]
ds_read_b128 v[100:103], v6 offset:55392
v_cvt_pk_bf16_f32 v53, v26, v27
v_cvt_pk_bf16_f32 v54, v28, v29
s_waitcnt lgkmcnt(2)
v_mfma_f32_32x32x16_bf16 v[32:47], v[108:111], v[204:207], v[32:47]
ds_read_b128 v[104:107], v6 offset:36992
v_cvt_pk_bf16_f32 v55, v30, v31
buffer_store_dwordx4 v[52:55], v8, s[20:23], s60 offen offset:1024 sc0 sc1
s_add_u32 s60, s60, 98304
s_cmp_ge_u32 s60, 294912
s_cselect_b32 s35, 294912, 0
s_sub_u32 s60, s60, s35
s_waitcnt lgkmcnt(2)
v_mfma_f32_32x32x16_bf16 v[32:47], v[96:99], v[208:211], v[32:47]
ds_read_b128 v[108:111], v6 offset:55424
s_waitcnt lgkmcnt(2)
v_mfma_f32_32x32x16_bf16 v[32:47], v[100:103], v[212:215], v[32:47]
ds_read_b128 v[96:99], v6 offset:37024
s_waitcnt lgkmcnt(2)
v_mfma_f32_32x32x16_bf16 v[32:47], v[104:107], v[216:219], v[32:47]
ds_read_b128 v[100:103], v6 offset:55456
s_waitcnt lgkmcnt(2)
v_mfma_f32_32x32x16_bf16 v[32:47], v[108:111], v[220:223], v[32:47]
ds_read_b128 v[104:107], v6 offset:37056
s_waitcnt lgkmcnt(2)
v_mfma_f32_32x32x16_bf16 v[32:47], v[96:99], v[224:227], v[32:47]
ds_read_b128 v[108:111], v6 offset:55488
s_waitcnt lgkmcnt(2)
v_mfma_f32_32x32x16_bf16 v[32:47], v[100:103], v[228:231], v[32:47]
ds_read_b128 v[96:99], v6 offset:37088
s_waitcnt lgkmcnt(2)
v_mfma_f32_32x32x16_bf16 v[32:47], v[104:107], v[232:235], v[32:47]
ds_read_b128 v[100:103], v6 offset:55520
s_waitcnt lgkmcnt(2)
v_mfma_f32_32x32x16_bf16 v[32:47], v[108:111], v[236:239], v[32:47]
ds_read_b128 v[104:107], v6 offset:37120
s_waitcnt lgkmcnt(2)
v_mfma_f32_32x32x16_bf16 v[32:47], v[96:99], v[240:243], v[32:47]
ds_read_b128 v[108:111], v6 offset:55552
s_waitcnt lgkmcnt(2)
v_mfma_f32_32x32x16_bf16 v[32:47], v[100:103], v[244:247], v[32:47]
s_barrier
ds_read_b128 v[96:99], v7 offset:0
s_waitcnt lgkmcnt(2)
v_mfma_f32_32x32x16_bf16 v[32:47], v[104:107], v[248:251], v[32:47]
ds_read_b128 v[100:103], v7 offset:18432
s_waitcnt lgkmcnt(2)
v_mfma_f32_32x32x16_bf16 v[32:47], v[108:111], v[252:255], v[32:47]
ds_read_b128 v[104:107], v7 offset:32
s_waitcnt lgkmcnt(2)
v_mfma_f32_32x32x16_bf16 v[16:31], v[96:99], v[184:187], 0
ds_read_b128 v[108:111], v7 offset:18464
s_waitcnt lgkmcnt(2)
v_mfma_f32_32x32x16_bf16 v[16:31], v[100:103], v[188:191], v[16:31]
ds_read_b128 v[96:99], v7 offset:64
s_waitcnt lgkmcnt(2)
v_mfma_f32_32x32x16_bf16 v[16:31], v[104:107], v[192:195], v[16:31]
ds_read_b128 v[100:103], v7 offset:18496
s_nop 1
v_cvt_pk_bf16_f32 v48, v32, v33
v_cvt_pk_bf16_f32 v49, v34, v35
v_cvt_pk_bf16_f32 v50, v36, v37
s_waitcnt lgkmcnt(2)
v_mfma_f32_32x32x16_bf16 v[16:31], v[108:111], v[196:199], v[16:31]
ds_read_b128 v[104:107], v7 offset:96
v_cvt_pk_bf16_f32 v51, v38, v39
buffer_store_dwordx4 v[48:51], v8, s[20:23], s60 offen sc0 sc1
v_cvt_pk_bf16_f32 v52, v40, v41
s_waitcnt lgkmcnt(2)
v_mfma_f32_32x32x16_bf16 v[16:31], v[96:99], v[200:203], v[16:31]
ds_read_b128 v[108:111], v7 offset:18528
v_cvt_pk_bf16_f32 v53, v42, v43
v_cvt_pk_bf16_f32 v54, v44, v45
s_waitcnt lgkmcnt(2)
v_mfma_f32_32x32x16_bf16 v[16:31], v[100:103], v[204:207], v[16:31]
ds_read_b128 v[96:99], v7 offset:128
v_cvt_pk_bf16_f32 v55, v46, v47
buffer_store_dwordx4 v[52:55], v8, s[20:23], s60 offen offset:1024 sc0 sc1
s_add_u32 s60, s60, 98304
s_cmp_ge_u32 s60, 294912
s_cselect_b32 s35, 294912, 0
s_sub_u32 s60, s60, s35
s_waitcnt lgkmcnt(2)
v_mfma_f32_32x32x16_bf16 v[16:31], v[104:107], v[208:211], v[16:31]
ds_read_b128 v[100:103], v7 offset:18560
s_waitcnt lgkmcnt(2)
v_mfma_f32_32x32x16_bf16 v[16:31], v[108:111], v[212:215], v[16:31]
ds_read_b128 v[104:107], v7 offset:160
s_waitcnt lgkmcnt(2)
v_mfma_f32_32x32x16_bf16 v[16:31], v[96:99], v[216:219], v[16:31]
ds_read_b128 v[108:111], v7 offset:18592
s_waitcnt lgkmcnt(2)
v_mfma_f32_32x32x16_bf16 v[16:31], v[100:103], v[220:223], v[16:31]
ds_read_b128 v[96:99], v7 offset:192
s_waitcnt lgkmcnt(2)
v_mfma_f32_32x32x16_bf16 v[16:31], v[104:107], v[224:227], v[16:31]
ds_read_b128 v[100:103], v7 offset:18624
s_waitcnt lgkmcnt(2)
v_mfma_f32_32x32x16_bf16 v[16:31], v[108:111], v[228:231], v[16:31]
ds_read_b128 v[104:107], v7 offset:224
s_waitcnt lgkmcnt(2)
v_mfma_f32_32x32x16_bf16 v[16:31], v[96:99], v[232:235], v[16:31]
ds_read_b128 v[108:111], v7 offset:18656
s_waitcnt lgkmcnt(2)
v_mfma_f32_32x32x16_bf16 v[16:31], v[100:103], v[236:239], v[16:31]
ds_read_b128 v[96:99], v7 offset:256
s_waitcnt lgkmcnt(2)
v_mfma_f32_32x32x16_bf16 v[16:31], v[104:107], v[240:243], v[16:31]
ds_read_b128 v[100:103], v7 offset:18688
s_waitcnt lgkmcnt(2)
v_mfma_f32_32x32x16_bf16 v[16:31], v[108:111], v[244:247], v[16:31]
s_waitcnt lgkmcnt(1)
v_mfma_f32_32x32x16_bf16 v[16:31], v[96:99], v[248:251], v[16:31]
s_waitcnt lgkmcnt(0)
v_mfma_f32_32x32x16_bf16 v[16:31], v[100:103], v[252:255], v[16:31]
s_nop 7
s_nop 3
v_cvt_pk_bf16_f32 v48, v16, v17
v_cvt_pk_bf16_f32 v49, v18, v19
v_cvt_pk_bf16_f32 v50, v20, v21
v_cvt_pk_bf16_f32 v51, v22, v23
buffer_store_dwordx4 v[48:51], v8, s[20:23], s60 offen sc0 sc1
v_cvt_pk_bf16_f32 v52, v24, v25
v_cvt_pk_bf16_f32 v53, v26, v27
v_cvt_pk_bf16_f32 v54, v28, v29
v_cvt_pk_bf16_f32 v55, v30, v31
buffer_store_dwordx4 v[52:55], v8, s[20:23], s60 offen offset:1024 sc0 sc1
L_exit:
s_endpgm
.section .rodata,"a"
.p2align 6
.amdhsa_kernel recurrent_scan__ssm_conv_s5__mixer_channel_mlp__prompt_kernel
  .amdhsa_next_free_vgpr 256
  .amdhsa_next_free_sgpr 102
  .amdhsa_accum_offset 256
  .amdhsa_group_segment_fixed_size 0
  .amdhsa_kernarg_size 136
  .amdhsa_user_sgpr_count 2
  .amdhsa_user_sgpr_kernarg_segment_ptr 1
  .amdhsa_system_sgpr_workgroup_id_x 1
.end_amdhsa_kernel
```
